```python
import torch

def _softmax(x, axis=-1):
    return torch.softmax(x, dim=axis)
def _gelu(x):
    return torch.nn.functional.gelu(x, approximate="tanh")
def _silu(x):
    return torch.nn.functional.silu(x)
def _sigmoid(x):
    return torch.sigmoid(x)
def _layernorm(x, axis=-1, eps=1e-5):
    m = x.mean(dim=axis, keepdim=True)
    v = x.var(dim=axis, keepdim=True, unbiased=False)
    return (x - m) / torch.sqrt(v + eps)
def _scatter_add(tgt, idx, src, axis=0):
    return tgt.clone().index_add_(axis, idx, src)
def _segment_sum(src, seg, n):
    out = torch.zeros((n,) + src.shape[1:], dtype=src.dtype)
    return out.index_add_(0, seg, src)
def _pad(x, pw):
    flat = tuple(v for pair in reversed(pw) for v in pair)
    return torch.nn.functional.pad(x, flat)

kernel_name = 'parallel_sum__ssm_conv_s5__geglu_ffn__prompt'

def setup_inputs():

    _w = (lambda a: (lambda t: t.to(torch.bfloat16) if t.is_floating_point() else t)(torch.as_tensor(a)))
    def _A_setup():
        B, S, D = 1, 2048, 576
        P = D
        Lambda_re = -0.5 * (lambda _x: torch.exp(torch.as_tensor(_x)))((lambda *s: torch.randn(*s, dtype=torch.bfloat16) * 0.8)(P))
        Lambda_im = (lambda *s: torch.randn(*s, dtype=torch.bfloat16) * 0.8)(P) * 1.0
        B_re = (lambda *s: torch.randn(*s, dtype=torch.bfloat16) * 0.8)(P, D) * (D ** -0.5)
        B_im = (lambda *s: torch.randn(*s, dtype=torch.bfloat16) * 0.8)(P, D) * (D ** -0.5)
        C_re = (lambda *s: torch.randn(*s, dtype=torch.bfloat16) * 0.8)(D, P) * (P ** -0.5)
        C_im = (lambda *s: torch.randn(*s, dtype=torch.bfloat16) * 0.8)(D, P) * (P ** -0.5)
        log_dt = (lambda *s: torch.randn(*s, dtype=torch.bfloat16) * 0.8)(P) * 0.3 - 2.0
        Dskip = (lambda *s: torch.randn(*s, dtype=torch.bfloat16) * 0.8)(D)
        return {
            "x": _w((lambda *s: torch.randn(*s, dtype=torch.bfloat16) * 0.05)(B, S, D)),
            "Lambda_re": _w(Lambda_re),
            "Lambda_im": _w(Lambda_im),
            "B_re": _w(B_re),
            "B_im": _w(B_im),
            "C_re": _w(C_re),
            "C_im": _w(C_im),
            "log_dt": _w(log_dt),
            "Dskip": _w(Dskip),
        }
    _A_in = _A_setup()

    def _B_setup():
        B, S, D, F = 1, 2048, 576, 4608
        return {
            "x": _w((lambda *s: torch.randn(*s, dtype=torch.bfloat16) * 0.05)(B, S, D)),
            "w_gate": _w((lambda *s: torch.randn(*s, dtype=torch.bfloat16) * 0.05)(D, F)),
            "w_up": _w((lambda *s: torch.randn(*s, dtype=torch.bfloat16) * 0.05)(D, F)),
            "w_down": _w((lambda *s: torch.randn(*s, dtype=torch.bfloat16) * 0.05)(F, D)),
        }
    _B_in = _B_setup()

    return {
        "A_x": _A_in["x"],
        "A_Lambda_re": _A_in["Lambda_re"],
        "A_Lambda_im": _A_in["Lambda_im"],
        "A_B_re": _A_in["B_re"],
        "A_B_im": _A_in["B_im"],
        "A_C_re": _A_in["C_re"],
        "A_C_im": _A_in["C_im"],
        "A_log_dt": _A_in["log_dt"],
        "A_Dskip": _A_in["Dskip"],
        "B_x": _B_in["x"],
        "B_w_gate": _B_in["w_gate"],
        "B_w_up": _B_in["w_up"],
        "B_w_down": _B_in["w_down"],
    }

def reference(A_x, A_Lambda_re, A_Lambda_im, A_B_re, A_B_im, A_C_re, A_C_im, A_log_dt, A_Dskip, B_x, B_w_gate, B_w_up, B_w_down):
    def _A_ref(x, Lambda_re, Lambda_im, B_re, B_im, C_re, C_im, log_dt, Dskip):
        Bsz, L, H = x.shape
        Lam = Lambda_re + 1j * Lambda_im
        Bmat = B_re + 1j * B_im
        Cmat = C_re + 1j * C_im
        dt = torch.exp(log_dt)
        Lam_bar = torch.exp(dt * Lam)
        B_bar = ((Lam_bar - 1.0) / Lam)[:, None] * Bmat
        Bu = torch.einsum("bld,pd->blp", x + 0j, B_bar)
        h = torch.zeros_like(Bu[:, 0, :])
        hs = []
        for t in range(L):
            h = Lam_bar[None, :] * h + Bu[:, t, :]
            hs.append(h)
        hseq = torch.stack(hs, 1)
        y = 2.0 * torch.einsum("blp,dp->bld", hseq, Cmat).real + x * Dskip[None, None, :]
        return y

    def _B_ref(x, w_gate, w_up, w_down):
        return (_gelu(x @ w_gate) * (x @ w_up)) @ w_down

    x = A_x
    xn = _layernorm(x, axis=-1)
    return x + _A_ref(xn, A_Lambda_re, A_Lambda_im, A_B_re, A_B_im, A_C_re, A_C_im, A_log_dt, A_Dskip) + _B_ref(xn, B_w_gate, B_w_up, B_w_down)
```

```asm
; @launch grid=(256,1,1) block=(512,1,1) lds=163840
.amdgcn_target "amdgcn-amd-amdhsa--gfx950"
.text
.globl parallel_sum__ssm_conv_s5__geglu_ffn__prompt_kernel
.p2align 8
.type parallel_sum__ssm_conv_s5__geglu_ffn__prompt_kernel,@function
parallel_sum__ssm_conv_s5__geglu_ffn__prompt_kernel:
    s_cmp_ge_u32 s2, 256
    s_cbranch_scc1 K_END
    s_load_dwordx16 s[16:31], s[0:1], 0
    s_load_dwordx8 s[36:43], s[0:1], 80
    s_load_dwordx4 s[44:47], s[0:1], 112
    v_and_b32 v1, 63, v0
    v_lshrrev_b32 v2, 6, v0
    s_and_b32 s3, s2, 7
    s_lshr_b32 s4, s2, 3
    v_readfirstlane_b32 s7, v2
    s_lshr_b32 s5, s4, 3
    s_lshl_b32 s8, s3, 2
    s_add_u32 s5, s5, s8
    s_and_b32 s6, s4, 7
    s_lshr_b32 s8, s3, 2
    s_lshl_b32 s8, s8, 2
    s_lshr_b32 s9, s4, 3
    s_add_u32 s8, s8, s9
    s_and_b32 s9, s3, 3
    s_lshl_b32 s9, s9, 3
    s_add_u32 s9, s9, s6
    s_lshl_b32 s10, s8, 3
    s_add_u32 s10, s10, s7
    v_lshlrev_b32 v3, 4, v1
    v_lshrrev_b32 v4, 3, v1
    v_and_b32 v5, 7, v1
    v_add_u32 v6, 1024, v3
    v_cmp_gt_u32 vcc, 8, v1
    v_mov_b32 v7, 0x3ffffff0
    s_lshl_b32 s11, s5, 3
    s_add_u32 s11, s11, s6
    v_cndmask_b32 v6, v7, v6, vcc
    s_lshl_b32 s33, s11, 3
    s_add_u32 s33, s33, s7
    s_mul_i32 s13, s33, 1152
    v_mul_u32_u24 v8, 1152, v4
    v_bfe_u32 v9, v4, 1, 1
    s_and_b32 s14, s7, 6
    v_xor_b32 v9, s14, v9
    v_xor_b32 v9, v9, v5
    v_lshl_add_u32 v9, v9, 4, v8
    v_lshrrev_b32 v10, 1, v4
    v_xor_b32 v10, v10, v5
    v_lshl_add_u32 v10, v10, 4, v8
    v_xor_b32 v11, 64, v10
    s_lshl_b32 s14, s7, 6
    s_and_b32 s14, s14, 64
    v_xor_b32 v12, s14, v10
    s_lshl_b32 s14, s5, 3
    s_add_u32 s14, s14, s7
    s_mul_i32 s34, s14, 9216
    s_lshl_b32 s14, s6, 3
    s_add_u32 s35, s14, s7
    s_mul_i32 s35, s35, 9216
    s_add_u32 s80, s6, 64
    s_mul_i32 s80, s80, 9216
    s_lshr_b32 s14, s7, 1
    s_lshl_b32 s14, s14, 7
    s_add_u32 s80, s80, s14
    s_lshl_b32 s81, s7, 10
    s_lshl_b32 s82, s7, 11
    s_waitcnt lgkmcnt(0)
    s_mov_b32 s56, s16
    s_mov_b32 s57, s17
    s_mov_b32 s58, 2359296
    s_mov_b32 s59, 0x20000
    buffer_load_dwordx4 v[80:83], v3, s[56:59], s13 offen
    buffer_load_dwordx4 v[84:87], v6, s[56:59], s13 offen
    s_mov_b32 s60, s22
    s_mov_b32 s61, s23
    s_mov_b32 s62, 663552
    s_mov_b32 s63, 0x20000
    s_mov_b32 s64, s24
    s_mov_b32 s65, s25
    s_mov_b32 s66, 663552
    s_mov_b32 s67, 0x20000
    s_and_b32 s14, s7, 1
    s_cselect_b32 s68, s24, s22
    s_cselect_b32 s69, s25, s23
    s_mov_b32 s70, 663552
    s_mov_b32 s71, 0x20000
    s_mov_b32 s23, 100000
    s_cmp_lt_u32 s2, 128
    s_cselect_b32 s76, s60, s64
    s_cselect_b32 s77, s61, s65
    s_mov_b32 s78, 663552
    s_mov_b32 s79, 0x20000
    s_and_b32 s12, s2, 127
    s_lshl_b32 s12, s12, 3
    s_add_u32 s12, s12, s7
    s_mul_i32 s12, s12, 648
    s_and_b32 s12, s12, 0xffffff80
    v_lshlrev_b32 v13, 7, v1
    s_mov_b64 exec, 0x7f
    buffer_load_dword v111, v13, s[76:79], s12 offen
    s_mov_b64 exec, -1
    s_add_u32 s12, s34, 0
    s_add_u32 m0, s81, 16384
    s_nop 0
    buffer_load_dwordx4 v9, s[56:59], s12 offen lds
    buffer_load_dwordx4 v[112:115], v10, s[60:63], s35 offen offset:0
    buffer_load_dwordx4 v[116:119], v11, s[64:67], s35 offen offset:0
    s_add_u32 s12, s80, 0
    s_add_u32 m0, s81, 122912
    s_nop 0
    buffer_load_dwordx4 v12, s[68:71], s12 offen lds
    s_cmp_lg_u32 s7, 5
    s_cbranch_scc1 NOCPF
    s_getpc_b64 s[76:77]
PCREF:
    s_and_b32 s76, s76, 0xffffff80
    s_mov_b32 s78, K_LAST-PCREF
    s_mov_b32 s79, 0x20000
    s_lshl_b32 s14, s4, 11
    v_lshlrev_b32 v13, 7, v1
    s_mov_b64 exec, 0xffff
    buffer_load_dword v111, v13, s[76:79], s14 offen
    s_mov_b64 exec, -1
NOCPF:
    s_mov_b32 s72, s44
    s_mov_b32 s73, s45
    s_mov_b32 s74, 256
    s_mov_b32 s75, 0x20000
    s_or_b32 s14, s2, s7
    s_cmp_lg_u32 s14, 0
    s_cbranch_scc1 NOTAG
    s_memrealtime s[84:85]
    s_waitcnt lgkmcnt(0)
    s_mul_i32 s14, s84, 0x9E3779B1
    s_or_b32 s14, s14, 1
    v_mov_b32 v8, s14
    s_mov_b64 exec, 1
    buffer_store_dword v8, off, s[72:75], 0 sc1
    s_mov_b64 exec, -1
NOTAG:
    s_mov_b32 s48, s46
    s_mov_b32 s49, s47
    s_mov_b32 s50, 268435456
    s_mov_b32 s51, 0x20000
    s_mov_b32 s52, s42
    s_mov_b32 s53, s43
    s_mov_b32 s54, 4718592
    s_mov_b32 s55, 0x20000
    v_and_b32 v13, 15, v1
    v_lshrrev_b32 v14, 4, v1
    v_bfe_u32 v2, v1, 1, 3
    v_xor_b32 v2, v2, v14
    v_lshlrev_b32 v2, 4, v2
    v_lshl_add_u32 v8, v13, 7, v2
    v_bfe_u32 v14, v1, 2, 2
    v_lshlrev_b32 v14, 11, v14
    v_and_b32 v13, 3, v1
    v_lshl_add_u32 v14, v13, 7, v14
    s_add_u32 s12, s34, 128
    s_add_u32 m0, s81, 90144
    s_nop 0
    buffer_load_dwordx4 v9, s[56:59], s12 offen lds
    v_add_u32 v196, v14, v2
    v_xor_b32 v197, 64, v196
    v_add_u32 v198, 90144, v196
    v_add_u32 v199, 90144, v197
    s_lshr_b32 s14, s7, 2
    s_lshl_b32 s14, s14, 6
    v_xor_b32 v204, s14, v8
    v_add_u32 v204, 122912, v204
    v_xor_b32 v200, s14, v196
    s_and_b32 s14, s7, 3
    s_lshl_b32 s14, s14, 9
    v_add_u32 v200, s14, v200
    v_add_u32 v201, 90144, v200
    s_add_u32 s14, s82, 57344
    v_add_u32 v192, s14, v8
    v_xor_b32 v193, 64, v192
    v_add_u32 v194, s14, v3
    v_mov_b32 v236, 0x3f803f80
    v_mov_b32 v237, 0x3f803f80
    v_mov_b32 v238, 0x3f803f80
    buffer_load_dwordx4 v[120:123], v10, s[60:63], s35 offen offset:128
    v_mov_b32 v239, 0x3f803f80
    s_mov_b32 s83, 0x3f803f80
    s_lshl_b32 s14, s6, 3
    v_add_u32 v14, s14, v5
    v_add_u32 v14, 512, v14
    s_add_u32 s14, s14, s7
    s_lshl_b32 s14, s14, 3
    v_add_u32 v13, s14, v5
    v_lshlrev_b32 v108, 1, v13
    v_lshlrev_b32 v109, 1, v14
    buffer_load_dwordx4 v[124:127], v11, s[64:67], s35 offen offset:128
    s_lshr_b32 s14, s9, 2
    s_mul_i32 s14, s14, 1152
    s_cmp_lt_u32 s2, 128
    s_cselect_b32 s76, s36, s38
    s_cselect_b32 s77, s37, s39
    s_mov_b32 s78, 5308416
    s_mov_b32 s79, 0x20000
    s_add_u32 s24, s36, s14
    s_addc_u32 s25, s37, 0
    s_sub_u32 s26, 5308416, s14
    s_mov_b32 s27, 0x20000
    s_add_u32 s36, s38, s14
    s_addc_u32 s37, s39, 0
    s_mov_b32 s38, s26
    s_mov_b32 s39, 0x20000
    s_and_b32 s14, s9, 3
    s_lshl_b32 s32, s14, 8
    s_mul_i32 s41, s7, 73728
    s_add_u32 s32, s32, s41
    s_mul_i32 s40, s10, 36864
    v_bfe_u32 v0, v1, 2, 3
    v_mul_u32_u24 v0, 9216, v0
    v_lshrrev_b32 v13, 5, v1
    v_lshl_add_u32 v0, v13, 6, v0
    v_and_b32 v13, 3, v1
    v_lshl_add_u32 v0, v13, 4, v0
    v_lshlrev_b32 v110, 7, v1
    v_min_u32 v110, 1792, v110
    s_and_b32 s14, s2, 127
    s_lshl_b32 s14, s14, 3
    s_add_u32 s14, s14, s7
    s_mul_i32 s41, s14, 1728
    s_and_b32 s41, s41, 0xffffff80
    s_lshl_b32 s14, s7, 4
    s_add_u32 s14, s14, 147584
    v_lshl_add_u32 v202, v1, 7, s14
    s_add_u32 s14, s81, 147584
    v_add_u32 v203, s14, v3
    v_lshlrev_b32 v205, 9, v4
    v_lshl_add_u32 v205, v5, 4, v205
    s_add_u32 s12, s34, 256
    s_add_u32 m0, s81, 24576
    s_nop 0
    buffer_load_dwordx4 v9, s[56:59], s12 offen lds
    s_lshr_b32 s42, s11, 2
    s_mul_i32 s42, s42, 36864
    s_and_b32 s14, s6, 3
    s_lshl_b32 s14, s14, 7
    s_add_u32 s42, s42, s14
    s_lshl_b32 s14, s7, 12
    s_add_u32 s42, s42, s14
    s_lshl_b32 s43, s33, 3
    s_add_u32 s43, s43, 63963136
    v_lshlrev_b32 v17, 2, v1
    buffer_load_dwordx4 v[128:131], v10, s[60:63], s35 offen offset:256
    v_and_b32 v16, 31, v17
    v_and_b32 v17, 127, v17
    s_lshl_b32 s14, s8, 7
    v_add_u32 v17, s14, v17
    s_lshl_b32 s14, s5, 5
    v_add_u32 v16, s14, v16
    v_cmp_lt_u32 vcc, 31, v1
    s_mov_b32 s33, 65011712
    s_nop 0
    v_cndmask_b32 v17, v17, v16, vcc
    buffer_load_dwordx4 v[132:135], v11, s[64:67], s35 offen offset:256
    s_waitcnt vmcnt(11)
    v_dot2_f32_bf16 v96, v80, s83, 0
    v_dot2_f32_bf16 v97, v80, v80, 0
    v_dot2_f32_bf16 v96, v81, s83, v96
    v_dot2_f32_bf16 v97, v81, v81, v97
    v_dot2_f32_bf16 v96, v82, s83, v96
    v_dot2_f32_bf16 v97, v82, v82, v97
    v_dot2_f32_bf16 v96, v83, s83, v96
    v_dot2_f32_bf16 v97, v83, v83, v97
    v_dot2_f32_bf16 v96, v84, s83, v96
    v_dot2_f32_bf16 v97, v84, v84, v97
    v_dot2_f32_bf16 v96, v85, s83, v96
    v_dot2_f32_bf16 v97, v85, v85, v97
    s_add_u32 s12, s34, 384
    s_add_u32 m0, s81, 98336
    s_nop 0
    buffer_load_dwordx4 v9, s[56:59], s12 offen lds
    v_dot2_f32_bf16 v96, v86, s83, v96
    v_dot2_f32_bf16 v97, v86, v86, v97
    v_dot2_f32_bf16 v96, v87, s83, v96
    v_dot2_f32_bf16 v97, v87, v87, v97
    s_nop 2
    v_add_f32_dpp v96, v96, v96 quad_perm:[1,0,3,2] row_mask:0xf bank_mask:0xf
    v_add_f32_dpp v97, v97, v97 quad_perm:[1,0,3,2] row_mask:0xf bank_mask:0xf
    s_nop 0
    v_add_f32_dpp v96, v96, v96 quad_perm:[2,3,0,1] row_mask:0xf bank_mask:0xf
    v_add_f32_dpp v97, v97, v97 quad_perm:[2,3,0,1] row_mask:0xf bank_mask:0xf
    s_nop 0
    v_add_f32_dpp v96, v96, v96 row_half_mirror row_mask:0xf bank_mask:0xf
    buffer_load_dwordx4 v[136:139], v10, s[60:63], s35 offen offset:384
    v_add_f32_dpp v97, v97, v97 row_half_mirror row_mask:0xf bank_mask:0xf
    s_nop 0
    v_add_f32_dpp v96, v96, v96 row_mirror row_mask:0xf bank_mask:0xf
    v_add_f32_dpp v97, v97, v97 row_mirror row_mask:0xf bank_mask:0xf
    s_nop 0
    v_add_f32_dpp v96, v96, v96 row_bcast:15 row_mask:0xa bank_mask:0xf
    v_add_f32_dpp v97, v97, v97 row_bcast:15 row_mask:0xa bank_mask:0xf
    s_nop 0
    v_add_f32_dpp v96, v96, v96 row_bcast:31 row_mask:0xc bank_mask:0xf
    v_add_f32_dpp v97, v97, v97 row_bcast:31 row_mask:0xc bank_mask:0xf
    s_nop 0
    v_readlane_b32 s44, v96, 63
    buffer_load_dwordx4 v[140:143], v11, s[64:67], s35 offen offset:384
    v_readlane_b32 s45, v97, 63
    s_nop 1
    v_mov_b32 v96, s44
    v_mov_b32 v97, s45
    v_mul_f32 v96, 0x3ae38e39, v96
    v_mul_f32 v97, 0x3ae38e39, v97
    v_fma_f32 v97, -v96, v96, v97
    v_max_f32 v97, 0, v97
    v_cvt_pk_bf16_f32 v98, v96, v97
    v_lshlrev_b32 v96, 16, v98
    v_and_b32 v97, 0xffff0000, v98
    v_add_f32 v97, 0x3727c5ac, v97
    s_add_u32 s12, s80, 512
    s_add_u32 m0, s81, 131104
    s_nop 0
    buffer_load_dwordx4 v12, s[68:71], s12 offen lds
    v_cvt_pk_bf16_f32 v97, v97, v97
    v_lshlrev_b32 v97, 16, v97
    v_sqrt_f32 v97, v97
    s_nop 0
    v_cvt_pk_bf16_f32 v97, v97, v97
    v_lshlrev_b32 v97, 16, v97
    v_rcp_f32 v97, v97
    s_nop 0
    s_mov_b32 s44, 0xffff0000
    v_sub_f32 v18, 0, v96
    v_sub_f32 v19, 0, v96
    v_mov_b32 v20, v97
    global_load_ushort v250, v108, s[18:19]
    global_load_ushort v251, v108, s[20:21]
    global_load_ushort v252, v108, s[30:31]
    v_mov_b32 v21, v97
    v_lshlrev_b32 v100, 16, v80
    v_and_b32 v101, s44, v80
    v_lshlrev_b32 v102, 16, v81
    v_and_b32 v103, s44, v81
    v_lshlrev_b32 v104, 16, v82
    v_and_b32 v105, s44, v82
    v_lshlrev_b32 v106, 16, v83
    v_and_b32 v107, s44, v83
    v_pk_add_f32 v[100:101], v[100:101], v[18:19]
    v_pk_add_f32 v[102:103], v[102:103], v[18:19]
    v_pk_add_f32 v[104:105], v[104:105], v[18:19]
    global_load_ushort v253, v109, s[18:19]
    global_load_ushort v254, v109, s[20:21]
    global_load_ushort v255, v109, s[30:31]
    v_pk_add_f32 v[106:107], v[106:107], v[18:19]
    v_cvt_pk_bf16_f32 v101, v100, v101
    v_cvt_pk_bf16_f32 v103, v102, v103
    v_cvt_pk_bf16_f32 v105, v104, v105
    v_cvt_pk_bf16_f32 v107, v106, v107
    v_lshlrev_b32 v100, 16, v101
    v_and_b32 v101, s44, v101
    v_lshlrev_b32 v102, 16, v103
    v_and_b32 v103, s44, v103
    v_lshlrev_b32 v104, 16, v105
    v_and_b32 v105, s44, v105
    v_lshlrev_b32 v106, 16, v107
    buffer_load_dword v15, off, s[72:75], 0 sc1
    v_and_b32 v107, s44, v107
    v_pk_mul_f32 v[100:101], v[100:101], v[20:21]
    v_pk_mul_f32 v[102:103], v[102:103], v[20:21]
    v_pk_mul_f32 v[104:105], v[104:105], v[20:21]
    v_pk_mul_f32 v[106:107], v[106:107], v[20:21]
    v_cvt_pk_bf16_f32 v88, v100, v101
    v_cvt_pk_bf16_f32 v89, v102, v103
    v_cvt_pk_bf16_f32 v90, v104, v105
    v_cvt_pk_bf16_f32 v91, v106, v107
    v_lshlrev_b32 v100, 16, v84
    v_and_b32 v101, s44, v84
    v_lshlrev_b32 v102, 16, v85
    s_add_u32 s12, s41, 3538944
    s_mov_b64 exec, 0x7fff
    buffer_load_dword v111, v110, s[76:79], s12 offen
    s_mov_b64 exec, -1
    v_and_b32 v103, s44, v85
    v_lshlrev_b32 v104, 16, v86
    v_and_b32 v105, s44, v86
    v_lshlrev_b32 v106, 16, v87
    v_and_b32 v107, s44, v87
    v_pk_add_f32 v[100:101], v[100:101], v[18:19]
    v_pk_add_f32 v[102:103], v[102:103], v[18:19]
    v_pk_add_f32 v[104:105], v[104:105], v[18:19]
    v_pk_add_f32 v[106:107], v[106:107], v[18:19]
    v_cvt_pk_bf16_f32 v101, v100, v101
    v_cvt_pk_bf16_f32 v103, v102, v103
    v_cvt_pk_bf16_f32 v105, v104, v105
    s_add_u32 s12, s34, 512
    s_add_u32 m0, s81, 32768
    s_nop 0
    buffer_load_dwordx4 v9, s[56:59], s12 offen lds
    v_cvt_pk_bf16_f32 v107, v106, v107
    v_lshlrev_b32 v100, 16, v101
    v_and_b32 v101, s44, v101
    v_lshlrev_b32 v102, 16, v103
    v_and_b32 v103, s44, v103
    v_lshlrev_b32 v104, 16, v105
    v_and_b32 v105, s44, v105
    v_lshlrev_b32 v106, 16, v107
    v_and_b32 v107, s44, v107
    v_pk_mul_f32 v[100:101], v[100:101], v[20:21]
    v_pk_mul_f32 v[102:103], v[102:103], v[20:21]
    v_pk_mul_f32 v[104:105], v[104:105], v[20:21]
    buffer_load_dwordx4 v[144:147], v10, s[60:63], s35 offen offset:512
    v_pk_mul_f32 v[106:107], v[106:107], v[20:21]
    v_cvt_pk_bf16_f32 v92, v100, v101
    v_cvt_pk_bf16_f32 v93, v102, v103
    v_cvt_pk_bf16_f32 v94, v104, v105
    v_cvt_pk_bf16_f32 v95, v106, v107
    ds_write_b128 v202, v[88:91]
    s_mov_b64 exec, 0xff
    ds_write_b128 v202, v[92:95] offset:8192
    s_mov_b64 exec, -1
    s_mov_b64 exec, 1
    buffer_store_dwordx2 v[96:97], off, s[48:51], s43 sc1
    s_mov_b64 exec, -1
    s_waitcnt lgkmcnt(0)
    s_waitcnt vmcnt(20)
    s_barrier
    ds_read_b128 v[80:83], v203
    s_cmp_lg_u32 s7, 0
    s_cbranch_scc1 NOXN8_2
    ds_read_b128 v[84:87], v203 offset:8192
    s_add_u32 s12, s42, 32768
    s_waitcnt lgkmcnt(0)
    buffer_store_dwordx4 v[84:87], v205, s[48:51], s12 offen sc1
NOXN8_2:
    ds_write_b128 v194, v[112:115]
    ds_write_b128 v194, v[116:119] offset:1024
    ds_read_b128 v[176:179], v192
    ds_read_b128 v[180:183], v193
    ds_read_b128 v[24:27], v196 offset:16384
    ds_read_b128 v[28:31], v196 offset:16896
    ds_read_b128 v[32:35], v196 offset:17408
    ds_read_b128 v[36:39], v196 offset:17920
    ds_read_b128 v[40:43], v197 offset:16384
    ds_read_b128 v[44:47], v197 offset:16896
    ds_read_b128 v[48:51], v197 offset:17408
    ds_read_b128 v[52:55], v197 offset:17920
    ds_read_b128 v[56:59], v198 offset:0
    ds_read_b128 v[60:63], v198 offset:512
    ds_read_b128 v[64:67], v198 offset:1024
    ds_read_b128 v[68:71], v198 offset:1536
    ds_read_b128 v[72:75], v200 offset:16384
    ds_read_b128 v[76:79], v204 offset:0
    s_waitcnt lgkmcnt(10)
    v_mfma_f32_16x16x32_bf16 v[208:211], v[24:27], v[176:179], 0
    buffer_store_dwordx4 v[80:83], v205, s[48:51], s42 offen sc1
    v_mfma_f32_16x16x32_bf16 v[212:215], v[28:31], v[176:179], 0
    buffer_load_dwordx4 v[148:151], v11, s[64:67], s35 offen offset:512
    v_mfma_f32_16x16x32_bf16 v[216:219], v[32:35], v[176:179], 0
    v_mfma_f32_16x16x32_bf16 v[220:223], v[36:39], v[176:179], 0
    s_add_u32 s12, s34, 640
    s_add_u32 m0, s81, 106528
    s_nop 0
    buffer_load_dwordx4 v9, s[56:59], s12 offen lds
    v_mfma_f32_16x16x32_bf16 v[240:243], v[236:239], v[176:179], 0
    s_waitcnt vmcnt(21)
    ds_write_b128 v194, v[120:123]
    ds_write_b128 v194, v[124:127] offset:1024
    ds_read_b128 v[184:187], v192
    ds_read_b128 v[188:191], v193
    ds_read_b128 v[24:27], v199 offset:0
    ds_read_b128 v[28:31], v199 offset:512
    ds_read_b128 v[32:35], v199 offset:1024
    ds_read_b128 v[36:39], v199 offset:1536
    s_waitcnt lgkmcnt(14)
    s_waitcnt lgkmcnt(8)
    v_mfma_f32_16x16x32_bf16 v[208:211], v[40:43], v[180:183], v[208:211]
    v_mfma_f32_16x16x32_bf16 v[212:215], v[44:47], v[180:183], v[212:215]
    buffer_load_dwordx4 v[152:155], v10, s[60:63], s35 offen offset:640
    v_mfma_f32_16x16x32_bf16 v[216:219], v[48:51], v[180:183], v[216:219]
    v_mfma_f32_16x16x32_bf16 v[220:223], v[52:55], v[180:183], v[220:223]
    buffer_load_dwordx4 v[156:159], v11, s[64:67], s35 offen offset:640
    v_mfma_f32_16x16x32_bf16 v[240:243], v[236:239], v[180:183], v[240:243]
    v_mfma_f32_16x16x32_bf16 v[224:227], v[72:75], v[76:79], 0
    s_add_u32 s12, s34, 768
    s_add_u32 m0, s81, 40960
    s_nop 0
    buffer_load_dwordx4 v9, s[56:59], s12 offen lds
    v_mfma_f32_16x16x32_bf16 v[228:231], v[236:239], v[76:79], 0
    s_waitcnt vmcnt(20)
    s_barrier
    ds_read_b128 v[40:43], v196 offset:24576
    ds_read_b128 v[44:47], v196 offset:25088
    ds_read_b128 v[48:51], v196 offset:25600
    ds_read_b128 v[52:55], v196 offset:26112
    ds_read_b128 v[72:75], v201 offset:0
    ds_read_b128 v[76:79], v204 offset:2048
    s_waitcnt lgkmcnt(10)
    v_mfma_f32_16x16x32_bf16 v[208:211], v[56:59], v[184:187], v[208:211]
    v_mfma_f32_16x16x32_bf16 v[212:215], v[60:63], v[184:187], v[212:215]
    buffer_load_dwordx4 v[160:163], v10, s[60:63], s35 offen offset:768
    v_mfma_f32_16x16x32_bf16 v[216:219], v[64:67], v[184:187], v[216:219]
    v_mfma_f32_16x16x32_bf16 v[220:223], v[68:71], v[184:187], v[220:223]
    buffer_load_dwordx4 v[164:167], v11, s[64:67], s35 offen offset:768
    v_mfma_f32_16x16x32_bf16 v[240:243], v[236:239], v[184:187], v[240:243]
    ds_write_b128 v194, v[128:131]
    ds_write_b128 v194, v[132:135] offset:1024
    ds_read_b128 v[176:179], v192
    ds_read_b128 v[180:183], v193
    ds_read_b128 v[56:59], v197 offset:24576
    ds_read_b128 v[60:63], v197 offset:25088
    ds_read_b128 v[64:67], v197 offset:25600
    ds_read_b128 v[68:71], v197 offset:26112
    s_waitcnt lgkmcnt(14)
    s_waitcnt lgkmcnt(8)
    v_mfma_f32_16x16x32_bf16 v[208:211], v[24:27], v[188:191], v[208:211]
    v_mfma_f32_16x16x32_bf16 v[212:215], v[28:31], v[188:191], v[212:215]
    s_add_u32 s12, s34, 896
    s_add_u32 m0, s81, 114720
    s_nop 0
    buffer_load_dwordx4 v9, s[56:59], s12 offen lds
    v_mfma_f32_16x16x32_bf16 v[216:219], v[32:35], v[188:191], v[216:219]
    v_mfma_f32_16x16x32_bf16 v[220:223], v[36:39], v[188:191], v[220:223]
    buffer_load_dwordx4 v[168:171], v10, s[60:63], s35 offen offset:896
    v_mfma_f32_16x16x32_bf16 v[240:243], v[236:239], v[188:191], v[240:243]
    v_mfma_f32_16x16x32_bf16 v[224:227], v[72:75], v[76:79], v[224:227]
    buffer_load_dwordx4 v[172:175], v11, s[64:67], s35 offen offset:896
    v_mfma_f32_16x16x32_bf16 v[228:231], v[236:239], v[76:79], v[228:231]
    ds_read_b128 v[24:27], v198 offset:8192
    ds_read_b128 v[28:31], v198 offset:8704
    ds_read_b128 v[32:35], v198 offset:9216
    ds_read_b128 v[36:39], v198 offset:9728
    ds_read_b128 v[72:75], v200 offset:24576
    ds_read_b128 v[76:79], v204 offset:4096
    s_waitcnt lgkmcnt(10)
    v_mfma_f32_16x16x32_bf16 v[208:211], v[40:43], v[176:179], v[208:211]
    v_mfma_f32_16x16x32_bf16 v[212:215], v[44:47], v[176:179], v[212:215]
    s_add_u32 s12, s41, 1769472
    s_mov_b64 exec, 0x7fff
    buffer_load_dword v111, v110, s[76:79], s12 offen
    s_mov_b64 exec, -1
    v_mfma_f32_16x16x32_bf16 v[216:219], v[48:51], v[176:179], v[216:219]
    v_mfma_f32_16x16x32_bf16 v[220:223], v[52:55], v[176:179], v[220:223]
    s_cmp_ge_u32 s7, 2
    s_cbranch_scc1 B8X_1
    s_add_u32 s12, s80, 1024
    s_add_u32 m0, s81, 139296
    s_nop 0
    buffer_load_dwordx4 v12, s[68:71], s12 offen lds
B8X_1:
    v_mfma_f32_16x16x32_bf16 v[240:243], v[236:239], v[176:179], v[240:243]
    s_waitcnt vmcnt(24)
    ds_write_b128 v194, v[136:139]
    ds_write_b128 v194, v[140:143] offset:1024
    ds_read_b128 v[184:187], v192
    ds_read_b128 v[188:191], v193
    ds_read_b128 v[40:43], v199 offset:8192
    ds_read_b128 v[44:47], v199 offset:8704
    ds_read_b128 v[48:51], v199 offset:9216
    ds_read_b128 v[52:55], v199 offset:9728
    s_waitcnt lgkmcnt(14)
    s_waitcnt lgkmcnt(8)
    v_mfma_f32_16x16x32_bf16 v[208:211], v[56:59], v[180:183], v[208:211]
    v_mfma_f32_16x16x32_bf16 v[212:215], v[60:63], v[180:183], v[212:215]
    s_add_u32 s12, s34, 1024
    s_add_u32 m0, s81, 49152
    s_nop 0
    buffer_load_dwordx4 v9, s[56:59], s12 offen lds
    v_mfma_f32_16x16x32_bf16 v[216:219], v[64:67], v[180:183], v[216:219]
    v_mfma_f32_16x16x32_bf16 v[220:223], v[68:71], v[180:183], v[220:223]
    buffer_load_dwordx4 v[88:91], v10, s[60:63], s35 offen offset:1024
    v_mfma_f32_16x16x32_bf16 v[240:243], v[236:239], v[180:183], v[240:243]
    v_mfma_f32_16x16x32_bf16 v[224:227], v[72:75], v[76:79], v[224:227]
    buffer_load_dwordx4 v[92:95], v11, s[64:67], s35 offen offset:1024
    v_mfma_f32_16x16x32_bf16 v[228:231], v[236:239], v[76:79], v[228:231]
    s_waitcnt vmcnt(12)
    v_readfirstlane_b32 s15, v15
    s_cmp_eq_u32 s15, 0
    s_cbranch_scc1 TAGSLOW_3
TAGBACK_4:
    s_barrier
    s_cmp_lg_u32 s7, 6
    s_cbranch_scc1 NOFLAG_5
    s_lshl_b32 s14, s11, 2
    s_add_u32 s14, s14, 65011712
    v_mov_b32 v13, s15
    s_mov_b64 exec, 1
    buffer_store_dword v13, off, s[48:51], s14 sc1
    s_mov_b64 exec, -1
NOFLAG_5:
    ds_read_b128 v[56:59], v196 offset:32768
    ds_read_b128 v[60:63], v196 offset:33280
    ds_read_b128 v[64:67], v196 offset:33792
    ds_read_b128 v[68:71], v196 offset:34304
    ds_read_b128 v[72:75], v201 offset:8192
    ds_read_b128 v[76:79], v204 offset:6144
    s_waitcnt lgkmcnt(10)
    v_mfma_f32_16x16x32_bf16 v[208:211], v[24:27], v[184:187], v[208:211]
    v_mfma_f32_16x16x32_bf16 v[212:215], v[28:31], v[184:187], v[212:215]
    s_add_u32 s12, s32, 0
    s_add_u32 m0, s81, 0
    s_nop 0
    buffer_load_dwordx4 v0, s[24:27], s12 offen lds
    v_mfma_f32_16x16x32_bf16 v[216:219], v[32:35], v[184:187], v[216:219]
    v_mfma_f32_16x16x32_bf16 v[220:223], v[36:39], v[184:187], v[220:223]
    s_add_u32 s12, s32, 0
    s_add_u32 m0, s81, 73760
    s_nop 0
    buffer_load_dwordx4 v0, s[36:39], s12 offen lds
    v_mfma_f32_16x16x32_bf16 v[240:243], v[236:239], v[184:187], v[240:243]
    ds_write_b128 v194, v[144:147]
    ds_write_b128 v194, v[148:151] offset:1024
    ds_read_b128 v[176:179], v192
    ds_read_b128 v[180:183], v193
    ds_read_b128 v[24:27], v197 offset:32768
    ds_read_b128 v[28:31], v197 offset:33280
    ds_read_b128 v[32:35], v197 offset:33792
    ds_read_b128 v[36:39], v197 offset:34304
    s_waitcnt lgkmcnt(14)
    s_waitcnt lgkmcnt(8)
    v_mfma_f32_16x16x32_bf16 v[208:211], v[40:43], v[188:191], v[208:211]
    v_lshlrev_b32 v250, 16, v250
    v_lshlrev_b32 v251, 16, v251
    v_mfma_f32_16x16x32_bf16 v[212:215], v[44:47], v[188:191], v[212:215]
    v_lshlrev_b32 v252, 16, v252
    v_mul_f32 v103, 0x3fb8aa3b, v252
    s_add_u32 s12, s32, 589824
    s_add_u32 m0, s81, 8192
    s_nop 0
    buffer_load_dwordx4 v0, s[24:27], s12 offen lds
    v_mfma_f32_16x16x32_bf16 v[216:219], v[48:51], v[188:191], v[216:219]
    v_exp_f32 v103, v103
    s_nop 0
    v_mfma_f32_16x16x32_bf16 v[220:223], v[52:55], v[188:191], v[220:223]
    v_cvt_pk_bf16_f32 v103, v103, v103
    v_lshlrev_b32 v103, 16, v103
    s_add_u32 s12, s32, 589824
    s_add_u32 m0, s81, 81952
    s_nop 0
    buffer_load_dwordx4 v0, s[36:39], s12 offen lds
    v_mfma_f32_16x16x32_bf16 v[240:243], v[236:239], v[188:191], v[240:243]
    v_mul_f32 v104, v103, v250
    v_mul_f32 v105, v103, v251
    v_mfma_f32_16x16x32_bf16 v[224:227], v[72:75], v[76:79], v[224:227]
    v_mul_f32 v104, 0x3fb8aa3b, v104
    v_exp_f32 v104, v104
    s_add_u32 s12, s41, 0
    s_mov_b64 exec, 0x7fff
    buffer_load_dword v111, v110, s[76:79], s12 offen
    s_mov_b64 exec, -1
    v_mfma_f32_16x16x32_bf16 v[228:231], v[236:239], v[76:79], v[228:231]
    v_mul_f32 v105, 0x3e22f983, v105
    v_rndne_f32 v106, v105
    ds_read_b128 v[40:43], v198 offset:16384
    ds_read_b128 v[44:47], v198 offset:16896
    ds_read_b128 v[48:51], v198 offset:17408
    ds_read_b128 v[52:55], v198 offset:17920
    ds_read_b128 v[72:75], v200 offset:32768
    ds_read_b128 v[76:79], v204 offset:8192
    s_waitcnt lgkmcnt(10)
    v_mfma_f32_16x16x32_bf16 v[208:211], v[56:59], v[176:179], v[208:211]
    v_sub_f32 v105, v105, v106
    v_cos_f32 v106, v105
    v_mfma_f32_16x16x32_bf16 v[212:215], v[60:63], v[176:179], v[212:215]
    v_sin_f32 v105, v105
    s_nop 0
    s_add_u32 s12, s32, 1179648
    s_add_u32 m0, s81, 16384
    s_nop 0
    buffer_load_dwordx4 v0, s[24:27], s12 offen lds
    v_mfma_f32_16x16x32_bf16 v[216:219], v[64:67], v[176:179], v[216:219]
    v_mul_f32 v244, v104, v106
    v_mul_f32 v100, v104, v105
    v_mfma_f32_16x16x32_bf16 v[220:223], v[68:71], v[176:179], v[220:223]
    v_add_f32 v103, -1.0, v244
    v_mul_f32 v104, v250, v250
    s_add_u32 s12, s32, 1179648
    s_add_u32 m0, s81, 90144
    s_nop 0
    buffer_load_dwordx4 v0, s[36:39], s12 offen lds
    v_mfma_f32_16x16x32_bf16 v[240:243], v[236:239], v[176:179], v[240:243]
    v_fmac_f32 v104, v251, v251
    v_rcp_f32 v104, v104
    s_waitcnt vmcnt(17)
    ds_write_b128 v194, v[152:155]
    ds_write_b128 v194, v[156:159] offset:1024
    ds_read_b128 v[184:187], v192
    ds_read_b128 v[188:191], v193
    ds_read_b128 v[56:59], v199 offset:16384
    ds_read_b128 v[60:63], v199 offset:16896
    ds_read_b128 v[64:67], v199 offset:17408
    ds_read_b128 v[68:71], v199 offset:17920
    s_waitcnt lgkmcnt(14)
    s_waitcnt lgkmcnt(8)
    v_mfma_f32_16x16x32_bf16 v[208:211], v[24:27], v[180:183], v[208:211]
    v_mul_f32 v101, v103, v250
    v_fmac_f32 v101, v100, v251
    v_mfma_f32_16x16x32_bf16 v[212:215], v[28:31], v[180:183], v[212:215]
    v_mul_f32 v102, v100, v250
    v_fma_f32 v102, -v103, v251, v102
    v_mfma_f32_16x16x32_bf16 v[216:219], v[32:35], v[180:183], v[216:219]
    v_mul_f32 v101, v101, v104
    v_mul_f32 v102, v102, v104
    v_mfma_f32_16x16x32_bf16 v[220:223], v[36:39], v[180:183], v[220:223]
    v_and_b32 v107, 8, v1
    v_lshlrev_b32 v107, 28, v107
    v_mfma_f32_16x16x32_bf16 v[240:243], v[236:239], v[180:183], v[240:243]
    v_xor_b32 v245, v107, v100
    v_add_f32 v246, v101, v101
    v_mfma_f32_16x16x32_bf16 v[224:227], v[72:75], v[76:79], v[224:227]
    v_xor_b32 v246, v107, v246
    v_mul_f32 v247, -2.0, v102
    v_mfma_f32_16x16x32_bf16 v[228:231], v[236:239], v[76:79], v[228:231]
    v_mul_f32 v103, v100, v100
    v_mul_f32 v249, v244, v100
    s_waitcnt vmcnt(13)
    s_barrier
    ds_read_b128 v[24:27], v196 offset:40960
    ds_read_b128 v[28:31], v196 offset:41472
    ds_read_b128 v[32:35], v196 offset:41984
    ds_read_b128 v[36:39], v196 offset:42496
    ds_read_b128 v[72:75], v201 offset:16384
    ds_read_b128 v[76:79], v204 offset:10240
    s_waitcnt lgkmcnt(10)
    v_mfma_f32_16x16x32_bf16 v[208:211], v[40:43], v[184:187], v[208:211]
    v_fma_f32 v248, v244, v244, -v103
    v_add_f32 v249, v249, v249
    v_mfma_f32_16x16x32_bf16 v[212:215], v[44:47], v[184:187], v[212:215]
    v_mul_f32 v103, v249, v249
    v_mul_f32 v249, v248, v249
    s_add_u32 s12, s32, 1769472
    s_add_u32 m0, s81, 24576
    s_nop 0
    buffer_load_dwordx4 v0, s[24:27], s12 offen lds
    v_mfma_f32_16x16x32_bf16 v[216:219], v[48:51], v[184:187], v[216:219]
    v_fma_f32 v248, v248, v248, -v103
    v_add_f32 v249, v249, v249
    v_mfma_f32_16x16x32_bf16 v[220:223], v[52:55], v[184:187], v[220:223]
    v_mul_f32 v103, v249, v249
    v_mul_f32 v249, v248, v249
    s_add_u32 s12, s32, 1769472
    s_add_u32 m0, s81, 98336
    s_nop 0
    buffer_load_dwordx4 v0, s[36:39], s12 offen lds
    v_mfma_f32_16x16x32_bf16 v[240:243], v[236:239], v[184:187], v[240:243]
    v_fma_f32 v248, v248, v248, -v103
    v_add_f32 v249, v249, v249
    ds_write_b128 v194, v[160:163]
    ds_write_b128 v194, v[164:167] offset:1024
    ds_read_b128 v[176:179], v192
    ds_read_b128 v[180:183], v193
    ds_read_b128 v[40:43], v197 offset:40960
    ds_read_b128 v[44:47], v197 offset:41472
    ds_read_b128 v[48:51], v197 offset:41984
    ds_read_b128 v[52:55], v197 offset:42496
    s_waitcnt lgkmcnt(14)
    s_waitcnt lgkmcnt(8)
    v_mfma_f32_16x16x32_bf16 v[208:211], v[56:59], v[188:191], v[208:211]
    v_mul_f32 v103, v249, v249
    v_mul_f32 v249, v248, v249
    v_mfma_f32_16x16x32_bf16 v[212:215], v[60:63], v[188:191], v[212:215]
    v_fma_f32 v248, v248, v248, -v103
    v_add_f32 v249, v249, v249
    v_mfma_f32_16x16x32_bf16 v[216:219], v[64:67], v[188:191], v[216:219]
    v_xor_b32 v249, v107, v249
    v_mfma_f32_16x16x32_bf16 v[220:223], v[68:71], v[188:191], v[220:223]
    v_mfma_f32_16x16x32_bf16 v[240:243], v[236:239], v[188:191], v[240:243]
    v_mfma_f32_16x16x32_bf16 v[224:227], v[72:75], v[76:79], v[224:227]
    v_mfma_f32_16x16x32_bf16 v[228:231], v[236:239], v[76:79], v[228:231]
    ds_read_b128 v[56:59], v198 offset:24576
    ds_read_b128 v[60:63], v198 offset:25088
    ds_read_b128 v[64:67], v198 offset:25600
    ds_read_b128 v[68:71], v198 offset:26112
    ds_read_b128 v[72:75], v200 offset:40960
    ds_read_b128 v[76:79], v204 offset:12288
    s_waitcnt lgkmcnt(10)
    v_mfma_f32_16x16x32_bf16 v[208:211], v[24:27], v[176:179], v[208:211]
    v_mfma_f32_16x16x32_bf16 v[212:215], v[28:31], v[176:179], v[212:215]
    v_mfma_f32_16x16x32_bf16 v[216:219], v[32:35], v[176:179], v[216:219]
    v_mfma_f32_16x16x32_bf16 v[220:223], v[36:39], v[176:179], v[220:223]
    v_mfma_f32_16x16x32_bf16 v[240:243], v[236:239], v[176:179], v[240:243]
    s_waitcnt vmcnt(13)
    ds_write_b128 v194, v[168:171]
    ds_write_b128 v194, v[172:175] offset:1024
    ds_read_b128 v[184:187], v192
    ds_read_b128 v[188:191], v193
    ds_read_b128 v[24:27], v199 offset:24576
    ds_read_b128 v[28:31], v199 offset:25088
    ds_read_b128 v[32:35], v199 offset:25600
    ds_read_b128 v[36:39], v199 offset:26112
    s_waitcnt lgkmcnt(14)
    s_waitcnt lgkmcnt(8)
    v_mfma_f32_16x16x32_bf16 v[208:211], v[40:43], v[180:183], v[208:211]
    v_mfma_f32_16x16x32_bf16 v[212:215], v[44:47], v[180:183], v[212:215]
    v_mfma_f32_16x16x32_bf16 v[216:219], v[48:51], v[180:183], v[216:219]
    v_mfma_f32_16x16x32_bf16 v[220:223], v[52:55], v[180:183], v[220:223]
    v_mfma_f32_16x16x32_bf16 v[240:243], v[236:239], v[180:183], v[240:243]
    v_mfma_f32_16x16x32_bf16 v[224:227], v[72:75], v[76:79], v[224:227]
    v_mfma_f32_16x16x32_bf16 v[228:231], v[236:239], v[76:79], v[228:231]
    s_waitcnt vmcnt(11)
    s_barrier
    ds_read_b128 v[40:43], v196 offset:49152
    ds_read_b128 v[44:47], v196 offset:49664
    ds_read_b128 v[48:51], v196 offset:50176
    ds_read_b128 v[52:55], v196 offset:50688
    ds_read_b128 v[72:75], v201 offset:24576
    ds_read_b128 v[76:79], v204 offset:14336
    s_waitcnt lgkmcnt(10)
    v_mfma_f32_16x16x32_bf16 v[208:211], v[56:59], v[184:187], v[208:211]
    v_mfma_f32_16x16x32_bf16 v[212:215], v[60:63], v[184:187], v[212:215]
    s_add_u32 s12, s32, 2359296
    s_add_u32 m0, s81, 32768
    s_nop 0
    buffer_load_dwordx4 v0, s[24:27], s12 offen lds
    v_mfma_f32_16x16x32_bf16 v[216:219], v[64:67], v[184:187], v[216:219]
    v_mfma_f32_16x16x32_bf16 v[220:223], v[68:71], v[184:187], v[220:223]
    s_add_u32 s12, s32, 2359296
    s_add_u32 m0, s81, 106528
    s_nop 0
    buffer_load_dwordx4 v0, s[36:39], s12 offen lds
    v_mfma_f32_16x16x32_bf16 v[240:243], v[236:239], v[184:187], v[240:243]
    s_waitcnt vmcnt(11)
    ds_write_b128 v194, v[88:91]
    ds_write_b128 v194, v[92:95] offset:1024
    ds_read_b128 v[176:179], v192
    ds_read_b128 v[180:183], v193
    ds_read_b128 v[56:59], v197 offset:49152
    ds_read_b128 v[60:63], v197 offset:49664
    ds_read_b128 v[64:67], v197 offset:50176
    ds_read_b128 v[68:71], v197 offset:50688
    s_waitcnt lgkmcnt(14)
    s_waitcnt lgkmcnt(8)
    v_mfma_f32_16x16x32_bf16 v[208:211], v[24:27], v[188:191], v[208:211]
    v_mfma_f32_16x16x32_bf16 v[212:215], v[28:31], v[188:191], v[212:215]
    v_mfma_f32_16x16x32_bf16 v[216:219], v[32:35], v[188:191], v[216:219]
    v_mfma_f32_16x16x32_bf16 v[220:223], v[36:39], v[188:191], v[220:223]
    v_mfma_f32_16x16x32_bf16 v[240:243], v[236:239], v[188:191], v[240:243]
    v_mfma_f32_16x16x32_bf16 v[224:227], v[72:75], v[76:79], v[224:227]
    v_mfma_f32_16x16x32_bf16 v[228:231], v[236:239], v[76:79], v[228:231]
    ds_read_b128 v[72:75], v200 offset:49152
    ds_read_b128 v[76:79], v204 offset:16384
    s_waitcnt lgkmcnt(6)
    v_mfma_f32_16x16x32_bf16 v[208:211], v[40:43], v[176:179], v[208:211]
    v_mfma_f32_16x16x32_bf16 v[212:215], v[44:47], v[176:179], v[212:215]
    buffer_load_dword v16, v17, s[48:51], s33 offen sc1
    v_mfma_f32_16x16x32_bf16 v[216:219], v[48:51], v[176:179], v[216:219]
    v_mfma_f32_16x16x32_bf16 v[220:223], v[52:55], v[176:179], v[220:223]
    v_mfma_f32_16x16x32_bf16 v[240:243], v[236:239], v[176:179], v[240:243]
    s_waitcnt lgkmcnt(2)
    s_waitcnt lgkmcnt(0)
    v_mfma_f32_16x16x32_bf16 v[208:211], v[56:59], v[180:183], v[208:211]
    v_mfma_f32_16x16x32_bf16 v[212:215], v[60:63], v[180:183], v[212:215]
    v_mfma_f32_16x16x32_bf16 v[216:219], v[64:67], v[180:183], v[216:219]
    v_mfma_f32_16x16x32_bf16 v[220:223], v[68:71], v[180:183], v[220:223]
    v_mfma_f32_16x16x32_bf16 v[240:243], v[236:239], v[180:183], v[240:243]
    v_mfma_f32_16x16x32_bf16 v[224:227], v[72:75], v[76:79], v[224:227]
    v_mfma_f32_16x16x32_bf16 v[228:231], v[236:239], v[76:79], v[228:231]
    s_waitcnt vmcnt(0)
    v_cmp_ne_u32 vcc, s15, v16
    s_cbranch_vccnz SLOW_6
BACK_7:
    v_lshlrev_b32 v22, 3, v1
    s_lshl_b32 s12, s5, 9
    s_add_u32 s12, s12, 63963136
    buffer_load_dwordx2 v[18:19], v22, s[48:51], s12 offen sc1
    s_nop 3
    s_add_u32 s14, s81, 147584
    v_add_u32 v14, s14, v3
    s_lshl_b32 s14, s7, 8
    s_add_u32 s14, s14, 155776
    v_lshl_add_u32 v2, v1, 2, s14
    ds_write_b128 v14, v[224:227]
    ds_write_b32 v2, v228
    s_waitcnt lgkmcnt(0)
    s_barrier
    buffer_load_dwordx4 v[112:115], v3, s[48:51], s40 offen offset:0 sc1
    buffer_load_dwordx4 v[116:119], v3, s[48:51], s40 offen offset:1024 sc1
    v_bfe_u32 v13, v1, 4, 1
    v_lshrrev_b32 v14, 5, v1
    v_and_b32 v2, 15, v1
    v_lshlrev_b32 v2, 3, v2
    v_mul_u32_u24 v5, 73760, v13
    v_lshl_add_u32 v5, v14, 10, v5
    v_add_u32 v5, v5, v2
    v_and_b32 v6, 12, v1
    v_lshl_add_u32 v5, v6, 3, v5
    v_add_u32 v6, 36864, v5
    v_mul_u32_u24 v7, 18560, v13
    v_lshl_add_u32 v7, v14, 8, v7
    v_add_u32 v7, v7, v2
    ds_read_b64_tr_b16 v[24:25], v5 offset:0
    ds_read_b64_tr_b16 v[26:27], v5 offset:256
    ds_read_b64_tr_b16 v[28:29], v5 offset:32
    ds_read_b64_tr_b16 v[30:31], v5 offset:288
    ds_read_b64_tr_b16 v[32:33], v5 offset:512
    ds_read_b64_tr_b16 v[34:35], v5 offset:768
    ds_read_b64_tr_b16 v[36:37], v5 offset:544
    ds_read_b64_tr_b16 v[38:39], v5 offset:800
    ds_read_b64_tr_b16 v[40:41], v5 offset:2048
    ds_read_b64_tr_b16 v[42:43], v5 offset:2304
    s_waitcnt vmcnt(1)
    s_waitcnt lgkmcnt(8)
    v_mfma_f32_32x32x16_bf16 v[48:63], v[24:27], v[112:115], 0
    v_mul_f32 v18, -v18, v19
    s_lshl_b32 s44, s7, 9
    s_add_u32 s44, s44, 69632
    v_lshl_add_u32 v241, v1, 3, s44
    v_lshrrev_b32 v242, 4, v1
    ds_read_b64_tr_b16 v[44:45], v5 offset:2080
    ds_read_b64_tr_b16 v[46:47], v5 offset:2336
    s_waitcnt lgkmcnt(8)
    v_mfma_f32_32x32x16_bf16 v[64:79], v[28:31], v[112:115], 0
    buffer_load_dwordx4 v[120:123], v3, s[48:51], s40 offen offset:2048 sc1
    v_lshl_add_u32 v243, v242, 7, s44
    ds_write_b64 v241, v[18:19]
    ds_read_b128 v[224:227], v243 offset:0
    ds_read_b128 v[228:231], v243 offset:16
    ds_read_b128 v[232:235], v243 offset:32
    ds_read_b64_tr_b16 v[24:25], v5 offset:2560
    ds_read_b64_tr_b16 v[26:27], v5 offset:2816
    s_waitcnt lgkmcnt(12)
    v_mfma_f32_32x32x16_bf16 v[80:95], v[32:35], v[112:115], 0
    ds_read_b128 v[236:239], v243 offset:48
    v_and_b32 v8, 15, v1
    v_lshlrev_b32 v8, 2, v8
    v_add_u32 v9, 64, v8
    v_add_u32 v10, 128, v8
    ds_read_b64_tr_b16 v[28:29], v5 offset:2592
    ds_read_b64_tr_b16 v[30:31], v5 offset:2848
    s_waitcnt lgkmcnt(13)
    v_mfma_f32_32x32x16_bf16 v[96:111], v[36:39], v[112:115], 0
    buffer_load_dwordx4 v[124:127], v3, s[48:51], s40 offen offset:3072 sc1
    v_add_u32 v12, 192, v8
    s_mul_i32 s83, s11, 9
    s_add_u32 s83, s83, s7
    s_waitcnt lgkmcnt(2)
    v_mul_f32 v208, v225, v208
    v_mul_f32 v209, v227, v209
    ds_read_b64_tr_b16 v[32:33], v5 offset:4096
    ds_read_b64_tr_b16 v[34:35], v5 offset:4352
    s_waitcnt vmcnt(2)
    v_mfma_f32_32x32x16_bf16 v[48:63], v[40:43], v[116:119], v[48:63]
    v_mul_f32 v210, v229, v210
    v_mul_f32 v211, v231, v211
    v_mul_f32 v212, v233, v212
    v_mul_f32 v213, v235, v213
    v_mul_f32 v214, v237, v214
    ds_read_b64_tr_b16 v[36:37], v5 offset:4128
    ds_read_b64_tr_b16 v[38:39], v5 offset:4384
    v_mfma_f32_32x32x16_bf16 v[64:79], v[44:47], v[116:119], v[64:79]
    s_add_u32 s12, s40, 4096
    buffer_load_dwordx4 v[128:131], v3, s[48:51], s12 offen sc1
    v_mul_f32 v215, v239, v215
    v_fmac_f32 v208, v224, v240
    v_fmac_f32 v209, v226, v240
    v_fmac_f32 v210, v228, v240
    v_fmac_f32 v211, v230, v240
    ds_read_b64_tr_b16 v[40:41], v5 offset:4608
    ds_read_b64_tr_b16 v[42:43], v5 offset:4864
    v_mfma_f32_32x32x16_bf16 v[80:95], v[24:27], v[116:119], v[80:95]
    v_fmac_f32 v212, v232, v240
    v_fmac_f32 v213, v234, v240
    v_fmac_f32 v214, v236, v240
    v_fmac_f32 v215, v238, v240
    ds_read_b128 v[224:227], v243 offset:64
    ds_read_b64_tr_b16 v[44:45], v5 offset:4640
    ds_read_b64_tr_b16 v[46:47], v5 offset:4896
    s_waitcnt lgkmcnt(9)
    v_mfma_f32_32x32x16_bf16 v[96:111], v[28:31], v[116:119], v[96:111]
    s_add_u32 s12, s40, 5120
    buffer_load_dwordx4 v[132:135], v3, s[48:51], s12 offen sc1
    ds_read_b128 v[228:231], v243 offset:80
    ds_read_b128 v[232:235], v243 offset:96
    ds_read_b128 v[236:239], v243 offset:112
    s_waitcnt lgkmcnt(0)
    v_mul_f32 v216, v225, v216
    v_mul_f32 v217, v227, v217
    ds_read_b64_tr_b16 v[24:25], v5 offset:6144
    ds_read_b64_tr_b16 v[26:27], v5 offset:6400
    s_waitcnt vmcnt(3)
    v_mfma_f32_32x32x16_bf16 v[48:63], v[32:35], v[120:123], v[48:63]
    v_mul_f32 v218, v229, v218
    v_mul_f32 v219, v231, v219
    v_mul_f32 v220, v233, v220
    v_mul_f32 v221, v235, v221
    v_mul_f32 v222, v237, v222
    ds_read_b64_tr_b16 v[28:29], v5 offset:6176
    ds_read_b64_tr_b16 v[30:31], v5 offset:6432
    v_mfma_f32_32x32x16_bf16 v[64:79], v[36:39], v[120:123], v[64:79]
    s_add_u32 s12, s40, 6144
    buffer_load_dwordx4 v[136:139], v3, s[48:51], s12 offen sc1
    v_mul_f32 v223, v239, v223
    v_fmac_f32 v216, v224, v240
    v_fmac_f32 v217, v226, v240
    v_fmac_f32 v218, v228, v240
    v_fmac_f32 v219, v230, v240
    ds_read_b64_tr_b16 v[32:33], v5 offset:6656
    ds_read_b64_tr_b16 v[34:35], v5 offset:6912
    v_mfma_f32_32x32x16_bf16 v[80:95], v[40:43], v[120:123], v[80:95]
    v_fmac_f32 v220, v232, v240
    v_fmac_f32 v221, v234, v240
    v_fmac_f32 v222, v236, v240
    v_fmac_f32 v223, v238, v240
    v_mul_f32 v22, v246, v208
    ds_read_b64_tr_b16 v[36:37], v5 offset:6688
    ds_read_b64_tr_b16 v[38:39], v5 offset:6944
    v_mfma_f32_32x32x16_bf16 v[96:111], v[44:47], v[120:123], v[96:111]
    s_add_u32 s12, s40, 7168
    buffer_load_dwordx4 v[140:143], v3, s[48:51], s12 offen sc1
    v_fmac_f32_dpp v22, v208, v247 row_ror:8 row_mask:0xf bank_mask:0xf
    v_mul_f32 v23, v246, v209
    v_fmac_f32_dpp v23, v209, v247 row_ror:8 row_mask:0xf bank_mask:0xf
    v_mov_b32 v208, v22
    v_fma_f32 v209, v244, v208, v23
    ds_read_b64_tr_b16 v[40:41], v5 offset:8192
    ds_read_b64_tr_b16 v[42:43], v5 offset:8448
    s_waitcnt vmcnt(4)
    s_waitcnt lgkmcnt(8)
    v_mfma_f32_32x32x16_bf16 v[48:63], v[24:27], v[124:127], v[48:63]
    v_mul_f32 v22, v246, v210
    v_fmac_f32_dpp v209, v208, v245 row_ror:8 row_mask:0xf bank_mask:0xf
    v_fmac_f32_dpp v22, v210, v247 row_ror:8 row_mask:0xf bank_mask:0xf
    v_fma_f32 v210, v244, v209, v22
    v_mul_f32 v23, v246, v211
    ds_read_b64_tr_b16 v[44:45], v5 offset:8224
    ds_read_b64_tr_b16 v[46:47], v5 offset:8480
    s_waitcnt lgkmcnt(8)
    v_mfma_f32_32x32x16_bf16 v[64:79], v[28:31], v[124:127], v[64:79]
    s_add_u32 s12, s40, 8192
    buffer_load_dwordx4 v[144:147], v3, s[48:51], s12 offen sc1
    v_fmac_f32_dpp v210, v209, v245 row_ror:8 row_mask:0xf bank_mask:0xf
    v_fmac_f32_dpp v23, v211, v247 row_ror:8 row_mask:0xf bank_mask:0xf
    v_fma_f32 v211, v244, v210, v23
    v_mul_f32 v22, v246, v212
    v_fmac_f32_dpp v211, v210, v245 row_ror:8 row_mask:0xf bank_mask:0xf
    ds_read_b64_tr_b16 v[24:25], v5 offset:8704
    ds_read_b64_tr_b16 v[26:27], v5 offset:8960
    s_waitcnt lgkmcnt(8)
    v_mfma_f32_32x32x16_bf16 v[80:95], v[32:35], v[124:127], v[80:95]
    v_fmac_f32_dpp v22, v212, v247 row_ror:8 row_mask:0xf bank_mask:0xf
    v_fma_f32 v212, v244, v211, v22
    v_mul_f32 v23, v246, v213
    v_fmac_f32_dpp v212, v211, v245 row_ror:8 row_mask:0xf bank_mask:0xf
    v_fmac_f32_dpp v23, v213, v247 row_ror:8 row_mask:0xf bank_mask:0xf
    ds_read_b64_tr_b16 v[28:29], v5 offset:8736
    ds_read_b64_tr_b16 v[30:31], v5 offset:8992
    s_waitcnt lgkmcnt(8)
    v_mfma_f32_32x32x16_bf16 v[96:111], v[36:39], v[124:127], v[96:111]
    s_add_u32 s12, s40, 9216
    buffer_load_dwordx4 v[148:151], v3, s[48:51], s12 offen sc1
    v_fma_f32 v213, v244, v212, v23
    v_mul_f32 v22, v246, v214
    v_fmac_f32_dpp v213, v212, v245 row_ror:8 row_mask:0xf bank_mask:0xf
    v_fmac_f32_dpp v22, v214, v247 row_ror:8 row_mask:0xf bank_mask:0xf
    v_fma_f32 v214, v244, v213, v22
    ds_read_b64_tr_b16 v[32:33], v5 offset:10240
    ds_read_b64_tr_b16 v[34:35], v5 offset:10496
    s_waitcnt vmcnt(5)
    s_waitcnt lgkmcnt(8)
    v_mfma_f32_32x32x16_bf16 v[48:63], v[40:43], v[128:131], v[48:63]
    v_mul_f32 v23, v246, v215
    v_fmac_f32_dpp v214, v213, v245 row_ror:8 row_mask:0xf bank_mask:0xf
    v_fmac_f32_dpp v23, v215, v247 row_ror:8 row_mask:0xf bank_mask:0xf
    v_fma_f32 v215, v244, v214, v23
    v_mul_f32 v22, v246, v216
    ds_read_b64_tr_b16 v[36:37], v5 offset:10272
    ds_read_b64_tr_b16 v[38:39], v5 offset:10528
    s_waitcnt lgkmcnt(8)
    v_mfma_f32_32x32x16_bf16 v[64:79], v[44:47], v[128:131], v[64:79]
    s_add_u32 s12, s40, 10240
    buffer_load_dwordx4 v[152:155], v3, s[48:51], s12 offen sc1
    v_fmac_f32_dpp v215, v214, v245 row_ror:8 row_mask:0xf bank_mask:0xf
    v_fmac_f32_dpp v22, v216, v247 row_ror:8 row_mask:0xf bank_mask:0xf
    v_fma_f32 v216, v244, v215, v22
    v_mul_f32 v23, v246, v217
    v_fmac_f32_dpp v216, v215, v245 row_ror:8 row_mask:0xf bank_mask:0xf
    ds_read_b64_tr_b16 v[40:41], v5 offset:10752
    ds_read_b64_tr_b16 v[42:43], v5 offset:11008
    s_waitcnt lgkmcnt(8)
    v_mfma_f32_32x32x16_bf16 v[80:95], v[24:27], v[128:131], v[80:95]
    v_fmac_f32_dpp v23, v217, v247 row_ror:8 row_mask:0xf bank_mask:0xf
    v_fma_f32 v217, v244, v216, v23
    v_mul_f32 v22, v246, v218
    v_fmac_f32_dpp v217, v216, v245 row_ror:8 row_mask:0xf bank_mask:0xf
    v_fmac_f32_dpp v22, v218, v247 row_ror:8 row_mask:0xf bank_mask:0xf
    ds_read_b64_tr_b16 v[44:45], v5 offset:10784
    ds_read_b64_tr_b16 v[46:47], v5 offset:11040
    s_waitcnt lgkmcnt(8)
    v_mfma_f32_32x32x16_bf16 v[96:111], v[28:31], v[128:131], v[96:111]
    s_add_u32 s12, s40, 11264
    buffer_load_dwordx4 v[156:159], v3, s[48:51], s12 offen sc1
    v_fma_f32 v218, v244, v217, v22
    v_mul_f32 v23, v246, v219
    v_fmac_f32_dpp v218, v217, v245 row_ror:8 row_mask:0xf bank_mask:0xf
    v_fmac_f32_dpp v23, v219, v247 row_ror:8 row_mask:0xf bank_mask:0xf
    v_fma_f32 v219, v244, v218, v23
    ds_read_b64_tr_b16 v[24:25], v5 offset:12288
    ds_read_b64_tr_b16 v[26:27], v5 offset:12544
    s_waitcnt vmcnt(6)
    s_waitcnt lgkmcnt(8)
    v_mfma_f32_32x32x16_bf16 v[48:63], v[32:35], v[132:135], v[48:63]
    v_mul_f32 v22, v246, v220
    v_fmac_f32_dpp v219, v218, v245 row_ror:8 row_mask:0xf bank_mask:0xf
    v_fmac_f32_dpp v22, v220, v247 row_ror:8 row_mask:0xf bank_mask:0xf
    v_fma_f32 v220, v244, v219, v22
    v_mul_f32 v23, v246, v221
    ds_read_b64_tr_b16 v[28:29], v5 offset:12320
    ds_read_b64_tr_b16 v[30:31], v5 offset:12576
    s_waitcnt lgkmcnt(8)
    v_mfma_f32_32x32x16_bf16 v[64:79], v[36:39], v[132:135], v[64:79]
    s_add_u32 s12, s40, 12288
    buffer_load_dwordx4 v[160:163], v3, s[48:51], s12 offen sc1
    v_fmac_f32_dpp v220, v219, v245 row_ror:8 row_mask:0xf bank_mask:0xf
    v_fmac_f32_dpp v23, v221, v247 row_ror:8 row_mask:0xf bank_mask:0xf
    v_fma_f32 v221, v244, v220, v23
    v_mul_f32 v22, v246, v222
    v_fmac_f32_dpp v221, v220, v245 row_ror:8 row_mask:0xf bank_mask:0xf
    ds_read_b64_tr_b16 v[32:33], v5 offset:12800
    ds_read_b64_tr_b16 v[34:35], v5 offset:13056
    s_waitcnt lgkmcnt(8)
    v_mfma_f32_32x32x16_bf16 v[80:95], v[40:43], v[132:135], v[80:95]
    v_fmac_f32_dpp v22, v222, v247 row_ror:8 row_mask:0xf bank_mask:0xf
    v_fma_f32 v222, v244, v221, v22
    v_mul_f32 v23, v246, v223
    v_fmac_f32_dpp v222, v221, v245 row_ror:8 row_mask:0xf bank_mask:0xf
    v_fmac_f32_dpp v23, v223, v247 row_ror:8 row_mask:0xf bank_mask:0xf
    ds_read_b64_tr_b16 v[36:37], v5 offset:12832
    ds_read_b64_tr_b16 v[38:39], v5 offset:13088
    s_waitcnt lgkmcnt(8)
    v_mfma_f32_32x32x16_bf16 v[96:111], v[44:47], v[132:135], v[96:111]
    s_add_u32 s12, s40, 13312
    buffer_load_dwordx4 v[164:167], v3, s[48:51], s12 offen sc1
    v_fma_f32 v223, v244, v222, v23
    s_nop 0
    v_fmac_f32_dpp v223, v222, v245 row_ror:8 row_mask:0xf bank_mask:0xf
    ds_bpermute_b32 v16, v8, v223
    ds_bpermute_b32 v17, v9, v223
    ds_read_b64_tr_b16 v[40:41], v5 offset:14336
    ds_read_b64_tr_b16 v[42:43], v5 offset:14592
    s_waitcnt vmcnt(7)
    s_waitcnt lgkmcnt(10)
    v_mfma_f32_32x32x16_bf16 v[48:63], v[24:27], v[136:139], v[48:63]
    ds_bpermute_b32 v18, v10, v223
    ds_bpermute_b32 v19, v12, v223
    s_mul_i32 s45, s83, 4352
    s_add_u32 s45, s45, 25165824
    buffer_store_dwordx4 v[208:211], v3, s[48:51], s45 offen offset:0
    ds_read_b64_tr_b16 v[44:45], v5 offset:14368
    ds_read_b64_tr_b16 v[46:47], v5 offset:14624
    s_waitcnt lgkmcnt(12)
    v_mfma_f32_32x32x16_bf16 v[64:79], v[28:31], v[136:139], v[64:79]
    s_add_u32 s12, s40, 14336
    buffer_load_dwordx4 v[168:171], v3, s[48:51], s12 offen sc1
    buffer_store_dwordx4 v[212:215], v3, s[48:51], s45 offen offset:1024
    buffer_store_dwordx4 v[216:219], v3, s[48:51], s45 offen offset:2048
    buffer_store_dwordx4 v[220:223], v3, s[48:51], s45 offen offset:3072
    ds_read_b64_tr_b16 v[24:25], v5 offset:14848
    ds_read_b64_tr_b16 v[26:27], v5 offset:15104
    s_waitcnt lgkmcnt(12)
    v_mfma_f32_32x32x16_bf16 v[80:95], v[32:35], v[136:139], v[80:95]
    s_waitcnt lgkmcnt(4)
    v_fma_f32 v20, v248, v16, v17
    s_nop 0
    v_fmac_f32_dpp v20, v16, v249 row_ror:8 row_mask:0xf bank_mask:0xf
    v_fma_f32 v21, v248, v20, v18
    s_nop 0
    ds_read_b64_tr_b16 v[28:29], v5 offset:14880
    ds_read_b64_tr_b16 v[30:31], v5 offset:15136
    v_mfma_f32_32x32x16_bf16 v[96:111], v[36:39], v[136:139], v[96:111]
    s_add_u32 s12, s40, 15360
    buffer_load_dwordx4 v[172:175], v3, s[48:51], s12 offen sc1
    v_fmac_f32_dpp v21, v20, v249 row_ror:8 row_mask:0xf bank_mask:0xf
    v_fma_f32 v15, v248, v21, v19
    s_nop 0
    v_fmac_f32_dpp v15, v21, v249 row_ror:8 row_mask:0xf bank_mask:0xf
    v_mov_b32 v241, 0
    s_barrier
    ds_read_b64_tr_b16 v[32:33], v5 offset:16384
    ds_read_b64_tr_b16 v[34:35], v5 offset:16640
    s_waitcnt vmcnt(12)
    v_mfma_f32_32x32x16_bf16 v[48:63], v[40:43], v[140:143], v[48:63]
    v_cmp_eq_u32 vcc, 1, v242
    s_nop 1
    v_cndmask_b32 v241, v241, v16, vcc
    v_cmp_eq_u32 vcc, 2, v242
    s_nop 1
    v_cndmask_b32 v241, v241, v20, vcc
    ds_read_b64_tr_b16 v[36:37], v5 offset:16416
    ds_read_b64_tr_b16 v[38:39], v5 offset:16672
    s_waitcnt lgkmcnt(8)
    v_mfma_f32_32x32x16_bf16 v[64:79], v[44:47], v[140:143], v[64:79]
    s_add_u32 s12, s32, 2949120
    s_add_u32 m0, s81, 40960
    s_nop 0
    buffer_load_dwordx4 v0, s[24:27], s12 offen lds
    v_cmp_eq_u32 vcc, 3, v242
    s_nop 1
    v_cndmask_b32 v241, v241, v21, vcc
    v_lshlrev_b32 v16, 2, v1
    s_add_u32 s12, s45, 4096
    buffer_store_dword v241, v16, s[48:51], s12 offen
    ds_read_b64_tr_b16 v[40:41], v5 offset:16896
    ds_read_b64_tr_b16 v[42:43], v5 offset:17152
    s_waitcnt lgkmcnt(8)
    v_mfma_f32_32x32x16_bf16 v[80:95], v[24:27], v[140:143], v[80:95]
    s_cmp_lg_u32 s7, 7
    s_cbranch_scc1 UNIT_DONE
    s_add_u32 s83, s83, 1
    v_add_u32 v241, 147584, v3
    v_lshlrev_b32 v16, 2, v1
    v_add_u32 v16, 155776, v16
    ds_read_b128 v[208:211], v241 offset:0
    ds_read_b128 v[224:227], v241 offset:4096
    ds_read_b128 v[212:215], v241 offset:1024
    ds_read_b128 v[228:231], v241 offset:5120
    ds_read_b128 v[216:219], v241 offset:2048
    ds_read_b128 v[232:235], v241 offset:6144
    ds_read_b128 v[220:223], v241 offset:3072
    ds_read_b128 v[236:239], v241 offset:7168
    ds_read_b32 v240, v16
    ds_read_b32 v241, v16 offset:1024
    v_lshlrev_b32 v253, 16, v253
    v_lshlrev_b32 v254, 16, v254
    v_lshlrev_b32 v255, 16, v255
    v_mul_f32 v19, 0x3fb8aa3b, v255
    v_exp_f32 v19, v19
    s_nop 0
    v_cvt_pk_bf16_f32 v19, v19, v19
    v_lshlrev_b32 v19, 16, v19
    v_mul_f32 v20, v19, v253
    v_mul_f32 v21, v19, v254
    v_mul_f32 v20, 0x3fb8aa3b, v20
    v_exp_f32 v20, v20
    v_mul_f32 v21, 0x3e22f983, v21
    v_rndne_f32 v22, v21
    v_sub_f32 v21, v21, v22
    v_cos_f32 v22, v21
    v_sin_f32 v21, v21
    s_nop 0
    v_mul_f32 v244, v20, v22
    v_mul_f32 v16, v20, v21
    v_add_f32 v19, -1.0, v244
    v_mul_f32 v20, v253, v253
    v_fmac_f32 v20, v254, v254
    v_rcp_f32 v20, v20
    v_mul_f32 v17, v19, v253
    v_fmac_f32 v17, v16, v254
    v_mul_f32 v18, v16, v253
    v_fma_f32 v18, -v19, v254, v18
    v_mul_f32 v17, v17, v20
    v_mul_f32 v18, v18, v20
    v_and_b32 v23, 8, v1
    v_lshlrev_b32 v23, 28, v23
    v_xor_b32 v245, v23, v16
    v_add_f32 v246, v17, v17
    v_xor_b32 v246, v23, v246
    v_mul_f32 v247, -2.0, v18
    v_mul_f32 v19, v16, v16
    v_mul_f32 v249, v244, v16
    v_fma_f32 v248, v244, v244, -v19
    v_add_f32 v249, v249, v249
    v_mul_f32 v19, v249, v249
    v_mul_f32 v249, v248, v249
    v_fma_f32 v248, v248, v248, -v19
    v_add_f32 v249, v249, v249
    v_mul_f32 v19, v249, v249
    v_mul_f32 v249, v248, v249
    v_fma_f32 v248, v248, v248, -v19
    v_add_f32 v249, v249, v249
    v_mul_f32 v19, v249, v249
    v_mul_f32 v249, v248, v249
    v_fma_f32 v248, v248, v248, -v19
    v_add_f32 v249, v249, v249
    v_xor_b32 v249, v23, v249
    s_waitcnt lgkmcnt(0)
    v_add_f32 v208, v208, v224
    v_add_f32 v209, v209, v225
    v_add_f32 v210, v210, v226
    v_add_f32 v211, v211, v227
    v_add_f32 v212, v212, v228
    v_add_f32 v213, v213, v229
    v_add_f32 v214, v214, v230
    v_add_f32 v215, v215, v231
    v_add_f32 v216, v216, v232
    v_add_f32 v217, v217, v233
    v_add_f32 v218, v218, v234
    v_add_f32 v219, v219, v235
    v_add_f32 v220, v220, v236
    v_add_f32 v221, v221, v237
    v_add_f32 v222, v222, v238
    v_add_f32 v223, v223, v239
    v_add_f32 v240, v240, v241
    ds_read_b128 v[224:227], v243 offset:0
    ds_read_b128 v[228:231], v243 offset:16
    ds_read_b128 v[232:235], v243 offset:32
    ds_read_b128 v[236:239], v243 offset:48
    s_waitcnt lgkmcnt(0)
    v_mul_f32 v208, v225, v208
    v_mul_f32 v209, v227, v209
    v_mul_f32 v210, v229, v210
    v_mul_f32 v211, v231, v211
    v_mul_f32 v212, v233, v212
    v_mul_f32 v213, v235, v213
    v_mul_f32 v214, v237, v214
    v_mul_f32 v215, v239, v215
    v_fmac_f32 v208, v224, v240
    v_fmac_f32 v209, v226, v240
    v_fmac_f32 v210, v228, v240
    v_fmac_f32 v211, v230, v240
    v_fmac_f32 v212, v232, v240
    v_fmac_f32 v213, v234, v240
    v_fmac_f32 v214, v236, v240
    v_fmac_f32 v215, v238, v240
    ds_read_b128 v[224:227], v243 offset:64
    ds_read_b128 v[228:231], v243 offset:80
    ds_read_b128 v[232:235], v243 offset:96
    ds_read_b128 v[236:239], v243 offset:112
    s_waitcnt lgkmcnt(0)
    v_mul_f32 v216, v225, v216
    v_mul_f32 v217, v227, v217
    v_mul_f32 v218, v229, v218
    v_mul_f32 v219, v231, v219
    v_mul_f32 v220, v233, v220
    v_mul_f32 v221, v235, v221
    v_mul_f32 v222, v237, v222
    v_mul_f32 v223, v239, v223
    v_fmac_f32 v216, v224, v240
    v_fmac_f32 v217, v226, v240
    v_fmac_f32 v218, v228, v240
    v_fmac_f32 v219, v230, v240
    v_fmac_f32 v220, v232, v240
    v_fmac_f32 v221, v234, v240
    v_fmac_f32 v222, v236, v240
    v_fmac_f32 v223, v238, v240
    v_mul_f32 v22, v246, v208
    v_fmac_f32_dpp v22, v208, v247 row_ror:8 row_mask:0xf bank_mask:0xf
    v_mul_f32 v23, v246, v209
    v_fmac_f32_dpp v23, v209, v247 row_ror:8 row_mask:0xf bank_mask:0xf
    v_mov_b32 v208, v22
    v_fma_f32 v209, v244, v208, v23
    v_mul_f32 v22, v246, v210
    v_fmac_f32_dpp v209, v208, v245 row_ror:8 row_mask:0xf bank_mask:0xf
    v_fmac_f32_dpp v22, v210, v247 row_ror:8 row_mask:0xf bank_mask:0xf
    v_fma_f32 v210, v244, v209, v22
    v_mul_f32 v23, v246, v211
    v_fmac_f32_dpp v210, v209, v245 row_ror:8 row_mask:0xf bank_mask:0xf
    v_fmac_f32_dpp v23, v211, v247 row_ror:8 row_mask:0xf bank_mask:0xf
    v_fma_f32 v211, v244, v210, v23
    v_mul_f32 v22, v246, v212
    v_fmac_f32_dpp v211, v210, v245 row_ror:8 row_mask:0xf bank_mask:0xf
    v_fmac_f32_dpp v22, v212, v247 row_ror:8 row_mask:0xf bank_mask:0xf
    v_fma_f32 v212, v244, v211, v22
    v_mul_f32 v23, v246, v213
    v_fmac_f32_dpp v212, v211, v245 row_ror:8 row_mask:0xf bank_mask:0xf
    v_fmac_f32_dpp v23, v213, v247 row_ror:8 row_mask:0xf bank_mask:0xf
    v_fma_f32 v213, v244, v212, v23
    v_mul_f32 v22, v246, v214
    v_fmac_f32_dpp v213, v212, v245 row_ror:8 row_mask:0xf bank_mask:0xf
    v_fmac_f32_dpp v22, v214, v247 row_ror:8 row_mask:0xf bank_mask:0xf
    v_fma_f32 v214, v244, v213, v22
    v_mul_f32 v23, v246, v215
    v_fmac_f32_dpp v214, v213, v245 row_ror:8 row_mask:0xf bank_mask:0xf
    v_fmac_f32_dpp v23, v215, v247 row_ror:8 row_mask:0xf bank_mask:0xf
    v_fma_f32 v215, v244, v214, v23
    v_mul_f32 v22, v246, v216
    v_fmac_f32_dpp v215, v214, v245 row_ror:8 row_mask:0xf bank_mask:0xf
    v_fmac_f32_dpp v22, v216, v247 row_ror:8 row_mask:0xf bank_mask:0xf
    v_fma_f32 v216, v244, v215, v22
    v_mul_f32 v23, v246, v217
    v_fmac_f32_dpp v216, v215, v245 row_ror:8 row_mask:0xf bank_mask:0xf
    v_fmac_f32_dpp v23, v217, v247 row_ror:8 row_mask:0xf bank_mask:0xf
    v_fma_f32 v217, v244, v216, v23
    v_mul_f32 v22, v246, v218
    v_fmac_f32_dpp v217, v216, v245 row_ror:8 row_mask:0xf bank_mask:0xf
    v_fmac_f32_dpp v22, v218, v247 row_ror:8 row_mask:0xf bank_mask:0xf
    v_fma_f32 v218, v244, v217, v22
    v_mul_f32 v23, v246, v219
    v_fmac_f32_dpp v218, v217, v245 row_ror:8 row_mask:0xf bank_mask:0xf
    v_fmac_f32_dpp v23, v219, v247 row_ror:8 row_mask:0xf bank_mask:0xf
    v_fma_f32 v219, v244, v218, v23
    v_mul_f32 v22, v246, v220
    v_fmac_f32_dpp v219, v218, v245 row_ror:8 row_mask:0xf bank_mask:0xf
    v_fmac_f32_dpp v22, v220, v247 row_ror:8 row_mask:0xf bank_mask:0xf
    v_fma_f32 v220, v244, v219, v22
    v_mul_f32 v23, v246, v221
    v_fmac_f32_dpp v220, v219, v245 row_ror:8 row_mask:0xf bank_mask:0xf
    v_fmac_f32_dpp v23, v221, v247 row_ror:8 row_mask:0xf bank_mask:0xf
    v_fma_f32 v221, v244, v220, v23
    v_mul_f32 v22, v246, v222
    v_fmac_f32_dpp v221, v220, v245 row_ror:8 row_mask:0xf bank_mask:0xf
    v_fmac_f32_dpp v22, v222, v247 row_ror:8 row_mask:0xf bank_mask:0xf
    v_fma_f32 v222, v244, v221, v22
    v_mul_f32 v23, v246, v223
    v_fmac_f32_dpp v222, v221, v245 row_ror:8 row_mask:0xf bank_mask:0xf
    v_fmac_f32_dpp v23, v223, v247 row_ror:8 row_mask:0xf bank_mask:0xf
    v_fma_f32 v223, v244, v222, v23
    s_nop 0
    v_fmac_f32_dpp v223, v222, v245 row_ror:8 row_mask:0xf bank_mask:0xf
    ds_bpermute_b32 v16, v8, v223
    ds_bpermute_b32 v17, v9, v223
    ds_bpermute_b32 v18, v10, v223
    ds_bpermute_b32 v19, v12, v223
    s_mul_i32 s45, s83, 4352
    s_add_u32 s45, s45, 25165824
    buffer_store_dwordx4 v[208:211], v3, s[48:51], s45 offen offset:0 sc1
    buffer_store_dwordx4 v[212:215], v3, s[48:51], s45 offen offset:1024 sc1
    buffer_store_dwordx4 v[216:219], v3, s[48:51], s45 offen offset:2048 sc1
    buffer_store_dwordx4 v[220:223], v3, s[48:51], s45 offen offset:3072 sc1
    s_waitcnt lgkmcnt(0)
    v_fma_f32 v20, v248, v16, v17
    s_nop 0
    v_fmac_f32_dpp v20, v16, v249 row_ror:8 row_mask:0xf bank_mask:0xf
    v_fma_f32 v21, v248, v20, v18
    s_nop 0
    v_fmac_f32_dpp v21, v20, v249 row_ror:8 row_mask:0xf bank_mask:0xf
    v_fma_f32 v14, v248, v21, v19
    s_nop 0
    v_fmac_f32_dpp v14, v21, v249 row_ror:8 row_mask:0xf bank_mask:0xf
    v_mov_b32 v241, 0
    v_cmp_eq_u32 vcc, 1, v242
    s_nop 1
    v_cndmask_b32 v241, v241, v16, vcc
    v_cmp_eq_u32 vcc, 2, v242
    s_nop 1
    v_cndmask_b32 v241, v241, v20, vcc
    v_cmp_eq_u32 vcc, 3, v242
    s_nop 1
    v_cndmask_b32 v241, v241, v21, vcc
    v_lshlrev_b32 v16, 2, v1
    s_add_u32 s12, s45, 4096
    buffer_store_dword v241, v16, s[48:51], s12 offen sc1
    s_sub_u32 s83, s83, 1
UNIT_DONE:
    v_lshrrev_b32 v4, 1, v1
    v_mul_u32_u24 v4, 9216, v4
    v_and_b32 v13, 1, v1
    v_lshl_add_u32 v4, v13, 4, v4
    s_mul_i32 s41, s7, 294912
    ds_read_b64_tr_b16 v[44:45], v5 offset:16928
    ds_read_b64_tr_b16 v[46:47], v5 offset:17184
    s_waitcnt lgkmcnt(8)
    v_mfma_f32_32x32x16_bf16 v[96:111], v[28:31], v[140:143], v[96:111]
    s_add_u32 s12, s32, 2949120
    s_add_u32 m0, s81, 114720
    s_nop 0
    buffer_load_dwordx4 v0, s[36:39], s12 offen lds
    s_and_b32 s13, s9, 3
    s_lshl_b32 s13, s13, 5
    s_add_u32 s41, s41, s13
    s_add_u32 s41, s41, 1024
    s_mov_b32 s42, 0xbdd2d3e8
    ds_read_b64_tr_b16 v[24:25], v5 offset:18432
    ds_read_b64_tr_b16 v[26:27], v5 offset:18688
    s_waitcnt vmcnt(14)
    s_waitcnt lgkmcnt(8)
    v_mfma_f32_32x32x16_bf16 v[48:63], v[32:35], v[144:147], v[48:63]
    v_mov_b32 v11, 0xc0135761
    s_lshr_b32 s14, s9, 2
    s_mul_i32 s14, s14, 9
    s_and_b32 s13, s9, 3
    s_lshl_b32 s34, s13, 1
    ds_read_b64_tr_b16 v[28:29], v5 offset:18464
    ds_read_b64_tr_b16 v[30:31], v5 offset:18720
    s_waitcnt lgkmcnt(8)
    v_mfma_f32_32x32x16_bf16 v[64:79], v[36:39], v[144:147], v[64:79]
    s_add_u32 s12, s32, 3538944
    s_add_u32 m0, s81, 49152
    s_nop 0
    buffer_load_dwordx4 v0, s[24:27], s12 offen lds
    s_add_u32 s34, s34, s14
    s_lshl_b32 s34, s34, 12
    s_mul_i32 s43, s10, 294912
    s_add_u32 s43, s43, 4194304
    s_add_u32 s14, s14, 8
    ds_read_b64_tr_b16 v[32:33], v5 offset:18944
    ds_read_b64_tr_b16 v[34:35], v5 offset:19200
    s_waitcnt lgkmcnt(8)
    v_mfma_f32_32x32x16_bf16 v[80:95], v[40:43], v[144:147], v[80:95]
    s_lshl_b32 s14, s14, 12
    s_lshl_b32 s13, s13, 10
    s_add_u32 s14, s14, s13
    s_add_u32 s35, s43, s14
    s_add_u32 s43, s43, s34
    ds_read_b64_tr_b16 v[36:37], v5 offset:18976
    ds_read_b64_tr_b16 v[38:39], v5 offset:19232
    s_waitcnt lgkmcnt(8)
    v_mfma_f32_32x32x16_bf16 v[96:111], v[44:47], v[144:147], v[96:111]
    s_add_u32 s12, s32, 3538944
    s_add_u32 m0, s81, 122912
    s_nop 0
    buffer_load_dwordx4 v0, s[36:39], s12 offen lds
    s_lshl_b32 s34, s8, 5
    s_add_u32 s34, s34, s9
    s_lshl_b32 s34, s34, 2
    s_add_u32 s34, s34, 65019904
    ds_read_b64_tr_b16 v[40:41], v5 offset:20480
    ds_read_b64_tr_b16 v[42:43], v5 offset:20736
    s_waitcnt vmcnt(15)
    s_waitcnt lgkmcnt(8)
    v_mfma_f32_32x32x16_bf16 v[48:63], v[24:27], v[148:151], v[48:63]
    ds_read_b64_tr_b16 v[44:45], v5 offset:20512
    ds_read_b64_tr_b16 v[46:47], v5 offset:20768
    s_waitcnt lgkmcnt(8)
    v_mfma_f32_32x32x16_bf16 v[64:79], v[28:31], v[148:151], v[64:79]
    s_add_u32 s12, s40, 16384
    buffer_load_dwordx4 v[176:179], v3, s[48:51], s12 offen sc1
    ds_read_b64_tr_b16 v[24:25], v5 offset:20992
    ds_read_b64_tr_b16 v[26:27], v5 offset:21248
    s_waitcnt lgkmcnt(8)
    v_mfma_f32_32x32x16_bf16 v[80:95], v[32:35], v[148:151], v[80:95]
    ds_read_b64_tr_b16 v[28:29], v5 offset:21024
    ds_read_b64_tr_b16 v[30:31], v5 offset:21280
    s_waitcnt lgkmcnt(8)
    v_mfma_f32_32x32x16_bf16 v[96:111], v[36:39], v[148:151], v[96:111]
    s_add_u32 s12, s40, 17408
    buffer_load_dwordx4 v[180:183], v3, s[48:51], s12 offen sc1
    ds_read_b64_tr_b16 v[32:33], v5 offset:22528
    ds_read_b64_tr_b16 v[34:35], v5 offset:22784
    s_waitcnt vmcnt(16)
    s_waitcnt lgkmcnt(8)
    v_mfma_f32_32x32x16_bf16 v[48:63], v[40:43], v[152:155], v[48:63]
    ds_read_b64_tr_b16 v[36:37], v5 offset:22560
    ds_read_b64_tr_b16 v[38:39], v5 offset:22816
    s_waitcnt lgkmcnt(8)
    v_mfma_f32_32x32x16_bf16 v[64:79], v[44:47], v[152:155], v[64:79]
    s_add_u32 s12, s40, 18432
    buffer_load_dwordx4 v[184:187], v3, s[48:51], s12 offen sc1
    ds_read_b64_tr_b16 v[40:41], v5 offset:23040
    ds_read_b64_tr_b16 v[42:43], v5 offset:23296
    s_waitcnt lgkmcnt(8)
    v_mfma_f32_32x32x16_bf16 v[80:95], v[24:27], v[152:155], v[80:95]
    ds_read_b64_tr_b16 v[44:45], v5 offset:23072
    ds_read_b64_tr_b16 v[46:47], v5 offset:23328
    s_waitcnt lgkmcnt(8)
    v_mfma_f32_32x32x16_bf16 v[96:111], v[28:31], v[152:155], v[96:111]
    s_add_u32 s12, s40, 19456
    buffer_load_dwordx4 v[188:191], v3, s[48:51], s12 offen sc1
    ds_read_b64_tr_b16 v[24:25], v5 offset:24576
    ds_read_b64_tr_b16 v[26:27], v5 offset:24832
    s_waitcnt vmcnt(17)
    s_waitcnt lgkmcnt(8)
    v_mfma_f32_32x32x16_bf16 v[48:63], v[32:35], v[156:159], v[48:63]
    ds_read_b64_tr_b16 v[28:29], v5 offset:24608
    ds_read_b64_tr_b16 v[30:31], v5 offset:24864
    s_waitcnt lgkmcnt(8)
    v_mfma_f32_32x32x16_bf16 v[64:79], v[36:39], v[156:159], v[64:79]
    s_add_u32 s12, s40, 20480
    buffer_load_dwordx4 v[192:195], v3, s[48:51], s12 offen sc1
    ds_read_b64_tr_b16 v[32:33], v5 offset:25088
    ds_read_b64_tr_b16 v[34:35], v5 offset:25344
    s_waitcnt lgkmcnt(8)
    v_mfma_f32_32x32x16_bf16 v[80:95], v[40:43], v[156:159], v[80:95]
    ds_read_b64_tr_b16 v[36:37], v5 offset:25120
    ds_read_b64_tr_b16 v[38:39], v5 offset:25376
    s_waitcnt lgkmcnt(8)
    v_mfma_f32_32x32x16_bf16 v[96:111], v[44:47], v[156:159], v[96:111]
    s_add_u32 s12, s40, 21504
    buffer_load_dwordx4 v[196:199], v3, s[48:51], s12 offen sc1
    ds_read_b64_tr_b16 v[40:41], v5 offset:26624
    ds_read_b64_tr_b16 v[42:43], v5 offset:26880
    s_waitcnt vmcnt(18)
    s_waitcnt lgkmcnt(8)
    v_mfma_f32_32x32x16_bf16 v[48:63], v[24:27], v[160:163], v[48:63]
    ds_read_b64_tr_b16 v[44:45], v5 offset:26656
    ds_read_b64_tr_b16 v[46:47], v5 offset:26912
    s_waitcnt lgkmcnt(8)
    v_mfma_f32_32x32x16_bf16 v[64:79], v[28:31], v[160:163], v[64:79]
    s_add_u32 s12, s40, 22528
    buffer_load_dwordx4 v[200:203], v3, s[48:51], s12 offen sc1
    ds_read_b64_tr_b16 v[24:25], v5 offset:27136
    ds_read_b64_tr_b16 v[26:27], v5 offset:27392
    s_waitcnt lgkmcnt(8)
    v_mfma_f32_32x32x16_bf16 v[80:95], v[32:35], v[160:163], v[80:95]
    ds_read_b64_tr_b16 v[28:29], v5 offset:27168
    ds_read_b64_tr_b16 v[30:31], v5 offset:27424
    s_waitcnt lgkmcnt(8)
    v_mfma_f32_32x32x16_bf16 v[96:111], v[36:39], v[160:163], v[96:111]
    s_add_u32 s12, s40, 23552
    buffer_load_dwordx4 v[204:207], v3, s[48:51], s12 offen sc1
    ds_read_b64_tr_b16 v[32:33], v5 offset:28672
    ds_read_b64_tr_b16 v[34:35], v5 offset:28928
    s_waitcnt vmcnt(19)
    s_waitcnt lgkmcnt(8)
    v_mfma_f32_32x32x16_bf16 v[48:63], v[40:43], v[164:167], v[48:63]
    ds_read_b64_tr_b16 v[36:37], v5 offset:28704
    ds_read_b64_tr_b16 v[38:39], v5 offset:28960
    s_waitcnt lgkmcnt(8)
    v_mfma_f32_32x32x16_bf16 v[64:79], v[44:47], v[164:167], v[64:79]
    s_add_u32 s12, s32, 4128768
    s_add_u32 m0, s81, 57344
    s_nop 0
    buffer_load_dwordx4 v0, s[24:27], s12 offen lds
    ds_read_b64_tr_b16 v[40:41], v5 offset:29184
    ds_read_b64_tr_b16 v[42:43], v5 offset:29440
    s_waitcnt lgkmcnt(8)
    v_mfma_f32_32x32x16_bf16 v[80:95], v[24:27], v[164:167], v[80:95]
    ds_read_b64_tr_b16 v[44:45], v5 offset:29216
    ds_read_b64_tr_b16 v[46:47], v5 offset:29472
    s_waitcnt lgkmcnt(8)
    v_mfma_f32_32x32x16_bf16 v[96:111], v[28:31], v[164:167], v[96:111]
    s_add_u32 s12, s32, 4128768
    s_add_u32 m0, s81, 131104
    s_nop 0
    buffer_load_dwordx4 v0, s[36:39], s12 offen lds
    ds_read_b64_tr_b16 v[24:25], v5 offset:30720
    ds_read_b64_tr_b16 v[26:27], v5 offset:30976
    s_waitcnt vmcnt(19)
    s_waitcnt lgkmcnt(8)
    v_mfma_f32_32x32x16_bf16 v[48:63], v[32:35], v[168:171], v[48:63]
    ds_read_b64_tr_b16 v[28:29], v5 offset:30752
    ds_read_b64_tr_b16 v[30:31], v5 offset:31008
    s_waitcnt lgkmcnt(8)
    v_mfma_f32_32x32x16_bf16 v[64:79], v[36:39], v[168:171], v[64:79]
    ds_read_b64_tr_b16 v[32:33], v5 offset:31232
    ds_read_b64_tr_b16 v[34:35], v5 offset:31488
    s_waitcnt lgkmcnt(8)
    v_mfma_f32_32x32x16_bf16 v[80:95], v[40:43], v[168:171], v[80:95]
    ds_read_b64_tr_b16 v[36:37], v5 offset:31264
    ds_read_b64_tr_b16 v[38:39], v5 offset:31520
    s_waitcnt lgkmcnt(8)
    v_mfma_f32_32x32x16_bf16 v[96:111], v[44:47], v[168:171], v[96:111]
    s_waitcnt vmcnt(12)
    s_barrier
    ds_read_b64_tr_b16 v[40:41], v5 offset:32768
    ds_read_b64_tr_b16 v[42:43], v5 offset:33024
    s_waitcnt lgkmcnt(8)
    v_mfma_f32_32x32x16_bf16 v[48:63], v[24:27], v[172:175], v[48:63]
    ds_read_b64_tr_b16 v[44:45], v5 offset:32800
    ds_read_b64_tr_b16 v[46:47], v5 offset:33056
    s_waitcnt lgkmcnt(8)
    v_mfma_f32_32x32x16_bf16 v[64:79], v[28:31], v[172:175], v[64:79]
    s_add_u32 s12, s40, 24576
    buffer_load_dwordx4 v[208:211], v3, s[48:51], s12 offen sc1
    ds_read_b64_tr_b16 v[24:25], v5 offset:33280
    ds_read_b64_tr_b16 v[26:27], v5 offset:33536
    s_waitcnt lgkmcnt(8)
    v_mfma_f32_32x32x16_bf16 v[80:95], v[32:35], v[172:175], v[80:95]
    ds_read_b64_tr_b16 v[28:29], v5 offset:33312
    ds_read_b64_tr_b16 v[30:31], v5 offset:33568
    s_waitcnt lgkmcnt(8)
    v_mfma_f32_32x32x16_bf16 v[96:111], v[36:39], v[172:175], v[96:111]
    s_add_u32 s12, s40, 25600
    buffer_load_dwordx4 v[212:215], v3, s[48:51], s12 offen sc1
    ds_read_b64_tr_b16 v[32:33], v5 offset:34816
    ds_read_b64_tr_b16 v[34:35], v5 offset:35072
    s_waitcnt vmcnt(11)
    s_waitcnt lgkmcnt(8)
    v_mfma_f32_32x32x16_bf16 v[48:63], v[40:43], v[176:179], v[48:63]
    ds_read_b64_tr_b16 v[36:37], v5 offset:34848
    ds_read_b64_tr_b16 v[38:39], v5 offset:35104
    s_waitcnt lgkmcnt(8)
    v_mfma_f32_32x32x16_bf16 v[64:79], v[44:47], v[176:179], v[64:79]
    s_add_u32 s12, s40, 26624
    buffer_load_dwordx4 v[216:219], v3, s[48:51], s12 offen sc1
    ds_read_b64_tr_b16 v[40:41], v5 offset:35328
    ds_read_b64_tr_b16 v[42:43], v5 offset:35584
    s_waitcnt lgkmcnt(8)
    v_mfma_f32_32x32x16_bf16 v[80:95], v[24:27], v[176:179], v[80:95]
    ds_read_b64_tr_b16 v[44:45], v5 offset:35360
    ds_read_b64_tr_b16 v[46:47], v5 offset:35616
    s_waitcnt lgkmcnt(8)
    v_mfma_f32_32x32x16_bf16 v[96:111], v[28:31], v[176:179], v[96:111]
    s_add_u32 s12, s40, 27648
    buffer_load_dwordx4 v[220:223], v3, s[48:51], s12 offen sc1
    ds_read_b64_tr_b16 v[24:25], v6 offset:0
    ds_read_b64_tr_b16 v[26:27], v6 offset:256
    s_waitcnt vmcnt(12)
    s_waitcnt lgkmcnt(8)
    v_mfma_f32_32x32x16_bf16 v[48:63], v[32:35], v[180:183], v[48:63]
    ds_read_b64_tr_b16 v[28:29], v6 offset:32
    ds_read_b64_tr_b16 v[30:31], v6 offset:288
    s_waitcnt lgkmcnt(8)
    v_mfma_f32_32x32x16_bf16 v[64:79], v[36:39], v[180:183], v[64:79]
    s_add_u32 s12, s32, 4718592
    s_add_u32 m0, s81, 65536
    s_nop 0
    buffer_load_dwordx4 v0, s[24:27], s12 offen lds
    ds_read_b64_tr_b16 v[32:33], v6 offset:512
    ds_read_b64_tr_b16 v[34:35], v6 offset:768
    s_waitcnt lgkmcnt(8)
    v_mfma_f32_32x32x16_bf16 v[80:95], v[40:43], v[180:183], v[80:95]
    ds_read_b64_tr_b16 v[36:37], v6 offset:544
    ds_read_b64_tr_b16 v[38:39], v6 offset:800
    s_waitcnt lgkmcnt(8)
    v_mfma_f32_32x32x16_bf16 v[96:111], v[44:47], v[180:183], v[96:111]
    s_add_u32 s12, s32, 4718592
    s_add_u32 m0, s81, 139296
    s_nop 0
    buffer_load_dwordx4 v0, s[36:39], s12 offen lds
    ds_read_b64_tr_b16 v[40:41], v6 offset:2048
    ds_read_b64_tr_b16 v[42:43], v6 offset:2304
    s_waitcnt vmcnt(13)
    s_waitcnt lgkmcnt(8)
    v_mfma_f32_32x32x16_bf16 v[48:63], v[24:27], v[184:187], v[48:63]
    ds_read_b64_tr_b16 v[44:45], v6 offset:2080
    ds_read_b64_tr_b16 v[46:47], v6 offset:2336
    s_waitcnt lgkmcnt(8)
    v_mfma_f32_32x32x16_bf16 v[64:79], v[28:31], v[184:187], v[64:79]
    s_add_u32 s12, s40, 28672
    buffer_load_dwordx4 v[224:227], v3, s[48:51], s12 offen sc1
    ds_read_b64_tr_b16 v[24:25], v6 offset:2560
    ds_read_b64_tr_b16 v[26:27], v6 offset:2816
    s_waitcnt lgkmcnt(8)
    v_mfma_f32_32x32x16_bf16 v[80:95], v[32:35], v[184:187], v[80:95]
    ds_read_b64_tr_b16 v[28:29], v6 offset:2592
    ds_read_b64_tr_b16 v[30:31], v6 offset:2848
    s_waitcnt lgkmcnt(8)
    v_mfma_f32_32x32x16_bf16 v[96:111], v[36:39], v[184:187], v[96:111]
    s_add_u32 s12, s40, 29696
    buffer_load_dwordx4 v[228:231], v3, s[48:51], s12 offen sc1
    ds_read_b64_tr_b16 v[32:33], v6 offset:4096
    ds_read_b64_tr_b16 v[34:35], v6 offset:4352
    s_waitcnt vmcnt(14)
    s_waitcnt lgkmcnt(8)
    v_mfma_f32_32x32x16_bf16 v[48:63], v[40:43], v[188:191], v[48:63]
    ds_read_b64_tr_b16 v[36:37], v6 offset:4128
    ds_read_b64_tr_b16 v[38:39], v6 offset:4384
    s_waitcnt lgkmcnt(8)
    v_mfma_f32_32x32x16_bf16 v[64:79], v[44:47], v[188:191], v[64:79]
    s_add_u32 s12, s40, 30720
    buffer_load_dwordx4 v[232:235], v3, s[48:51], s12 offen sc1
    ds_read_b64_tr_b16 v[40:41], v6 offset:4608
    ds_read_b64_tr_b16 v[42:43], v6 offset:4864
    s_waitcnt lgkmcnt(8)
    v_mfma_f32_32x32x16_bf16 v[80:95], v[24:27], v[188:191], v[80:95]
    ds_read_b64_tr_b16 v[44:45], v6 offset:4640
    ds_read_b64_tr_b16 v[46:47], v6 offset:4896
    s_waitcnt lgkmcnt(8)
    v_mfma_f32_32x32x16_bf16 v[96:111], v[28:31], v[188:191], v[96:111]
    s_add_u32 s12, s40, 31744
    buffer_load_dwordx4 v[236:239], v3, s[48:51], s12 offen sc1
    ds_read_b64_tr_b16 v[24:25], v6 offset:6144
    ds_read_b64_tr_b16 v[26:27], v6 offset:6400
    s_waitcnt vmcnt(15)
    s_waitcnt lgkmcnt(8)
    v_mfma_f32_32x32x16_bf16 v[48:63], v[32:35], v[192:195], v[48:63]
    ds_read_b64_tr_b16 v[28:29], v6 offset:6176
    ds_read_b64_tr_b16 v[30:31], v6 offset:6432
    s_waitcnt lgkmcnt(8)
    v_mfma_f32_32x32x16_bf16 v[64:79], v[36:39], v[192:195], v[64:79]
    s_add_u32 s12, s40, 32768
    buffer_load_dwordx4 v[240:243], v3, s[48:51], s12 offen sc1
    ds_read_b64_tr_b16 v[32:33], v6 offset:6656
    ds_read_b64_tr_b16 v[34:35], v6 offset:6912
    s_waitcnt lgkmcnt(8)
    v_mfma_f32_32x32x16_bf16 v[80:95], v[40:43], v[192:195], v[80:95]
    ds_read_b64_tr_b16 v[36:37], v6 offset:6688
    ds_read_b64_tr_b16 v[38:39], v6 offset:6944
    s_waitcnt lgkmcnt(8)
    v_mfma_f32_32x32x16_bf16 v[96:111], v[44:47], v[192:195], v[96:111]
    s_add_u32 s12, s40, 33792
    buffer_load_dwordx4 v[244:247], v3, s[48:51], s12 offen sc1
    ds_read_b64_tr_b16 v[40:41], v6 offset:8192
    ds_read_b64_tr_b16 v[42:43], v6 offset:8448
    s_waitcnt vmcnt(16)
    s_waitcnt lgkmcnt(8)
    v_mfma_f32_32x32x16_bf16 v[48:63], v[24:27], v[196:199], v[48:63]
    ds_read_b64_tr_b16 v[44:45], v6 offset:8224
    ds_read_b64_tr_b16 v[46:47], v6 offset:8480
    s_waitcnt lgkmcnt(8)
    v_mfma_f32_32x32x16_bf16 v[64:79], v[28:31], v[196:199], v[64:79]
    s_add_u32 s12, s40, 34816
    buffer_load_dwordx4 v[248:251], v3, s[48:51], s12 offen sc1
    ds_read_b64_tr_b16 v[24:25], v6 offset:8704
    ds_read_b64_tr_b16 v[26:27], v6 offset:8960
    s_waitcnt lgkmcnt(8)
    v_mfma_f32_32x32x16_bf16 v[80:95], v[32:35], v[196:199], v[80:95]
    ds_read_b64_tr_b16 v[28:29], v6 offset:8736
    ds_read_b64_tr_b16 v[30:31], v6 offset:8992
    s_waitcnt lgkmcnt(8)
    v_mfma_f32_32x32x16_bf16 v[96:111], v[36:39], v[196:199], v[96:111]
    s_add_u32 s12, s40, 35840
    buffer_load_dwordx4 v[252:255], v3, s[48:51], s12 offen sc1
    ds_read_b64_tr_b16 v[32:33], v6 offset:10240
    ds_read_b64_tr_b16 v[34:35], v6 offset:10496
    s_waitcnt vmcnt(17)
    s_waitcnt lgkmcnt(8)
    v_mfma_f32_32x32x16_bf16 v[48:63], v[40:43], v[200:203], v[48:63]
    ds_read_b64_tr_b16 v[36:37], v6 offset:10272
    ds_read_b64_tr_b16 v[38:39], v6 offset:10528
    s_waitcnt lgkmcnt(8)
    v_mfma_f32_32x32x16_bf16 v[64:79], v[44:47], v[200:203], v[64:79]
    s_add_u32 s12, s32, 128
    s_add_u32 m0, s81, 0
    s_nop 0
    buffer_load_dwordx4 v0, s[24:27], s12 offen lds
    ds_read_b64_tr_b16 v[40:41], v6 offset:10752
    ds_read_b64_tr_b16 v[42:43], v6 offset:11008
    s_waitcnt lgkmcnt(8)
    v_mfma_f32_32x32x16_bf16 v[80:95], v[24:27], v[200:203], v[80:95]
    ds_read_b64_tr_b16 v[44:45], v6 offset:10784
    ds_read_b64_tr_b16 v[46:47], v6 offset:11040
    s_waitcnt lgkmcnt(8)
    v_mfma_f32_32x32x16_bf16 v[96:111], v[28:31], v[200:203], v[96:111]
    s_add_u32 s12, s32, 128
    s_add_u32 m0, s81, 73760
    s_nop 0
    buffer_load_dwordx4 v0, s[36:39], s12 offen lds
    s_waitcnt vmcnt(16)
    s_barrier
    ds_read_b64_tr_b16 v[24:25], v6 offset:12288
    ds_read_b64_tr_b16 v[26:27], v6 offset:12544
    s_waitcnt lgkmcnt(8)
    v_mfma_f32_32x32x16_bf16 v[48:63], v[32:35], v[204:207], v[48:63]
    ds_read_b64_tr_b16 v[28:29], v6 offset:14336
    ds_read_b64_tr_b16 v[30:31], v6 offset:14592
    s_waitcnt lgkmcnt(8)
    v_mfma_f32_32x32x16_bf16 v[64:79], v[36:39], v[204:207], v[64:79]
    s_add_u32 s12, s32, 589952
    s_add_u32 m0, s81, 8192
    s_nop 0
    buffer_load_dwordx4 v0, s[24:27], s12 offen lds
    ds_read_b64_tr_b16 v[32:33], v6 offset:16384
    ds_read_b64_tr_b16 v[34:35], v6 offset:16640
    s_waitcnt lgkmcnt(8)
    v_mfma_f32_32x32x16_bf16 v[80:95], v[40:43], v[204:207], v[80:95]
    ds_read_b64_tr_b16 v[36:37], v6 offset:18432
    ds_read_b64_tr_b16 v[38:39], v6 offset:18688
    s_waitcnt lgkmcnt(8)
    v_mfma_f32_32x32x16_bf16 v[96:111], v[44:47], v[204:207], v[96:111]
    s_add_u32 s12, s32, 589952
    s_add_u32 m0, s81, 81952
    s_nop 0
    buffer_load_dwordx4 v0, s[36:39], s12 offen lds
    ds_read_b64_tr_b16 v[40:41], v6 offset:20480
    ds_read_b64_tr_b16 v[42:43], v6 offset:20736
    s_waitcnt vmcnt(17)
    s_waitcnt lgkmcnt(8)
    v_mfma_f32_32x32x16_bf16 v[48:63], v[24:27], v[208:211], v[48:63]
    ds_read_b64_tr_b16 v[44:45], v6 offset:22528
    ds_read_b64_tr_b16 v[46:47], v6 offset:22784
    s_waitcnt vmcnt(16)
    s_waitcnt lgkmcnt(8)
    v_mfma_f32_32x32x16_bf16 v[48:63], v[28:31], v[212:215], v[48:63]
    s_add_u32 s12, s32, 1179776
    s_add_u32 m0, s81, 16384
    s_nop 0
    buffer_load_dwordx4 v0, s[24:27], s12 offen lds
    ds_read_b64_tr_b16 v[24:25], v6 offset:24576
    ds_read_b64_tr_b16 v[26:27], v6 offset:24832
    s_waitcnt vmcnt(16)
    s_waitcnt lgkmcnt(8)
    v_mfma_f32_32x32x16_bf16 v[48:63], v[32:35], v[216:219], v[48:63]
    ds_read_b64_tr_b16 v[28:29], v6 offset:26624
    ds_read_b64_tr_b16 v[30:31], v6 offset:26880
    s_waitcnt vmcnt(15)
    s_waitcnt lgkmcnt(8)
    v_mfma_f32_32x32x16_bf16 v[48:63], v[36:39], v[220:223], v[48:63]
    s_add_u32 s12, s32, 1179776
    s_add_u32 m0, s81, 90144
    s_nop 0
    buffer_load_dwordx4 v0, s[36:39], s12 offen lds
    s_waitcnt vmcnt(14)
    s_barrier
    ds_read_b64_tr_b16 v[32:33], v6 offset:28672
    ds_read_b64_tr_b16 v[34:35], v6 offset:28928
    s_waitcnt vmcnt(13)
    s_waitcnt lgkmcnt(8)
    v_mfma_f32_32x32x16_bf16 v[48:63], v[40:43], v[224:227], v[48:63]
    ds_read_b64_tr_b16 v[36:37], v6 offset:30720
    ds_read_b64_tr_b16 v[38:39], v6 offset:30976
    s_waitcnt vmcnt(12)
    s_waitcnt lgkmcnt(8)
    v_mfma_f32_32x32x16_bf16 v[48:63], v[44:47], v[228:231], v[48:63]
    s_add_u32 s12, s32, 1769600
    s_add_u32 m0, s81, 24576
    s_nop 0
    buffer_load_dwordx4 v0, s[24:27], s12 offen lds
    ds_read_b64_tr_b16 v[40:41], v6 offset:32768
    ds_read_b64_tr_b16 v[42:43], v6 offset:33024
    s_waitcnt vmcnt(12)
    s_waitcnt lgkmcnt(8)
    v_mfma_f32_32x32x16_bf16 v[48:63], v[24:27], v[232:235], v[48:63]
    ds_read_b64_tr_b16 v[44:45], v6 offset:34816
    ds_read_b64_tr_b16 v[46:47], v6 offset:35072
    s_waitcnt vmcnt(11)
    s_waitcnt lgkmcnt(8)
    v_mfma_f32_32x32x16_bf16 v[48:63], v[28:31], v[236:239], v[48:63]
    s_add_u32 s12, s32, 1769600
    s_add_u32 m0, s81, 98336
    s_nop 0
    buffer_load_dwordx4 v0, s[36:39], s12 offen lds
    ds_read_b64_tr_b16 v[24:25], v6 offset:12320
    ds_read_b64_tr_b16 v[26:27], v6 offset:12576
    s_waitcnt vmcnt(11)
    s_waitcnt lgkmcnt(8)
    v_mfma_f32_32x32x16_bf16 v[48:63], v[32:35], v[240:243], v[48:63]
    ds_read_b64_tr_b16 v[28:29], v6 offset:14368
    ds_read_b64_tr_b16 v[30:31], v6 offset:14624
    s_waitcnt vmcnt(10)
    s_waitcnt lgkmcnt(8)
    v_mfma_f32_32x32x16_bf16 v[48:63], v[36:39], v[244:247], v[48:63]
    s_add_u32 s12, s32, 2359424
    s_add_u32 m0, s81, 32768
    s_nop 0
    buffer_load_dwordx4 v0, s[24:27], s12 offen lds
    ds_read_b64_tr_b16 v[32:33], v6 offset:16416
    ds_read_b64_tr_b16 v[34:35], v6 offset:16672
    s_waitcnt vmcnt(10)
    s_waitcnt lgkmcnt(8)
    v_mfma_f32_32x32x16_bf16 v[48:63], v[40:43], v[248:251], v[48:63]
    ds_read_b64_tr_b16 v[36:37], v6 offset:18464
    ds_read_b64_tr_b16 v[38:39], v6 offset:18720
    s_waitcnt vmcnt(9)
    s_waitcnt lgkmcnt(8)
    v_mfma_f32_32x32x16_bf16 v[48:63], v[44:47], v[252:255], v[48:63]
    s_add_u32 s12, s32, 2359424
    s_add_u32 m0, s81, 106528
    s_nop 0
    buffer_load_dwordx4 v0, s[36:39], s12 offen lds
    ds_read_b64_tr_b16 v[40:41], v6 offset:20512
    ds_read_b64_tr_b16 v[42:43], v6 offset:20768
    s_waitcnt lgkmcnt(8)
    v_mfma_f32_32x32x16_bf16 v[64:79], v[24:27], v[208:211], v[64:79]
    ds_read_b64_tr_b16 v[44:45], v6 offset:22560
    ds_read_b64_tr_b16 v[46:47], v6 offset:22816
    s_waitcnt lgkmcnt(8)
    v_mfma_f32_32x32x16_bf16 v[64:79], v[28:31], v[212:215], v[64:79]
    s_add_u32 s12, s32, 2949248
    s_add_u32 m0, s81, 40960
    s_nop 0
    buffer_load_dwordx4 v0, s[24:27], s12 offen lds
    ds_read_b64_tr_b16 v[24:25], v6 offset:24608
    ds_read_b64_tr_b16 v[26:27], v6 offset:24864
    s_waitcnt lgkmcnt(8)
    v_mfma_f32_32x32x16_bf16 v[64:79], v[32:35], v[216:219], v[64:79]
    ds_read_b64_tr_b16 v[28:29], v6 offset:26656
    ds_read_b64_tr_b16 v[30:31], v6 offset:26912
    s_waitcnt lgkmcnt(8)
    v_mfma_f32_32x32x16_bf16 v[64:79], v[36:39], v[220:223], v[64:79]
    s_add_u32 s12, s32, 2949248
    s_add_u32 m0, s81, 114720
    s_nop 0
    buffer_load_dwordx4 v0, s[36:39], s12 offen lds
    v_mul_f32 v16, v48, v48
    v_mul_f32 v17, v49, v49
    v_mul_f32 v18, v50, v50
    ds_read_b64_tr_b16 v[32:33], v6 offset:28704
    ds_read_b64_tr_b16 v[34:35], v6 offset:28960
    s_waitcnt lgkmcnt(8)
    v_mfma_f32_32x32x16_bf16 v[64:79], v[40:43], v[224:227], v[64:79]
    v_mul_f32 v19, v51, v51
    v_fma_f32 v16, v16, s42, v11
    v_fma_f32 v17, v17, s42, v11
    ds_read_b64_tr_b16 v[36:37], v6 offset:30752
    ds_read_b64_tr_b16 v[38:39], v6 offset:31008
    s_waitcnt lgkmcnt(8)
    v_mfma_f32_32x32x16_bf16 v[64:79], v[44:47], v[228:231], v[64:79]
    s_lshl_b32 s12, s83, 6
    s_add_u32 s12, s12, 36700160
    s_cmp_lg_u32 s7, 7
    s_cbranch_scc1 E8_8
    buffer_store_dword v14, v8, s[48:51], s12 offen offset:64 sc1
E8_8:
    buffer_store_dword v15, v8, s[48:51], s12 offen sc1
    v_fma_f32 v18, v18, s42, v11
    v_fma_f32 v19, v19, s42, v11
    v_mul_f32 v16, v16, v48
    ds_read_b64_tr_b16 v[40:41], v6 offset:32800
    ds_read_b64_tr_b16 v[42:43], v6 offset:33056
    s_waitcnt lgkmcnt(8)
    v_mfma_f32_32x32x16_bf16 v[64:79], v[24:27], v[232:235], v[64:79]
    v_mul_f32 v17, v17, v49
    v_mul_f32 v18, v18, v50
    v_mul_f32 v19, v19, v51
    ds_read_b64_tr_b16 v[44:45], v6 offset:34848
    ds_read_b64_tr_b16 v[46:47], v6 offset:35104
    s_waitcnt lgkmcnt(8)
    v_mfma_f32_32x32x16_bf16 v[64:79], v[28:31], v[236:239], v[64:79]
    s_load_dwordx2 s[76:77], s[0:1], 96
    v_lshlrev_b32 v13, 7, v1
    v_min_u32 v13, 2688, v13
    s_lshl_b32 s12, s2, 3
    s_add_u32 s12, s12, s7
    s_mul_i32 s12, s12, 2592
    s_and_b32 s12, s12, 0xffffff80
    s_mov_b32 s78, 5308416
    s_mov_b32 s79, 0x20000
    s_waitcnt lgkmcnt(0)
    buffer_load_dword v9, v13, s[76:79], s12 offen
    v_exp_f32 v16, v16
    v_exp_f32 v17, v17
    v_exp_f32 v18, v18
    ds_read_b64_tr_b16 v[24:25], v6 offset:12800
    ds_read_b64_tr_b16 v[26:27], v6 offset:13056
    s_waitcnt lgkmcnt(8)
    v_mfma_f32_32x32x16_bf16 v[64:79], v[32:35], v[240:243], v[64:79]
    v_exp_f32 v19, v19
    v_mul_f32 v48, v48, v56
    v_mul_f32 v49, v49, v57
    ds_read_b64_tr_b16 v[28:29], v6 offset:14848
    ds_read_b64_tr_b16 v[30:31], v6 offset:15104
    s_waitcnt lgkmcnt(8)
    v_mfma_f32_32x32x16_bf16 v[64:79], v[36:39], v[244:247], v[64:79]
    s_lshr_b32 s12, s2, 7
    s_lshl_b32 s12, s12, 3
    s_add_u32 s76, s0, s12
    s_addc_u32 s77, s1, 0
    s_load_dwordx2 s[76:77], s[76:77], 40
    v_min_u32 v13, 768, v13
    s_and_b32 s12, s2, 127
    s_lshl_b32 s12, s12, 3
    s_add_u32 s12, s12, s7
    s_mul_i32 s12, s12, 648
    s_and_b32 s12, s12, 0xffffff80
    s_mov_b32 s78, 663552
    s_waitcnt lgkmcnt(0)
    buffer_load_dword v10, v13, s[76:79], s12 offen
    v_mul_f32 v50, v50, v58
    v_mul_f32 v51, v51, v59
    v_add_f32 v16, 1.0, v16
    ds_read_b64_tr_b16 v[32:33], v6 offset:16896
    ds_read_b64_tr_b16 v[34:35], v6 offset:17152
    s_waitcnt lgkmcnt(8)
    v_mfma_f32_32x32x16_bf16 v[64:79], v[40:43], v[248:251], v[64:79]
    v_add_f32 v17, 1.0, v17
    v_add_f32 v18, 1.0, v18
    v_add_f32 v19, 1.0, v19
    ds_read_b64_tr_b16 v[36:37], v6 offset:18944
    ds_read_b64_tr_b16 v[38:39], v6 offset:19200
    s_waitcnt lgkmcnt(8)
    v_mfma_f32_32x32x16_bf16 v[64:79], v[44:47], v[252:255], v[64:79]
    v_rcp_f32 v16, v16
    v_rcp_f32 v17, v17
    v_rcp_f32 v18, v18
    ds_read_b64_tr_b16 v[40:41], v6 offset:20992
    ds_read_b64_tr_b16 v[42:43], v6 offset:21248
    s_waitcnt lgkmcnt(8)
    v_mfma_f32_32x32x16_bf16 v[80:95], v[24:27], v[208:211], v[80:95]
    v_rcp_f32 v19, v19
    s_nop 0
    v_mul_f32 v48, v48, v16
    ds_read_b64_tr_b16 v[44:45], v6 offset:23040
    ds_read_b64_tr_b16 v[46:47], v6 offset:23296
    s_waitcnt lgkmcnt(8)
    v_mfma_f32_32x32x16_bf16 v[80:95], v[28:31], v[212:215], v[80:95]
    v_mul_f32 v49, v49, v17
    v_mul_f32 v50, v50, v18
    v_mul_f32 v51, v51, v19
    ds_read_b64_tr_b16 v[24:25], v6 offset:25088
    ds_read_b64_tr_b16 v[26:27], v6 offset:25344
    s_waitcnt lgkmcnt(8)
    v_mfma_f32_32x32x16_bf16 v[80:95], v[32:35], v[216:219], v[80:95]
    v_cvt_pk_bf16_f32 v20, v48, v49
    v_cvt_pk_bf16_f32 v21, v50, v51
    v_mul_f32 v16, v52, v52
    ds_read_b64_tr_b16 v[28:29], v6 offset:27136
    ds_read_b64_tr_b16 v[30:31], v6 offset:27392
    s_waitcnt lgkmcnt(8)
    v_mfma_f32_32x32x16_bf16 v[80:95], v[36:39], v[220:223], v[80:95]
    v_mul_f32 v17, v53, v53
    v_mul_f32 v18, v54, v54
    v_mul_f32 v19, v55, v55
    ds_read_b64_tr_b16 v[32:33], v6 offset:29184
    ds_read_b64_tr_b16 v[34:35], v6 offset:29440
    s_waitcnt lgkmcnt(8)
    v_mfma_f32_32x32x16_bf16 v[80:95], v[40:43], v[224:227], v[80:95]
    v_fma_f32 v16, v16, s42, v11
    v_fma_f32 v17, v17, s42, v11
    v_fma_f32 v18, v18, s42, v11
    ds_read_b64_tr_b16 v[36:37], v6 offset:31232
    ds_read_b64_tr_b16 v[38:39], v6 offset:31488
    s_waitcnt lgkmcnt(8)
    v_mfma_f32_32x32x16_bf16 v[80:95], v[44:47], v[228:231], v[80:95]
    v_fma_f32 v19, v19, s42, v11
    v_mul_f32 v16, v16, v52
    v_mul_f32 v17, v17, v53
    ds_read_b64_tr_b16 v[40:41], v6 offset:33280
    ds_read_b64_tr_b16 v[42:43], v6 offset:33536
    s_waitcnt lgkmcnt(8)
    v_mfma_f32_32x32x16_bf16 v[80:95], v[24:27], v[232:235], v[80:95]
    v_mul_f32 v18, v18, v54
    v_mul_f32 v19, v19, v55
    v_exp_f32 v16, v16
    ds_read_b64_tr_b16 v[44:45], v6 offset:35328
    ds_read_b64_tr_b16 v[46:47], v6 offset:35584
    s_waitcnt lgkmcnt(8)
    v_mfma_f32_32x32x16_bf16 v[80:95], v[28:31], v[236:239], v[80:95]
    v_exp_f32 v17, v17
    v_exp_f32 v18, v18
    v_exp_f32 v19, v19
    ds_read_b64_tr_b16 v[24:25], v6 offset:12832
    ds_read_b64_tr_b16 v[26:27], v6 offset:13088
    s_waitcnt lgkmcnt(8)
    v_mfma_f32_32x32x16_bf16 v[80:95], v[32:35], v[240:243], v[80:95]
    v_mul_f32 v52, v52, v60
    v_mul_f32 v53, v53, v61
    v_mul_f32 v54, v54, v62
    ds_read_b64_tr_b16 v[28:29], v6 offset:14880
    ds_read_b64_tr_b16 v[30:31], v6 offset:15136
    s_waitcnt lgkmcnt(8)
    v_mfma_f32_32x32x16_bf16 v[80:95], v[36:39], v[244:247], v[80:95]
    v_mul_f32 v55, v55, v63
    v_add_f32 v16, 1.0, v16
    v_add_f32 v17, 1.0, v17
    ds_read_b64_tr_b16 v[32:33], v6 offset:16928
    ds_read_b64_tr_b16 v[34:35], v6 offset:17184
    s_waitcnt lgkmcnt(8)
    v_mfma_f32_32x32x16_bf16 v[80:95], v[40:43], v[248:251], v[80:95]
    v_add_f32 v18, 1.0, v18
    v_add_f32 v19, 1.0, v19
    v_rcp_f32 v16, v16
    ds_read_b64_tr_b16 v[36:37], v6 offset:18976
    ds_read_b64_tr_b16 v[38:39], v6 offset:19232
    s_waitcnt lgkmcnt(8)
    v_mfma_f32_32x32x16_bf16 v[80:95], v[44:47], v[252:255], v[80:95]
    v_rcp_f32 v17, v17
    v_rcp_f32 v18, v18
    v_rcp_f32 v19, v19
    ds_read_b64_tr_b16 v[40:41], v6 offset:21024
    ds_read_b64_tr_b16 v[42:43], v6 offset:21280
    s_waitcnt lgkmcnt(8)
    v_mfma_f32_32x32x16_bf16 v[96:111], v[24:27], v[208:211], v[96:111]
    s_nop 0
    v_mul_f32 v52, v52, v16
    v_mul_f32 v53, v53, v17
    ds_read_b64_tr_b16 v[44:45], v6 offset:23072
    ds_read_b64_tr_b16 v[46:47], v6 offset:23328
    s_waitcnt lgkmcnt(8)
    v_mfma_f32_32x32x16_bf16 v[96:111], v[28:31], v[212:215], v[96:111]
    v_mul_f32 v54, v54, v18
    v_mul_f32 v55, v55, v19
    v_cvt_pk_bf16_f32 v22, v52, v53
    ds_read_b64_tr_b16 v[24:25], v6 offset:25120
    ds_read_b64_tr_b16 v[26:27], v6 offset:25376
    s_waitcnt lgkmcnt(8)
    v_mfma_f32_32x32x16_bf16 v[96:111], v[32:35], v[216:219], v[96:111]
    v_cvt_pk_bf16_f32 v23, v54, v55
    buffer_store_dwordx4 v[20:23], v3, s[48:51], s43 offen offset:0 sc1
    ds_read_b64_tr_b16 v[28:29], v6 offset:27168
    ds_read_b64_tr_b16 v[30:31], v6 offset:27424
    s_waitcnt lgkmcnt(8)
    v_mfma_f32_32x32x16_bf16 v[96:111], v[36:39], v[220:223], v[96:111]
    v_mul_f32 v16, v64, v64
    v_mul_f32 v17, v65, v65
    v_mul_f32 v18, v66, v66
    ds_read_b64_tr_b16 v[32:33], v6 offset:29216
    ds_read_b64_tr_b16 v[34:35], v6 offset:29472
    s_waitcnt lgkmcnt(8)
    v_mfma_f32_32x32x16_bf16 v[96:111], v[40:43], v[224:227], v[96:111]
    v_mul_f32 v19, v67, v67
    v_fma_f32 v16, v16, s42, v11
    v_fma_f32 v17, v17, s42, v11
    ds_read_b64_tr_b16 v[36:37], v6 offset:31264
    ds_read_b64_tr_b16 v[38:39], v6 offset:31520
    s_waitcnt lgkmcnt(8)
    v_mfma_f32_32x32x16_bf16 v[96:111], v[44:47], v[228:231], v[96:111]
    v_fma_f32 v18, v18, s42, v11
    v_fma_f32 v19, v19, s42, v11
    v_mul_f32 v16, v16, v64
    ds_read_b64_tr_b16 v[40:41], v6 offset:33312
    ds_read_b64_tr_b16 v[42:43], v6 offset:33568
    s_waitcnt lgkmcnt(8)
    v_mfma_f32_32x32x16_bf16 v[96:111], v[24:27], v[232:235], v[96:111]
    v_mul_f32 v17, v17, v65
    v_mul_f32 v18, v18, v66
    v_mul_f32 v19, v19, v67
    ds_read_b64_tr_b16 v[44:45], v6 offset:35360
    ds_read_b64_tr_b16 v[46:47], v6 offset:35616
    s_waitcnt lgkmcnt(8)
    v_mfma_f32_32x32x16_bf16 v[96:111], v[28:31], v[236:239], v[96:111]
    v_exp_f32 v16, v16
    v_exp_f32 v17, v17
    v_exp_f32 v18, v18
    s_waitcnt vmcnt(4)
    s_barrier
    ds_read_b64_tr_b16 v[24:25], v5 offset:0
    ds_read_b64_tr_b16 v[26:27], v5 offset:256
    s_waitcnt lgkmcnt(8)
    v_mfma_f32_32x32x16_bf16 v[96:111], v[32:35], v[240:243], v[96:111]
    v_exp_f32 v19, v19
    v_mul_f32 v64, v64, v72
    v_mul_f32 v65, v65, v73
    ds_read_b64_tr_b16 v[28:29], v5 offset:2048
    ds_read_b64_tr_b16 v[30:31], v5 offset:2304
    s_waitcnt lgkmcnt(8)
    v_mfma_f32_32x32x16_bf16 v[96:111], v[36:39], v[244:247], v[96:111]
    s_add_u32 s12, s32, 3539072
    s_add_u32 m0, s81, 49152
    s_nop 0
    buffer_load_dwordx4 v0, s[24:27], s12 offen lds
    v_mul_f32 v66, v66, v74
    v_mul_f32 v67, v67, v75
    v_add_f32 v16, 1.0, v16
    ds_read_b64_tr_b16 v[32:33], v5 offset:4096
    ds_read_b64_tr_b16 v[34:35], v5 offset:4352
    s_waitcnt lgkmcnt(8)
    v_mfma_f32_32x32x16_bf16 v[96:111], v[40:43], v[248:251], v[96:111]
    v_add_f32 v17, 1.0, v17
    v_add_f32 v18, 1.0, v18
    v_add_f32 v19, 1.0, v19
    ds_read_b64_tr_b16 v[36:37], v5 offset:6144
    ds_read_b64_tr_b16 v[38:39], v5 offset:6400
    s_waitcnt lgkmcnt(8)
    v_mfma_f32_32x32x16_bf16 v[96:111], v[44:47], v[252:255], v[96:111]
    s_add_u32 s12, s32, 3539072
    s_add_u32 m0, s81, 122912
    s_nop 0
    buffer_load_dwordx4 v0, s[36:39], s12 offen lds
    v_rcp_f32 v16, v16
    v_rcp_f32 v17, v17
    v_rcp_f32 v18, v18
    ds_read_b64_tr_b16 v[40:41], v5 offset:8192
    ds_read_b64_tr_b16 v[42:43], v5 offset:8448
    s_waitcnt lgkmcnt(8)
    v_mfma_f32_32x32x16_bf16 v[48:63], v[24:27], v[112:115], 0
    v_rcp_f32 v19, v19
    s_nop 0
    v_mul_f32 v64, v64, v16
    ds_read_b64_tr_b16 v[44:45], v5 offset:10240
    ds_read_b64_tr_b16 v[46:47], v5 offset:10496
    s_waitcnt lgkmcnt(8)
    v_mfma_f32_32x32x16_bf16 v[48:63], v[28:31], v[116:119], v[48:63]
    s_add_u32 s12, s32, 4128896
    s_add_u32 m0, s81, 57344
    s_nop 0
    buffer_load_dwordx4 v0, s[24:27], s12 offen lds
    v_mul_f32 v65, v65, v17
    v_mul_f32 v66, v66, v18
    v_mul_f32 v67, v67, v19
    s_barrier
    ds_read_b64_tr_b16 v[24:25], v5 offset:12288
    ds_read_b64_tr_b16 v[26:27], v5 offset:12544
    s_waitcnt lgkmcnt(8)
    v_mfma_f32_32x32x16_bf16 v[48:63], v[32:35], v[120:123], v[48:63]
    v_cvt_pk_bf16_f32 v20, v64, v65
    v_cvt_pk_bf16_f32 v21, v66, v67
    v_mul_f32 v16, v68, v68
    ds_read_b64_tr_b16 v[28:29], v5 offset:14336
    ds_read_b64_tr_b16 v[30:31], v5 offset:14592
    s_waitcnt lgkmcnt(8)
    v_mfma_f32_32x32x16_bf16 v[48:63], v[36:39], v[124:127], v[48:63]
    s_add_u32 s12, s32, 4128896
    s_add_u32 m0, s81, 131104
    s_nop 0
    buffer_load_dwordx4 v0, s[36:39], s12 offen lds
    v_mul_f32 v17, v69, v69
    v_mul_f32 v18, v70, v70
    v_mul_f32 v19, v71, v71
    ds_read_b64_tr_b16 v[32:33], v5 offset:16384
    ds_read_b64_tr_b16 v[34:35], v5 offset:16640
    s_waitcnt lgkmcnt(8)
    v_mfma_f32_32x32x16_bf16 v[48:63], v[40:43], v[128:131], v[48:63]
    v_fma_f32 v16, v16, s42, v11
    v_fma_f32 v17, v17, s42, v11
    v_fma_f32 v18, v18, s42, v11
    ds_read_b64_tr_b16 v[36:37], v5 offset:18432
    ds_read_b64_tr_b16 v[38:39], v5 offset:18688
    s_waitcnt lgkmcnt(8)
    v_mfma_f32_32x32x16_bf16 v[48:63], v[44:47], v[132:135], v[48:63]
    s_add_u32 s12, s32, 4718720
    s_add_u32 m0, s81, 65536
    s_nop 0
    buffer_load_dwordx4 v0, s[24:27], s12 offen lds
    v_fma_f32 v19, v19, s42, v11
    v_mul_f32 v16, v16, v68
    v_mul_f32 v17, v17, v69
    ds_read_b64_tr_b16 v[40:41], v5 offset:20480
    ds_read_b64_tr_b16 v[42:43], v5 offset:20736
    s_waitcnt lgkmcnt(8)
    v_mfma_f32_32x32x16_bf16 v[48:63], v[24:27], v[136:139], v[48:63]
    v_mul_f32 v18, v18, v70
    v_mul_f32 v19, v19, v71
    v_exp_f32 v16, v16
    ds_read_b64_tr_b16 v[44:45], v5 offset:22528
    ds_read_b64_tr_b16 v[46:47], v5 offset:22784
    s_waitcnt lgkmcnt(8)
    v_mfma_f32_32x32x16_bf16 v[48:63], v[28:31], v[140:143], v[48:63]
    s_add_u32 s12, s32, 4718720
    s_add_u32 m0, s81, 139296
    s_nop 0
    buffer_load_dwordx4 v0, s[36:39], s12 offen lds
    v_exp_f32 v17, v17
    v_exp_f32 v18, v18
    v_exp_f32 v19, v19
    ds_read_b64_tr_b16 v[24:25], v5 offset:24576
    ds_read_b64_tr_b16 v[26:27], v5 offset:24832
    s_waitcnt lgkmcnt(8)
    v_mfma_f32_32x32x16_bf16 v[48:63], v[32:35], v[144:147], v[48:63]
    v_mul_f32 v68, v68, v76
    v_mul_f32 v69, v69, v77
    v_mul_f32 v70, v70, v78
    ds_read_b64_tr_b16 v[28:29], v5 offset:26624
    ds_read_b64_tr_b16 v[30:31], v5 offset:26880
    s_waitcnt lgkmcnt(8)
    v_mfma_f32_32x32x16_bf16 v[48:63], v[36:39], v[148:151], v[48:63]
    v_mul_f32 v71, v71, v79
    v_add_f32 v16, 1.0, v16
    v_add_f32 v17, 1.0, v17
    ds_read_b64_tr_b16 v[32:33], v5 offset:28672
    ds_read_b64_tr_b16 v[34:35], v5 offset:28928
    s_waitcnt lgkmcnt(8)
    v_mfma_f32_32x32x16_bf16 v[48:63], v[40:43], v[152:155], v[48:63]
    v_add_f32 v18, 1.0, v18
    v_add_f32 v19, 1.0, v19
    v_rcp_f32 v16, v16
    ds_read_b64_tr_b16 v[36:37], v5 offset:30720
    ds_read_b64_tr_b16 v[38:39], v5 offset:30976
    s_waitcnt lgkmcnt(8)
    v_mfma_f32_32x32x16_bf16 v[48:63], v[44:47], v[156:159], v[48:63]
    v_rcp_f32 v17, v17
    v_rcp_f32 v18, v18
    v_rcp_f32 v19, v19
    ds_read_b64_tr_b16 v[40:41], v5 offset:32768
    ds_read_b64_tr_b16 v[42:43], v5 offset:33024
    s_waitcnt lgkmcnt(8)
    v_mfma_f32_32x32x16_bf16 v[48:63], v[24:27], v[160:163], v[48:63]
    s_nop 0
    v_mul_f32 v68, v68, v16
    v_mul_f32 v69, v69, v17
    ds_read_b64_tr_b16 v[44:45], v5 offset:34816
    ds_read_b64_tr_b16 v[46:47], v5 offset:35072
    s_waitcnt lgkmcnt(8)
    v_mfma_f32_32x32x16_bf16 v[48:63], v[28:31], v[164:167], v[48:63]
    v_mul_f32 v70, v70, v18
    v_mul_f32 v71, v71, v19
    v_cvt_pk_bf16_f32 v22, v68, v69
    ds_read_b64_tr_b16 v[24:25], v6 offset:0
    ds_read_b64_tr_b16 v[26:27], v6 offset:256
    s_waitcnt lgkmcnt(8)
    v_mfma_f32_32x32x16_bf16 v[48:63], v[32:35], v[168:171], v[48:63]
    v_cvt_pk_bf16_f32 v23, v70, v71
    buffer_store_dwordx4 v[20:23], v3, s[48:51], s43 offen offset:1024 sc1
    ds_read_b64_tr_b16 v[28:29], v6 offset:2048
    ds_read_b64_tr_b16 v[30:31], v6 offset:2304
    s_waitcnt lgkmcnt(8)
    v_mfma_f32_32x32x16_bf16 v[48:63], v[36:39], v[172:175], v[48:63]
    v_mul_f32 v16, v80, v80
    v_mul_f32 v17, v81, v81
    v_mul_f32 v18, v82, v82
    ds_read_b64_tr_b16 v[32:33], v6 offset:4096
    ds_read_b64_tr_b16 v[34:35], v6 offset:4352
    s_waitcnt lgkmcnt(8)
    v_mfma_f32_32x32x16_bf16 v[48:63], v[40:43], v[176:179], v[48:63]
    v_mul_f32 v19, v83, v83
    v_fma_f32 v16, v16, s42, v11
    v_fma_f32 v17, v17, s42, v11
    ds_read_b64_tr_b16 v[36:37], v6 offset:6144
    ds_read_b64_tr_b16 v[38:39], v6 offset:6400
    s_waitcnt lgkmcnt(8)
    v_mfma_f32_32x32x16_bf16 v[48:63], v[44:47], v[180:183], v[48:63]
    v_fma_f32 v18, v18, s42, v11
    v_fma_f32 v19, v19, s42, v11
    v_mul_f32 v16, v16, v80
    ds_read_b64_tr_b16 v[40:41], v6 offset:8192
    ds_read_b64_tr_b16 v[42:43], v6 offset:8448
    s_waitcnt lgkmcnt(8)
    v_mfma_f32_32x32x16_bf16 v[48:63], v[24:27], v[184:187], v[48:63]
    v_mul_f32 v17, v17, v81
    v_mul_f32 v18, v18, v82
    v_mul_f32 v19, v19, v83
    ds_read_b64_tr_b16 v[44:45], v6 offset:10240
    ds_read_b64_tr_b16 v[46:47], v6 offset:10496
    s_waitcnt lgkmcnt(8)
    v_mfma_f32_32x32x16_bf16 v[48:63], v[28:31], v[188:191], v[48:63]
    v_exp_f32 v16, v16
    v_exp_f32 v17, v17
    v_exp_f32 v18, v18
    ds_read_b64_tr_b16 v[24:25], v5 offset:32
    ds_read_b64_tr_b16 v[26:27], v5 offset:288
    s_waitcnt lgkmcnt(8)
    v_mfma_f32_32x32x16_bf16 v[48:63], v[32:35], v[192:195], v[48:63]
    v_exp_f32 v19, v19
    v_mul_f32 v80, v80, v88
    v_mul_f32 v81, v81, v89
    ds_read_b64_tr_b16 v[28:29], v5 offset:2080
    ds_read_b64_tr_b16 v[30:31], v5 offset:2336
    s_waitcnt lgkmcnt(8)
    v_mfma_f32_32x32x16_bf16 v[48:63], v[36:39], v[196:199], v[48:63]
    v_mul_f32 v82, v82, v90
    v_mul_f32 v83, v83, v91
    v_add_f32 v16, 1.0, v16
    ds_read_b64_tr_b16 v[32:33], v5 offset:4128
    ds_read_b64_tr_b16 v[34:35], v5 offset:4384
    s_waitcnt lgkmcnt(8)
    v_mfma_f32_32x32x16_bf16 v[48:63], v[40:43], v[200:203], v[48:63]
    v_add_f32 v17, 1.0, v17
    v_add_f32 v18, 1.0, v18
    v_add_f32 v19, 1.0, v19
    ds_read_b64_tr_b16 v[36:37], v5 offset:6176
    ds_read_b64_tr_b16 v[38:39], v5 offset:6432
    s_waitcnt lgkmcnt(8)
    v_mfma_f32_32x32x16_bf16 v[48:63], v[44:47], v[204:207], v[48:63]
    v_rcp_f32 v16, v16
    v_rcp_f32 v17, v17
    v_rcp_f32 v18, v18
    ds_read_b64_tr_b16 v[40:41], v5 offset:8224
    ds_read_b64_tr_b16 v[42:43], v5 offset:8480
    s_waitcnt lgkmcnt(8)
    v_mfma_f32_32x32x16_bf16 v[64:79], v[24:27], v[112:115], 0
    v_rcp_f32 v19, v19
    s_nop 0
    v_mul_f32 v80, v80, v16
    ds_read_b64_tr_b16 v[44:45], v5 offset:10272
    ds_read_b64_tr_b16 v[46:47], v5 offset:10528
    s_waitcnt lgkmcnt(8)
    v_mfma_f32_32x32x16_bf16 v[64:79], v[28:31], v[116:119], v[64:79]
    v_mul_f32 v81, v81, v17
    v_mul_f32 v82, v82, v18
    v_mul_f32 v83, v83, v19
    ds_read_b64_tr_b16 v[24:25], v5 offset:12320
    ds_read_b64_tr_b16 v[26:27], v5 offset:12576
    s_waitcnt lgkmcnt(8)
    v_mfma_f32_32x32x16_bf16 v[64:79], v[32:35], v[120:123], v[64:79]
    v_cvt_pk_bf16_f32 v20, v80, v81
    v_cvt_pk_bf16_f32 v21, v82, v83
    v_mul_f32 v16, v84, v84
    ds_read_b64_tr_b16 v[28:29], v5 offset:14368
    ds_read_b64_tr_b16 v[30:31], v5 offset:14624
    s_waitcnt lgkmcnt(8)
    v_mfma_f32_32x32x16_bf16 v[64:79], v[36:39], v[124:127], v[64:79]
    v_mul_f32 v17, v85, v85
    v_mul_f32 v18, v86, v86
    v_mul_f32 v19, v87, v87
    ds_read_b64_tr_b16 v[32:33], v5 offset:16416
    ds_read_b64_tr_b16 v[34:35], v5 offset:16672
    s_waitcnt lgkmcnt(8)
    v_mfma_f32_32x32x16_bf16 v[64:79], v[40:43], v[128:131], v[64:79]
    v_fma_f32 v16, v16, s42, v11
    v_fma_f32 v17, v17, s42, v11
    v_fma_f32 v18, v18, s42, v11
    ds_read_b64_tr_b16 v[36:37], v5 offset:18464
    ds_read_b64_tr_b16 v[38:39], v5 offset:18720
    s_waitcnt lgkmcnt(8)
    v_mfma_f32_32x32x16_bf16 v[64:79], v[44:47], v[132:135], v[64:79]
    v_fma_f32 v19, v19, s42, v11
    v_mul_f32 v16, v16, v84
    v_mul_f32 v17, v17, v85
    ds_read_b64_tr_b16 v[40:41], v5 offset:20512
    ds_read_b64_tr_b16 v[42:43], v5 offset:20768
    s_waitcnt lgkmcnt(8)
    v_mfma_f32_32x32x16_bf16 v[64:79], v[24:27], v[136:139], v[64:79]
    v_mul_f32 v18, v18, v86
    v_mul_f32 v19, v19, v87
    v_exp_f32 v16, v16
    ds_read_b64_tr_b16 v[44:45], v5 offset:22560
    ds_read_b64_tr_b16 v[46:47], v5 offset:22816
    s_waitcnt lgkmcnt(8)
    v_mfma_f32_32x32x16_bf16 v[64:79], v[28:31], v[140:143], v[64:79]
    v_exp_f32 v17, v17
    v_exp_f32 v18, v18
    v_exp_f32 v19, v19
    ds_read_b64_tr_b16 v[24:25], v5 offset:24608
    ds_read_b64_tr_b16 v[26:27], v5 offset:24864
    s_waitcnt lgkmcnt(8)
    v_mfma_f32_32x32x16_bf16 v[64:79], v[32:35], v[144:147], v[64:79]
    v_mul_f32 v84, v84, v92
    v_mul_f32 v85, v85, v93
    v_mul_f32 v86, v86, v94
    ds_read_b64_tr_b16 v[28:29], v5 offset:26656
    ds_read_b64_tr_b16 v[30:31], v5 offset:26912
    s_waitcnt lgkmcnt(8)
    v_mfma_f32_32x32x16_bf16 v[64:79], v[36:39], v[148:151], v[64:79]
    v_mul_f32 v87, v87, v95
    v_add_f32 v16, 1.0, v16
    v_add_f32 v17, 1.0, v17
    ds_read_b64_tr_b16 v[32:33], v5 offset:28704
    ds_read_b64_tr_b16 v[34:35], v5 offset:28960
    s_waitcnt lgkmcnt(8)
    v_mfma_f32_32x32x16_bf16 v[64:79], v[40:43], v[152:155], v[64:79]
    v_add_f32 v18, 1.0, v18
    v_add_f32 v19, 1.0, v19
    v_rcp_f32 v16, v16
    ds_read_b64_tr_b16 v[36:37], v5 offset:30752
    ds_read_b64_tr_b16 v[38:39], v5 offset:31008
    s_waitcnt lgkmcnt(8)
    v_mfma_f32_32x32x16_bf16 v[64:79], v[44:47], v[156:159], v[64:79]
    v_rcp_f32 v17, v17
    v_rcp_f32 v18, v18
    v_rcp_f32 v19, v19
    ds_read_b64_tr_b16 v[40:41], v5 offset:32800
    ds_read_b64_tr_b16 v[42:43], v5 offset:33056
    s_waitcnt lgkmcnt(8)
    v_mfma_f32_32x32x16_bf16 v[64:79], v[24:27], v[160:163], v[64:79]
    s_nop 0
    v_mul_f32 v84, v84, v16
    v_mul_f32 v85, v85, v17
    ds_read_b64_tr_b16 v[44:45], v5 offset:34848
    ds_read_b64_tr_b16 v[46:47], v5 offset:35104
    s_waitcnt lgkmcnt(8)
    v_mfma_f32_32x32x16_bf16 v[64:79], v[28:31], v[164:167], v[64:79]
    v_mul_f32 v86, v86, v18
    v_mul_f32 v87, v87, v19
    v_cvt_pk_bf16_f32 v22, v84, v85
    ds_read_b64_tr_b16 v[24:25], v6 offset:32
    ds_read_b64_tr_b16 v[26:27], v6 offset:288
    s_waitcnt lgkmcnt(8)
    v_mfma_f32_32x32x16_bf16 v[64:79], v[32:35], v[168:171], v[64:79]
    v_cvt_pk_bf16_f32 v23, v86, v87
    buffer_store_dwordx4 v[20:23], v3, s[48:51], s43 offen offset:2048 sc1
    ds_read_b64_tr_b16 v[28:29], v6 offset:2080
    ds_read_b64_tr_b16 v[30:31], v6 offset:2336
    s_waitcnt lgkmcnt(8)
    v_mfma_f32_32x32x16_bf16 v[64:79], v[36:39], v[172:175], v[64:79]
    v_mul_f32 v16, v96, v96
    v_mul_f32 v17, v97, v97
    v_mul_f32 v18, v98, v98
    ds_read_b64_tr_b16 v[32:33], v6 offset:4128
    ds_read_b64_tr_b16 v[34:35], v6 offset:4384
    s_waitcnt lgkmcnt(8)
    v_mfma_f32_32x32x16_bf16 v[64:79], v[40:43], v[176:179], v[64:79]
    v_mul_f32 v19, v99, v99
    v_fma_f32 v16, v16, s42, v11
    v_fma_f32 v17, v17, s42, v11
    ds_read_b64_tr_b16 v[36:37], v6 offset:6176
    ds_read_b64_tr_b16 v[38:39], v6 offset:6432
    s_waitcnt lgkmcnt(8)
    v_mfma_f32_32x32x16_bf16 v[64:79], v[44:47], v[180:183], v[64:79]
    v_fma_f32 v18, v18, s42, v11
    v_fma_f32 v19, v19, s42, v11
    v_mul_f32 v16, v16, v96
    ds_read_b64_tr_b16 v[40:41], v6 offset:8224
    ds_read_b64_tr_b16 v[42:43], v6 offset:8480
    s_waitcnt lgkmcnt(8)
    v_mfma_f32_32x32x16_bf16 v[64:79], v[24:27], v[184:187], v[64:79]
    v_mul_f32 v17, v17, v97
    v_mul_f32 v18, v18, v98
    v_mul_f32 v19, v19, v99
    ds_read_b64_tr_b16 v[44:45], v6 offset:10272
    ds_read_b64_tr_b16 v[46:47], v6 offset:10528
    s_waitcnt lgkmcnt(8)
    v_mfma_f32_32x32x16_bf16 v[64:79], v[28:31], v[188:191], v[64:79]
    v_exp_f32 v16, v16
    v_exp_f32 v17, v17
    v_exp_f32 v18, v18
    s_waitcnt vmcnt(2)
    s_barrier
    s_cmp_lg_u32 s7, 1
    s_cbranch_scc1 NOFLAG_9
    s_lshl_b32 s14, s6, 5
    s_add_u32 s14, s14, s5
    s_lshl_b32 s14, s14, 2
    s_add_u32 s14, s14, 65015808
    v_mov_b32 v2, s15
    s_mov_b64 exec, 1
    buffer_store_dword v2, off, s[48:51], s14 sc1
    s_mov_b64 exec, -1
NOFLAG_9:
    ds_read_b64_tr_b16 v[24:25], v6 offset:12288
    ds_read_b64_tr_b16 v[26:27], v6 offset:12544
    s_waitcnt lgkmcnt(8)
    v_mfma_f32_32x32x16_bf16 v[64:79], v[32:35], v[192:195], v[64:79]
    v_exp_f32 v19, v19
    v_mul_f32 v96, v96, v104
    v_mul_f32 v97, v97, v105
    ds_read_b64_tr_b16 v[28:29], v6 offset:14336
    ds_read_b64_tr_b16 v[30:31], v6 offset:14592
    s_waitcnt lgkmcnt(8)
    v_mfma_f32_32x32x16_bf16 v[64:79], v[36:39], v[196:199], v[64:79]
    v_mul_f32 v98, v98, v106
    v_mul_f32 v99, v99, v107
    v_add_f32 v16, 1.0, v16
    ds_read_b64_tr_b16 v[32:33], v6 offset:16384
    ds_read_b64_tr_b16 v[34:35], v6 offset:16640
    s_waitcnt lgkmcnt(8)
    v_mfma_f32_32x32x16_bf16 v[64:79], v[40:43], v[200:203], v[64:79]
    v_add_f32 v17, 1.0, v17
    v_add_f32 v18, 1.0, v18
    v_add_f32 v19, 1.0, v19
    ds_read_b64_tr_b16 v[36:37], v6 offset:18432
    ds_read_b64_tr_b16 v[38:39], v6 offset:18688
    s_waitcnt lgkmcnt(8)
    v_mfma_f32_32x32x16_bf16 v[64:79], v[44:47], v[204:207], v[64:79]
    v_rcp_f32 v16, v16
    v_rcp_f32 v17, v17
    v_rcp_f32 v18, v18
    ds_read_b64_tr_b16 v[40:41], v6 offset:20480
    ds_read_b64_tr_b16 v[42:43], v6 offset:20736
    s_waitcnt lgkmcnt(8)
    v_mfma_f32_32x32x16_bf16 v[48:63], v[24:27], v[208:211], v[48:63]
    v_rcp_f32 v19, v19
    s_nop 0
    v_mul_f32 v96, v96, v16
    ds_read_b64_tr_b16 v[44:45], v6 offset:22528
    ds_read_b64_tr_b16 v[46:47], v6 offset:22784
    s_waitcnt lgkmcnt(8)
    v_mfma_f32_32x32x16_bf16 v[48:63], v[28:31], v[212:215], v[48:63]
    v_mul_f32 v97, v97, v17
    v_mul_f32 v98, v98, v18
    v_mul_f32 v99, v99, v19
    ds_read_b64_tr_b16 v[24:25], v6 offset:24576
    ds_read_b64_tr_b16 v[26:27], v6 offset:24832
    s_waitcnt lgkmcnt(8)
    v_mfma_f32_32x32x16_bf16 v[48:63], v[32:35], v[216:219], v[48:63]
    v_cvt_pk_bf16_f32 v20, v96, v97
    v_cvt_pk_bf16_f32 v21, v98, v99
    v_mul_f32 v16, v100, v100
    ds_read_b64_tr_b16 v[28:29], v6 offset:26624
    ds_read_b64_tr_b16 v[30:31], v6 offset:26880
    s_waitcnt lgkmcnt(8)
    v_mfma_f32_32x32x16_bf16 v[48:63], v[36:39], v[220:223], v[48:63]
    v_mul_f32 v17, v101, v101
    v_mul_f32 v18, v102, v102
    v_mul_f32 v19, v103, v103
    ds_read_b64_tr_b16 v[32:33], v6 offset:28672
    ds_read_b64_tr_b16 v[34:35], v6 offset:28928
    s_waitcnt lgkmcnt(8)
    v_mfma_f32_32x32x16_bf16 v[48:63], v[40:43], v[224:227], v[48:63]
    v_fma_f32 v16, v16, s42, v11
    v_fma_f32 v17, v17, s42, v11
    v_fma_f32 v18, v18, s42, v11
    ds_read_b64_tr_b16 v[36:37], v6 offset:30720
    ds_read_b64_tr_b16 v[38:39], v6 offset:30976
    s_waitcnt lgkmcnt(8)
    v_mfma_f32_32x32x16_bf16 v[48:63], v[44:47], v[228:231], v[48:63]
    v_fma_f32 v19, v19, s42, v11
    v_mul_f32 v16, v16, v100
    v_mul_f32 v17, v17, v101
    ds_read_b64_tr_b16 v[40:41], v6 offset:32768
    ds_read_b64_tr_b16 v[42:43], v6 offset:33024
    s_waitcnt lgkmcnt(8)
    v_mfma_f32_32x32x16_bf16 v[48:63], v[24:27], v[232:235], v[48:63]
    v_mul_f32 v18, v18, v102
    v_mul_f32 v19, v19, v103
    v_exp_f32 v16, v16
    ds_read_b64_tr_b16 v[44:45], v6 offset:34816
    ds_read_b64_tr_b16 v[46:47], v6 offset:35072
    s_waitcnt lgkmcnt(8)
    v_mfma_f32_32x32x16_bf16 v[48:63], v[28:31], v[236:239], v[48:63]
    v_exp_f32 v17, v17
    v_exp_f32 v18, v18
    v_exp_f32 v19, v19
    ds_read_b64_tr_b16 v[24:25], v6 offset:12320
    ds_read_b64_tr_b16 v[26:27], v6 offset:12576
    s_waitcnt lgkmcnt(8)
    v_mfma_f32_32x32x16_bf16 v[48:63], v[32:35], v[240:243], v[48:63]
    v_mul_f32 v100, v100, v108
    v_mul_f32 v101, v101, v109
    v_mul_f32 v102, v102, v110
    ds_read_b64_tr_b16 v[28:29], v6 offset:14368
    ds_read_b64_tr_b16 v[30:31], v6 offset:14624
    s_waitcnt lgkmcnt(8)
    v_mfma_f32_32x32x16_bf16 v[48:63], v[36:39], v[244:247], v[48:63]
    v_mul_f32 v103, v103, v111
    v_add_f32 v16, 1.0, v16
    v_add_f32 v17, 1.0, v17
    ds_read_b64_tr_b16 v[32:33], v6 offset:16416
    ds_read_b64_tr_b16 v[34:35], v6 offset:16672
    s_waitcnt lgkmcnt(8)
    v_mfma_f32_32x32x16_bf16 v[48:63], v[40:43], v[248:251], v[48:63]
    v_add_f32 v18, 1.0, v18
    v_add_f32 v19, 1.0, v19
    v_rcp_f32 v16, v16
    ds_read_b64_tr_b16 v[36:37], v6 offset:18464
    ds_read_b64_tr_b16 v[38:39], v6 offset:18720
    s_waitcnt lgkmcnt(8)
    v_mfma_f32_32x32x16_bf16 v[48:63], v[44:47], v[252:255], v[48:63]
    v_rcp_f32 v17, v17
    v_rcp_f32 v18, v18
    v_rcp_f32 v19, v19
    ds_read_b64_tr_b16 v[40:41], v6 offset:20512
    ds_read_b64_tr_b16 v[42:43], v6 offset:20768
    s_waitcnt lgkmcnt(8)
    v_mfma_f32_32x32x16_bf16 v[64:79], v[24:27], v[208:211], v[64:79]
    s_nop 0
    v_mul_f32 v100, v100, v16
    v_mul_f32 v101, v101, v17
    ds_read_b64_tr_b16 v[44:45], v6 offset:22560
    ds_read_b64_tr_b16 v[46:47], v6 offset:22816
    s_waitcnt lgkmcnt(8)
    v_mfma_f32_32x32x16_bf16 v[64:79], v[28:31], v[212:215], v[64:79]
    v_mul_f32 v102, v102, v18
    v_mul_f32 v103, v103, v19
    v_cvt_pk_bf16_f32 v22, v100, v101
    ds_read_b64_tr_b16 v[24:25], v6 offset:24608
    ds_read_b64_tr_b16 v[26:27], v6 offset:24864
    s_waitcnt lgkmcnt(8)
    v_mfma_f32_32x32x16_bf16 v[64:79], v[32:35], v[216:219], v[64:79]
    v_cvt_pk_bf16_f32 v23, v102, v103
    buffer_store_dwordx4 v[20:23], v3, s[48:51], s43 offen offset:3072 sc1
    ds_read_b64_tr_b16 v[28:29], v6 offset:26656
    ds_read_b64_tr_b16 v[30:31], v6 offset:26912
    s_waitcnt lgkmcnt(8)
    v_mfma_f32_32x32x16_bf16 v[64:79], v[36:39], v[220:223], v[64:79]
    v_mul_f32 v16, v48, v48
    v_mul_f32 v17, v49, v49
    v_mul_f32 v18, v50, v50
    ds_read_b64_tr_b16 v[32:33], v6 offset:28704
    ds_read_b64_tr_b16 v[34:35], v6 offset:28960
    s_waitcnt lgkmcnt(8)
    v_mfma_f32_32x32x16_bf16 v[64:79], v[40:43], v[224:227], v[64:79]
    v_mul_f32 v19, v51, v51
    v_fma_f32 v16, v16, s42, v11
    v_fma_f32 v17, v17, s42, v11
    ds_read_b64_tr_b16 v[36:37], v6 offset:30752
    ds_read_b64_tr_b16 v[38:39], v6 offset:31008
    s_waitcnt lgkmcnt(8)
    v_mfma_f32_32x32x16_bf16 v[64:79], v[44:47], v[228:231], v[64:79]
    v_fma_f32 v18, v18, s42, v11
    v_fma_f32 v19, v19, s42, v11
    v_mul_f32 v16, v16, v48
    ds_read_b64_tr_b16 v[40:41], v6 offset:32800
    ds_read_b64_tr_b16 v[42:43], v6 offset:33056
    s_waitcnt lgkmcnt(8)
    v_mfma_f32_32x32x16_bf16 v[64:79], v[24:27], v[232:235], v[64:79]
    v_mul_f32 v17, v17, v49
    v_mul_f32 v18, v18, v50
    v_mul_f32 v19, v19, v51
    ds_read_b64_tr_b16 v[44:45], v6 offset:34848
    ds_read_b64_tr_b16 v[46:47], v6 offset:35104
    s_waitcnt lgkmcnt(8)
    v_mfma_f32_32x32x16_bf16 v[64:79], v[28:31], v[236:239], v[64:79]
    v_exp_f32 v16, v16
    v_exp_f32 v17, v17
    v_exp_f32 v18, v18
    ds_read_b64_tr_b16 v[24:25], v5 offset:512
    ds_read_b64_tr_b16 v[26:27], v5 offset:768
    s_waitcnt lgkmcnt(8)
    v_mfma_f32_32x32x16_bf16 v[64:79], v[32:35], v[240:243], v[64:79]
    v_exp_f32 v19, v19
    v_mul_f32 v48, v48, v56
    v_mul_f32 v49, v49, v57
    ds_read_b64_tr_b16 v[28:29], v5 offset:2560
    ds_read_b64_tr_b16 v[30:31], v5 offset:2816
    s_waitcnt lgkmcnt(8)
    v_mfma_f32_32x32x16_bf16 v[64:79], v[36:39], v[244:247], v[64:79]
    v_mul_f32 v50, v50, v58
    v_mul_f32 v51, v51, v59
    v_add_f32 v16, 1.0, v16
    ds_read_b64_tr_b16 v[32:33], v5 offset:4608
    ds_read_b64_tr_b16 v[34:35], v5 offset:4864
    s_waitcnt lgkmcnt(8)
    v_mfma_f32_32x32x16_bf16 v[64:79], v[40:43], v[248:251], v[64:79]
    v_add_f32 v17, 1.0, v17
    v_add_f32 v18, 1.0, v18
    v_add_f32 v19, 1.0, v19
    ds_read_b64_tr_b16 v[36:37], v5 offset:6656
    ds_read_b64_tr_b16 v[38:39], v5 offset:6912
    s_waitcnt lgkmcnt(8)
    v_mfma_f32_32x32x16_bf16 v[64:79], v[44:47], v[252:255], v[64:79]
    v_rcp_f32 v16, v16
    v_rcp_f32 v17, v17
    v_rcp_f32 v18, v18
    ds_read_b64_tr_b16 v[40:41], v5 offset:8704
    ds_read_b64_tr_b16 v[42:43], v5 offset:8960
    s_waitcnt lgkmcnt(8)
    v_mfma_f32_32x32x16_bf16 v[80:95], v[24:27], v[112:115], 0
    v_rcp_f32 v19, v19
    s_nop 0
    v_mul_f32 v48, v48, v16
    ds_read_b64_tr_b16 v[44:45], v5 offset:10752
    ds_read_b64_tr_b16 v[46:47], v5 offset:11008
    s_waitcnt lgkmcnt(8)
    v_mfma_f32_32x32x16_bf16 v[80:95], v[28:31], v[116:119], v[80:95]
    v_mul_f32 v49, v49, v17
    v_mul_f32 v50, v50, v18
    v_mul_f32 v51, v51, v19
    ds_read_b64_tr_b16 v[24:25], v5 offset:12800
    ds_read_b64_tr_b16 v[26:27], v5 offset:13056
    s_waitcnt lgkmcnt(8)
    v_mfma_f32_32x32x16_bf16 v[80:95], v[32:35], v[120:123], v[80:95]
    v_cvt_pk_bf16_f32 v20, v48, v49
    v_cvt_pk_bf16_f32 v21, v50, v51
    v_mul_f32 v16, v52, v52
    ds_read_b64_tr_b16 v[28:29], v5 offset:14848
    ds_read_b64_tr_b16 v[30:31], v5 offset:15104
    s_waitcnt lgkmcnt(8)
    v_mfma_f32_32x32x16_bf16 v[80:95], v[36:39], v[124:127], v[80:95]
    v_mul_f32 v17, v53, v53
    v_mul_f32 v18, v54, v54
    v_mul_f32 v19, v55, v55
    ds_read_b64_tr_b16 v[32:33], v5 offset:16896
    ds_read_b64_tr_b16 v[34:35], v5 offset:17152
    s_waitcnt lgkmcnt(8)
    v_mfma_f32_32x32x16_bf16 v[80:95], v[40:43], v[128:131], v[80:95]
    v_fma_f32 v16, v16, s42, v11
    v_fma_f32 v17, v17, s42, v11
    v_fma_f32 v18, v18, s42, v11
    ds_read_b64_tr_b16 v[36:37], v5 offset:18944
    ds_read_b64_tr_b16 v[38:39], v5 offset:19200
    s_waitcnt lgkmcnt(8)
    v_mfma_f32_32x32x16_bf16 v[80:95], v[44:47], v[132:135], v[80:95]
    v_fma_f32 v19, v19, s42, v11
    v_mul_f32 v16, v16, v52
    v_mul_f32 v17, v17, v53
    ds_read_b64_tr_b16 v[40:41], v5 offset:20992
    ds_read_b64_tr_b16 v[42:43], v5 offset:21248
    s_waitcnt lgkmcnt(8)
    v_mfma_f32_32x32x16_bf16 v[80:95], v[24:27], v[136:139], v[80:95]
    v_mul_f32 v18, v18, v54
    v_mul_f32 v19, v19, v55
    v_exp_f32 v16, v16
    ds_read_b64_tr_b16 v[44:45], v5 offset:23040
    ds_read_b64_tr_b16 v[46:47], v5 offset:23296
    s_waitcnt lgkmcnt(8)
    v_mfma_f32_32x32x16_bf16 v[80:95], v[28:31], v[140:143], v[80:95]
    v_exp_f32 v17, v17
    v_exp_f32 v18, v18
    v_exp_f32 v19, v19
    ds_read_b64_tr_b16 v[24:25], v5 offset:25088
    ds_read_b64_tr_b16 v[26:27], v5 offset:25344
    s_waitcnt lgkmcnt(8)
    v_mfma_f32_32x32x16_bf16 v[80:95], v[32:35], v[144:147], v[80:95]
    v_mul_f32 v52, v52, v60
    v_mul_f32 v53, v53, v61
    v_mul_f32 v54, v54, v62
    ds_read_b64_tr_b16 v[28:29], v5 offset:27136
    ds_read_b64_tr_b16 v[30:31], v5 offset:27392
    s_waitcnt lgkmcnt(8)
    v_mfma_f32_32x32x16_bf16 v[80:95], v[36:39], v[148:151], v[80:95]
    v_mul_f32 v55, v55, v63
    v_add_f32 v16, 1.0, v16
    v_add_f32 v17, 1.0, v17
    ds_read_b64_tr_b16 v[32:33], v5 offset:29184
    ds_read_b64_tr_b16 v[34:35], v5 offset:29440
    s_waitcnt lgkmcnt(8)
    v_mfma_f32_32x32x16_bf16 v[80:95], v[40:43], v[152:155], v[80:95]
    v_add_f32 v18, 1.0, v18
    v_add_f32 v19, 1.0, v19
    v_rcp_f32 v16, v16
    ds_read_b64_tr_b16 v[36:37], v5 offset:31232
    ds_read_b64_tr_b16 v[38:39], v5 offset:31488
    s_waitcnt lgkmcnt(8)
    v_mfma_f32_32x32x16_bf16 v[80:95], v[44:47], v[156:159], v[80:95]
    v_rcp_f32 v17, v17
    v_rcp_f32 v18, v18
    v_rcp_f32 v19, v19
    ds_read_b64_tr_b16 v[40:41], v5 offset:33280
    ds_read_b64_tr_b16 v[42:43], v5 offset:33536
    s_waitcnt lgkmcnt(8)
    v_mfma_f32_32x32x16_bf16 v[80:95], v[24:27], v[160:163], v[80:95]
    s_nop 0
    v_mul_f32 v52, v52, v16
    v_mul_f32 v53, v53, v17
    ds_read_b64_tr_b16 v[44:45], v5 offset:35328
    ds_read_b64_tr_b16 v[46:47], v5 offset:35584
    s_waitcnt lgkmcnt(8)
    v_mfma_f32_32x32x16_bf16 v[80:95], v[28:31], v[164:167], v[80:95]
    v_mul_f32 v54, v54, v18
    v_mul_f32 v55, v55, v19
    v_cvt_pk_bf16_f32 v22, v52, v53
    ds_read_b64_tr_b16 v[24:25], v6 offset:512
    ds_read_b64_tr_b16 v[26:27], v6 offset:768
    s_waitcnt lgkmcnt(8)
    v_mfma_f32_32x32x16_bf16 v[80:95], v[32:35], v[168:171], v[80:95]
    v_cvt_pk_bf16_f32 v23, v54, v55
    s_add_u32 s12, s43, 4096
    buffer_store_dwordx4 v[20:23], v3, s[48:51], s12 offen offset:0 sc1
    ds_read_b64_tr_b16 v[28:29], v6 offset:2560
    ds_read_b64_tr_b16 v[30:31], v6 offset:2816
    s_waitcnt lgkmcnt(8)
    v_mfma_f32_32x32x16_bf16 v[80:95], v[36:39], v[172:175], v[80:95]
    v_mul_f32 v16, v64, v64
    v_mul_f32 v17, v65, v65
    v_mul_f32 v18, v66, v66
    s_waitcnt vmcnt(1)
    s_barrier
    s_cmp_lg_u32 s7, 0
    s_cbranch_scc1 NOFLAG_10
    s_add_u32 s14, s34, 0
    v_mov_b32 v2, s15
    s_mov_b64 exec, 1
    buffer_store_dword v2, off, s[48:51], s14 sc1
    s_mov_b64 exec, -1
NOFLAG_10:
    ds_read_b64_tr_b16 v[32:33], v6 offset:4608
    ds_read_b64_tr_b16 v[34:35], v6 offset:4864
    s_waitcnt lgkmcnt(8)
    v_mfma_f32_32x32x16_bf16 v[80:95], v[40:43], v[176:179], v[80:95]
    v_mul_f32 v19, v67, v67
    v_fma_f32 v16, v16, s42, v11
    v_fma_f32 v17, v17, s42, v11
    ds_read_b64_tr_b16 v[36:37], v6 offset:6656
    ds_read_b64_tr_b16 v[38:39], v6 offset:6912
    s_waitcnt lgkmcnt(8)
    v_mfma_f32_32x32x16_bf16 v[80:95], v[44:47], v[180:183], v[80:95]
    v_fma_f32 v18, v18, s42, v11
    v_fma_f32 v19, v19, s42, v11
    v_mul_f32 v16, v16, v64
    ds_read_b64_tr_b16 v[40:41], v6 offset:8704
    ds_read_b64_tr_b16 v[42:43], v6 offset:8960
    s_waitcnt lgkmcnt(8)
    v_mfma_f32_32x32x16_bf16 v[80:95], v[24:27], v[184:187], v[80:95]
    v_mul_f32 v17, v17, v65
    v_mul_f32 v18, v18, v66
    v_mul_f32 v19, v19, v67
    ds_read_b64_tr_b16 v[44:45], v6 offset:10752
    ds_read_b64_tr_b16 v[46:47], v6 offset:11008
    s_waitcnt lgkmcnt(8)
    v_mfma_f32_32x32x16_bf16 v[80:95], v[28:31], v[188:191], v[80:95]
    v_exp_f32 v16, v16
    v_exp_f32 v17, v17
    v_exp_f32 v18, v18
    ds_read_b64_tr_b16 v[24:25], v5 offset:544
    ds_read_b64_tr_b16 v[26:27], v5 offset:800
    s_waitcnt lgkmcnt(8)
    v_mfma_f32_32x32x16_bf16 v[80:95], v[32:35], v[192:195], v[80:95]
    v_exp_f32 v19, v19
    v_mul_f32 v64, v64, v72
    v_mul_f32 v65, v65, v73
    ds_read_b64_tr_b16 v[28:29], v5 offset:2592
    ds_read_b64_tr_b16 v[30:31], v5 offset:2848
    s_waitcnt lgkmcnt(8)
    v_mfma_f32_32x32x16_bf16 v[80:95], v[36:39], v[196:199], v[80:95]
    v_mul_f32 v66, v66, v74
    v_mul_f32 v67, v67, v75
    v_add_f32 v16, 1.0, v16
    ds_read_b64_tr_b16 v[32:33], v5 offset:4640
    ds_read_b64_tr_b16 v[34:35], v5 offset:4896
    s_waitcnt lgkmcnt(8)
    v_mfma_f32_32x32x16_bf16 v[80:95], v[40:43], v[200:203], v[80:95]
    v_add_f32 v17, 1.0, v17
    v_add_f32 v18, 1.0, v18
    v_add_f32 v19, 1.0, v19
    ds_read_b64_tr_b16 v[36:37], v5 offset:6688
    ds_read_b64_tr_b16 v[38:39], v5 offset:6944
    s_waitcnt lgkmcnt(8)
    v_mfma_f32_32x32x16_bf16 v[80:95], v[44:47], v[204:207], v[80:95]
    v_rcp_f32 v16, v16
    v_rcp_f32 v17, v17
    v_rcp_f32 v18, v18
    ds_read_b64_tr_b16 v[40:41], v5 offset:8736
    ds_read_b64_tr_b16 v[42:43], v5 offset:8992
    s_waitcnt lgkmcnt(8)
    v_mfma_f32_32x32x16_bf16 v[96:111], v[24:27], v[112:115], 0
    v_rcp_f32 v19, v19
    s_nop 0
    v_mul_f32 v64, v64, v16
    ds_read_b64_tr_b16 v[44:45], v5 offset:10784
    ds_read_b64_tr_b16 v[46:47], v5 offset:11040
    s_waitcnt lgkmcnt(8)
    v_mfma_f32_32x32x16_bf16 v[96:111], v[28:31], v[116:119], v[96:111]
    v_mul_f32 v65, v65, v17
    v_mul_f32 v66, v66, v18
    v_mul_f32 v67, v67, v19
    ds_read_b64_tr_b16 v[24:25], v5 offset:12832
    ds_read_b64_tr_b16 v[26:27], v5 offset:13088
    s_waitcnt lgkmcnt(8)
    v_mfma_f32_32x32x16_bf16 v[96:111], v[32:35], v[120:123], v[96:111]
    v_cvt_pk_bf16_f32 v20, v64, v65
    v_cvt_pk_bf16_f32 v21, v66, v67
    v_mul_f32 v16, v68, v68
    ds_read_b64_tr_b16 v[28:29], v5 offset:14880
    ds_read_b64_tr_b16 v[30:31], v5 offset:15136
    s_waitcnt lgkmcnt(8)
    v_mfma_f32_32x32x16_bf16 v[96:111], v[36:39], v[124:127], v[96:111]
    v_mul_f32 v17, v69, v69
    v_mul_f32 v18, v70, v70
    v_mul_f32 v19, v71, v71
    ds_read_b64_tr_b16 v[32:33], v5 offset:16928
    ds_read_b64_tr_b16 v[34:35], v5 offset:17184
    s_waitcnt lgkmcnt(8)
    v_mfma_f32_32x32x16_bf16 v[96:111], v[40:43], v[128:131], v[96:111]
    v_fma_f32 v16, v16, s42, v11
    v_fma_f32 v17, v17, s42, v11
    v_fma_f32 v18, v18, s42, v11
    ds_read_b64_tr_b16 v[36:37], v5 offset:18976
    ds_read_b64_tr_b16 v[38:39], v5 offset:19232
    s_waitcnt lgkmcnt(8)
    v_mfma_f32_32x32x16_bf16 v[96:111], v[44:47], v[132:135], v[96:111]
    v_fma_f32 v19, v19, s42, v11
    v_mul_f32 v16, v16, v68
    v_mul_f32 v17, v17, v69
    ds_read_b64_tr_b16 v[40:41], v5 offset:21024
    ds_read_b64_tr_b16 v[42:43], v5 offset:21280
    s_waitcnt lgkmcnt(8)
    v_mfma_f32_32x32x16_bf16 v[96:111], v[24:27], v[136:139], v[96:111]
    v_mul_f32 v18, v18, v70
    v_mul_f32 v19, v19, v71
    v_exp_f32 v16, v16
    ds_read_b64_tr_b16 v[44:45], v5 offset:23072
    ds_read_b64_tr_b16 v[46:47], v5 offset:23328
    s_waitcnt lgkmcnt(8)
    v_mfma_f32_32x32x16_bf16 v[96:111], v[28:31], v[140:143], v[96:111]
    v_exp_f32 v17, v17
    v_exp_f32 v18, v18
    v_exp_f32 v19, v19
    ds_read_b64_tr_b16 v[24:25], v5 offset:25120
    ds_read_b64_tr_b16 v[26:27], v5 offset:25376
    s_waitcnt lgkmcnt(8)
    v_mfma_f32_32x32x16_bf16 v[96:111], v[32:35], v[144:147], v[96:111]
    v_mul_f32 v68, v68, v76
    v_mul_f32 v69, v69, v77
    v_mul_f32 v70, v70, v78
    ds_read_b64_tr_b16 v[28:29], v5 offset:27168
    ds_read_b64_tr_b16 v[30:31], v5 offset:27424
    s_waitcnt lgkmcnt(8)
    v_mfma_f32_32x32x16_bf16 v[96:111], v[36:39], v[148:151], v[96:111]
    v_mul_f32 v71, v71, v79
    v_add_f32 v16, 1.0, v16
    v_add_f32 v17, 1.0, v17
    ds_read_b64_tr_b16 v[32:33], v5 offset:29216
    ds_read_b64_tr_b16 v[34:35], v5 offset:29472
    s_waitcnt lgkmcnt(8)
    v_mfma_f32_32x32x16_bf16 v[96:111], v[40:43], v[152:155], v[96:111]
    v_add_f32 v18, 1.0, v18
    v_add_f32 v19, 1.0, v19
    v_rcp_f32 v16, v16
    ds_read_b64_tr_b16 v[36:37], v5 offset:31264
    ds_read_b64_tr_b16 v[38:39], v5 offset:31520
    s_waitcnt lgkmcnt(8)
    v_mfma_f32_32x32x16_bf16 v[96:111], v[44:47], v[156:159], v[96:111]
    v_rcp_f32 v17, v17
    v_rcp_f32 v18, v18
    v_rcp_f32 v19, v19
    s_barrier
    ds_read_b64_tr_b16 v[40:41], v5 offset:33312
    ds_read_b64_tr_b16 v[42:43], v5 offset:33568
    s_waitcnt lgkmcnt(8)
    v_mfma_f32_32x32x16_bf16 v[96:111], v[24:27], v[160:163], v[96:111]
    s_nop 0
    v_mul_f32 v68, v68, v16
    v_mul_f32 v69, v69, v17
    ds_read_b64_tr_b16 v[44:45], v5 offset:35360
    ds_read_b64_tr_b16 v[46:47], v5 offset:35616
    s_waitcnt lgkmcnt(8)
    v_mfma_f32_32x32x16_bf16 v[96:111], v[28:31], v[164:167], v[96:111]
    s_cmp_ge_u32 s7, 2
    s_cbranch_scc1 G2X_11
    s_add_u32 s12, s41, 4718592
    s_add_u32 m0, s81, 16384
    s_nop 0
    buffer_load_dwordx4 v4, s[24:27], s12 offen lds
G2X_11:
    v_mul_f32 v70, v70, v18
    v_mul_f32 v71, v71, v19
    v_cvt_pk_bf16_f32 v22, v68, v69
    ds_read_b64_tr_b16 v[24:25], v6 offset:544
    ds_read_b64_tr_b16 v[26:27], v6 offset:800
    s_waitcnt lgkmcnt(8)
    v_mfma_f32_32x32x16_bf16 v[96:111], v[32:35], v[168:171], v[96:111]
    v_cvt_pk_bf16_f32 v23, v70, v71
    s_add_u32 s12, s43, 4096
    buffer_store_dwordx4 v[20:23], v3, s[48:51], s12 offen offset:1024 sc1
    ds_read_b64_tr_b16 v[28:29], v6 offset:2592
    ds_read_b64_tr_b16 v[30:31], v6 offset:2848
    s_waitcnt lgkmcnt(8)
    v_mfma_f32_32x32x16_bf16 v[96:111], v[36:39], v[172:175], v[96:111]
    s_add_u32 s12, s41, 0
    s_add_u32 m0, s81, 0
    s_nop 0
    buffer_load_dwordx4 v4, s[24:27], s12 offen lds
    ds_read_b64_tr_b16 v[32:33], v6 offset:4640
    ds_read_b64_tr_b16 v[34:35], v6 offset:4896
    s_waitcnt lgkmcnt(8)
    v_mfma_f32_32x32x16_bf16 v[96:111], v[40:43], v[176:179], v[96:111]
    ds_read_b64_tr_b16 v[36:37], v6 offset:6688
    ds_read_b64_tr_b16 v[38:39], v6 offset:6944
    s_waitcnt lgkmcnt(8)
    v_mfma_f32_32x32x16_bf16 v[96:111], v[44:47], v[180:183], v[96:111]
    s_add_u32 s12, s41, 2359296
    s_add_u32 m0, s81, 8192
    s_nop 0
    buffer_load_dwordx4 v4, s[24:27], s12 offen lds
    ds_read_b64_tr_b16 v[40:41], v6 offset:8736
    ds_read_b64_tr_b16 v[42:43], v6 offset:8992
    s_waitcnt lgkmcnt(8)
    v_mfma_f32_32x32x16_bf16 v[96:111], v[24:27], v[184:187], v[96:111]
    ds_read_b64_tr_b16 v[44:45], v6 offset:10784
    ds_read_b64_tr_b16 v[46:47], v6 offset:11040
    s_waitcnt lgkmcnt(8)
    v_mfma_f32_32x32x16_bf16 v[96:111], v[28:31], v[188:191], v[96:111]
    s_barrier
    ds_read_b64_tr_b16 v[24:25], v6 offset:12800
    ds_read_b64_tr_b16 v[26:27], v6 offset:13056
    s_waitcnt lgkmcnt(8)
    v_mfma_f32_32x32x16_bf16 v[96:111], v[32:35], v[192:195], v[96:111]
    ds_read_b64_tr_b16 v[28:29], v6 offset:14848
    ds_read_b64_tr_b16 v[30:31], v6 offset:15104
    s_waitcnt lgkmcnt(8)
    v_mfma_f32_32x32x16_bf16 v[96:111], v[36:39], v[196:199], v[96:111]
    s_cmp_ge_u32 s7, 2
    s_cbranch_scc1 G2X_12
    s_add_u32 s12, s41, 4718592
    s_add_u32 m0, s81, 34944
    s_nop 0
    buffer_load_dwordx4 v4, s[36:39], s12 offen lds
G2X_12:
    ds_read_b64_tr_b16 v[32:33], v6 offset:16896
    ds_read_b64_tr_b16 v[34:35], v6 offset:17152
    s_waitcnt lgkmcnt(8)
    v_mfma_f32_32x32x16_bf16 v[96:111], v[40:43], v[200:203], v[96:111]
    ds_read_b64_tr_b16 v[36:37], v6 offset:18944
    ds_read_b64_tr_b16 v[38:39], v6 offset:19200
    s_waitcnt lgkmcnt(8)
    v_mfma_f32_32x32x16_bf16 v[96:111], v[44:47], v[204:207], v[96:111]
    s_add_u32 s12, s41, 0
    s_add_u32 m0, s81, 18560
    s_nop 0
    buffer_load_dwordx4 v4, s[36:39], s12 offen lds
    ds_read_b64_tr_b16 v[40:41], v6 offset:20992
    ds_read_b64_tr_b16 v[42:43], v6 offset:21248
    s_waitcnt lgkmcnt(8)
    v_mfma_f32_32x32x16_bf16 v[80:95], v[24:27], v[208:211], v[80:95]
    ds_read_b64_tr_b16 v[44:45], v6 offset:23040
    ds_read_b64_tr_b16 v[46:47], v6 offset:23296
    s_waitcnt lgkmcnt(8)
    v_mfma_f32_32x32x16_bf16 v[80:95], v[28:31], v[212:215], v[80:95]
    s_add_u32 s12, s41, 2359296
    s_add_u32 m0, s81, 26752
    s_nop 0
    buffer_load_dwordx4 v4, s[36:39], s12 offen lds
    ds_read_b64_tr_b16 v[24:25], v6 offset:25088
    ds_read_b64_tr_b16 v[26:27], v6 offset:25344
    s_waitcnt lgkmcnt(8)
    v_mfma_f32_32x32x16_bf16 v[80:95], v[32:35], v[216:219], v[80:95]
    ds_read_b64_tr_b16 v[28:29], v6 offset:27136
    ds_read_b64_tr_b16 v[30:31], v6 offset:27392
    s_waitcnt lgkmcnt(8)
    v_mfma_f32_32x32x16_bf16 v[80:95], v[36:39], v[220:223], v[80:95]
    ds_read_b64_tr_b16 v[32:33], v6 offset:29184
    ds_read_b64_tr_b16 v[34:35], v6 offset:29440
    s_waitcnt lgkmcnt(8)
    v_mfma_f32_32x32x16_bf16 v[80:95], v[40:43], v[224:227], v[80:95]
    ds_read_b64_tr_b16 v[36:37], v6 offset:31232
    ds_read_b64_tr_b16 v[38:39], v6 offset:31488
    s_waitcnt lgkmcnt(8)
    v_mfma_f32_32x32x16_bf16 v[80:95], v[44:47], v[228:231], v[80:95]
    ds_read_b64_tr_b16 v[40:41], v6 offset:33280
    ds_read_b64_tr_b16 v[42:43], v6 offset:33536
    s_waitcnt lgkmcnt(8)
    v_mfma_f32_32x32x16_bf16 v[80:95], v[24:27], v[232:235], v[80:95]
    ds_read_b64_tr_b16 v[44:45], v6 offset:35328
    ds_read_b64_tr_b16 v[46:47], v6 offset:35584
    s_waitcnt lgkmcnt(8)
    v_mfma_f32_32x32x16_bf16 v[80:95], v[28:31], v[236:239], v[80:95]
    s_load_dwordx4 s[68:71], s[0:1], 40
    s_load_dwordx2 s[56:57], s[0:1], 96
    s_load_dwordx2 s[60:61], s[0:1], 120
    s_mul_i32 s14, s3, 30
    s_add_u32 s14, s14, s4
    s_mul_i32 s44, s14, 1366
    s_lshr_b32 s44, s44, 16
    s_mul_i32 s13, s44, 48
    s_sub_u32 s47, s14, s13
    s_mul_i32 s45, s47, 86
    s_lshr_b32 s45, s45, 8
    s_mul_i32 s13, s45, 3
    s_sub_u32 s46, s47, s13
    s_lshl_b32 s14, s45, 2
    s_lshr_b32 s13, s7, 1
    s_add_u32 s14, s14, s13
    s_mul_i32 s76, s14, 294912
    s_and_b32 s9, s7, 1
    s_lshr_b32 s10, s7, 2
    s_add_u32 s76, s76, 4194304
    s_mul_i32 s83, s7, 3072
    s_add_u32 s83, s83, 16384
    s_mul_i32 s80, s46, 384
    s_lshr_b32 s14, s45, 1
    s_lshl_b32 s32, s14, 7
    s_add_u32 s32, s32, 65019904
    s_waitcnt lgkmcnt(0)
    s_mov_b32 s58, 5308416
    s_mov_b32 s59, 0x20000
    s_add_u32 s60, s60, 36700160
    s_addc_u32 s61, s61, 0
    s_mov_b32 s62, 147456
    s_mov_b32 s63, 0x20000
    v_lshlrev_b32 v15, 2, v1
    v_and_b32 v15, 127, v15
    s_lshl_b32 s33, s6, 7
    s_add_u32 s33, s33, 65015808
    s_and_b32 s13, s7, 3
    s_mul_i32 s13, s13, 192
    s_add_u32 s13, s13, 0
    v_add_u32 v12, s13, v1
    v_mul_u32_u24 v13, 2731, v12
    v_lshrrev_b32 v13, 16, v13
    v_mul_u32_u24 v14, 24, v13
    v_sub_u32 v14, v12, v14
    v_bfe_u32 v12, v13, 1, 1
    v_lshlrev_b32 v12, 2, v12
    v_xor_b32 v14, v14, v12
    v_mul_u32_u24 v13, 1152, v13
    v_lshl_add_u32 v8, v14, 4, v13
    s_and_b32 s13, s7, 3
    s_mul_i32 s13, s13, 192
    s_add_u32 s13, s13, 64
    v_add_u32 v12, s13, v1
    v_mul_u32_u24 v13, 2731, v12
    v_lshrrev_b32 v13, 16, v13
    v_mul_u32_u24 v14, 24, v13
    v_sub_u32 v14, v12, v14
    v_bfe_u32 v12, v13, 1, 1
    v_lshlrev_b32 v12, 2, v12
    v_xor_b32 v14, v14, v12
    v_mul_u32_u24 v13, 1152, v13
    v_lshl_add_u32 v9, v14, 4, v13
    s_and_b32 s13, s7, 3
    s_mul_i32 s13, s13, 192
    s_add_u32 s13, s13, 128
    v_add_u32 v12, s13, v1
    v_mul_u32_u24 v13, 2731, v12
    v_lshrrev_b32 v13, 16, v13
    v_mul_u32_u24 v14, 24, v13
    v_sub_u32 v14, v12, v14
    v_bfe_u32 v12, v13, 1, 1
    v_lshlrev_b32 v12, 2, v12
    v_xor_b32 v14, v14, v12
    v_mul_u32_u24 v13, 1152, v13
    v_lshl_add_u32 v10, v14, 4, v13
    buffer_load_dword v12, v15, s[48:51], s32 offen sc1
    buffer_load_dword v13, v15, s[48:51], s33 offen sc1
    ds_read_b64_tr_b16 v[24:25], v6 offset:12832
    ds_read_b64_tr_b16 v[26:27], v6 offset:13088
    v_mfma_f32_32x32x16_bf16 v[80:95], v[32:35], v[240:243], v[80:95]
    ds_read_b64_tr_b16 v[28:29], v6 offset:14880
    ds_read_b64_tr_b16 v[30:31], v6 offset:15136
    v_mfma_f32_32x32x16_bf16 v[80:95], v[36:39], v[244:247], v[80:95]
    ds_read_b64_tr_b16 v[32:33], v6 offset:16928
    ds_read_b64_tr_b16 v[34:35], v6 offset:17184
    v_mfma_f32_32x32x16_bf16 v[80:95], v[40:43], v[248:251], v[80:95]
    ds_read_b64_tr_b16 v[36:37], v6 offset:18976
    ds_read_b64_tr_b16 v[38:39], v6 offset:19232
    v_mfma_f32_32x32x16_bf16 v[80:95], v[44:47], v[252:255], v[80:95]
    ds_read_b64_tr_b16 v[40:41], v6 offset:21024
    ds_read_b64_tr_b16 v[42:43], v6 offset:21280
    s_waitcnt lgkmcnt(8)
    v_mfma_f32_32x32x16_bf16 v[96:111], v[24:27], v[208:211], v[96:111]
    ds_read_b64_tr_b16 v[44:45], v6 offset:23072
    ds_read_b64_tr_b16 v[46:47], v6 offset:23328
    s_waitcnt lgkmcnt(8)
    v_mfma_f32_32x32x16_bf16 v[96:111], v[28:31], v[212:215], v[96:111]
    ds_read_b64_tr_b16 v[24:25], v6 offset:25120
    ds_read_b64_tr_b16 v[26:27], v6 offset:25376
    s_waitcnt lgkmcnt(8)
    v_mfma_f32_32x32x16_bf16 v[96:111], v[32:35], v[216:219], v[96:111]
    ds_read_b64_tr_b16 v[28:29], v6 offset:27168
    ds_read_b64_tr_b16 v[30:31], v6 offset:27424
    s_waitcnt lgkmcnt(8)
    v_mfma_f32_32x32x16_bf16 v[96:111], v[36:39], v[220:223], v[96:111]
    v_mul_f32 v16, v80, v80
    v_mul_f32 v17, v81, v81
    v_mul_f32 v18, v82, v82
    ds_read_b64_tr_b16 v[32:33], v6 offset:29216
    ds_read_b64_tr_b16 v[34:35], v6 offset:29472
    s_waitcnt lgkmcnt(8)
    v_mfma_f32_32x32x16_bf16 v[96:111], v[40:43], v[224:227], v[96:111]
    v_mul_f32 v19, v83, v83
    v_fma_f32 v16, v16, s42, v11
    v_fma_f32 v17, v17, s42, v11
    ds_read_b64_tr_b16 v[36:37], v6 offset:31264
    ds_read_b64_tr_b16 v[38:39], v6 offset:31520
    s_waitcnt lgkmcnt(8)
    v_mfma_f32_32x32x16_bf16 v[96:111], v[44:47], v[228:231], v[96:111]
    v_fma_f32 v18, v18, s42, v11
    v_fma_f32 v19, v19, s42, v11
    v_mul_f32 v16, v16, v80
    ds_read_b64_tr_b16 v[40:41], v6 offset:33312
    ds_read_b64_tr_b16 v[42:43], v6 offset:33568
    s_waitcnt lgkmcnt(8)
    v_mfma_f32_32x32x16_bf16 v[96:111], v[24:27], v[232:235], v[96:111]
    v_mul_f32 v17, v17, v81
    v_mul_f32 v18, v18, v82
    v_mul_f32 v19, v19, v83
    ds_read_b64_tr_b16 v[44:45], v6 offset:35360
    ds_read_b64_tr_b16 v[46:47], v6 offset:35616
    s_waitcnt lgkmcnt(8)
    v_mfma_f32_32x32x16_bf16 v[96:111], v[28:31], v[236:239], v[96:111]
    v_exp_f32 v16, v16
    v_exp_f32 v17, v17
    v_exp_f32 v18, v18
    s_waitcnt vmcnt(2)
    s_barrier
    ds_read_b64_tr_b16 v[24:25], v7 offset:0
    ds_read_b64_tr_b16 v[26:27], v7 offset:128
    s_waitcnt lgkmcnt(8)
    v_mfma_f32_32x32x16_bf16 v[96:111], v[32:35], v[240:243], v[96:111]
    v_exp_f32 v19, v19
    v_mul_f32 v80, v80, v88
    v_mul_f32 v81, v81, v89
    ds_read_b64_tr_b16 v[28:29], v7 offset:512
    ds_read_b64_tr_b16 v[30:31], v7 offset:640
    s_waitcnt lgkmcnt(8)
    v_mfma_f32_32x32x16_bf16 v[96:111], v[36:39], v[244:247], v[96:111]
    v_mul_f32 v82, v82, v90
    v_mul_f32 v83, v83, v91
    v_add_f32 v16, 1.0, v16
    ds_read_b64_tr_b16 v[32:33], v7 offset:1024
    ds_read_b64_tr_b16 v[34:35], v7 offset:1152
    s_waitcnt lgkmcnt(8)
    v_mfma_f32_32x32x16_bf16 v[96:111], v[40:43], v[248:251], v[96:111]
    v_add_f32 v17, 1.0, v17
    v_add_f32 v18, 1.0, v18
    v_add_f32 v19, 1.0, v19
    ds_read_b64_tr_b16 v[36:37], v7 offset:1536
    ds_read_b64_tr_b16 v[38:39], v7 offset:1664
    s_waitcnt lgkmcnt(8)
    v_mfma_f32_32x32x16_bf16 v[96:111], v[44:47], v[252:255], v[96:111]
    v_rcp_f32 v16, v16
    v_rcp_f32 v17, v17
    v_rcp_f32 v18, v18
    s_barrier
    s_cmp_lg_u32 s7, 0
    s_cbranch_scc1 NOFLAG_13
    s_add_u32 s14, s34, 1024
    v_mov_b32 v2, s15
    s_mov_b64 exec, 1
    buffer_store_dword v2, off, s[48:51], s14 sc1
    s_mov_b64 exec, -1
NOFLAG_13:
    s_waitcnt vmcnt(0)
    v_cmp_ne_u32 vcc, s15, v13
    s_cbranch_vccnz SLOW_14
BACK_15:
    v_cmp_ne_u32 vcc, s15, v12
    s_cbranch_vccnz SLOW_16
BACK_17:
    ds_read_b64_tr_b16 v[40:41], v7 offset:2048
    ds_read_b64_tr_b16 v[42:43], v7 offset:2176
    s_waitcnt lgkmcnt(8)
    v_mfma_f32_32x32x16_bf16 v[48:63], v[24:27], v[112:115], 0
    s_add_u32 s73, s44, 0
    s_lshr_b32 s12, s73, 2
    s_lshl_b32 s73, s73, 1
    s_add_u32 s73, s73, s12
    s_lshl_b32 s73, s73, 1
    s_add_u32 s73, s73, s10
    s_mul_i32 s73, s73, 36864
    s_add_u32 s73, s73, s80
    s_add_u32 m0, s83, 40960
    s_nop 0
    buffer_load_dwordx4 v8, s[56:59], s73 offen lds
    v_rcp_f32 v19, v19
    s_nop 0
    v_mul_f32 v80, v80, v16
    v_mul_f32 v81, v81, v17
    ds_read_b64_tr_b16 v[44:45], v7 offset:2560
    ds_read_b64_tr_b16 v[46:47], v7 offset:2688
    s_waitcnt lgkmcnt(8)
    v_mfma_f32_32x32x16_bf16 v[48:63], v[28:31], v[116:119], v[48:63]
    s_add_u32 m0, s83, 41984
    s_nop 0
    buffer_load_dwordx4 v9, s[56:59], s73 offen lds
    v_mul_f32 v82, v82, v18
    v_mul_f32 v83, v83, v19
    v_cvt_pk_bf16_f32 v20, v80, v81
    v_cvt_pk_bf16_f32 v21, v82, v83
    ds_read_b64_tr_b16 v[24:25], v7 offset:3072
    ds_read_b64_tr_b16 v[26:27], v7 offset:3200
    s_waitcnt lgkmcnt(8)
    v_mfma_f32_32x32x16_bf16 v[48:63], v[32:35], v[120:123], v[48:63]
    s_add_u32 m0, s83, 43008
    s_nop 0
    buffer_load_dwordx4 v10, s[56:59], s73 offen lds
    v_mul_f32 v16, v84, v84
    v_mul_f32 v17, v85, v85
    v_mul_f32 v18, v86, v86
    v_mul_f32 v19, v87, v87
    ds_read_b64_tr_b16 v[28:29], v7 offset:3584
    ds_read_b64_tr_b16 v[30:31], v7 offset:3712
    s_waitcnt lgkmcnt(8)
    v_mfma_f32_32x32x16_bf16 v[48:63], v[36:39], v[124:127], v[48:63]
    s_add_u32 s72, s44, 0
    s_lshr_b32 s12, s72, 2
    s_lshl_b32 s72, s72, 1
    s_add_u32 s72, s72, s12
    s_lshl_b32 s72, s72, 1
    s_add_u32 s72, s72, s9
    s_lshl_b32 s72, s72, 11
    s_add_u32 s72, s72, s76
    s_add_u32 m0, s82, 40960
    s_nop 0
    buffer_load_dwordx4 v3, s[48:51], s72 offen sc1 lds
    v_fma_f32 v16, v16, s42, v11
    v_fma_f32 v17, v17, s42, v11
    v_fma_f32 v18, v18, s42, v11
    v_fma_f32 v19, v19, s42, v11
    ds_read_b64_tr_b16 v[32:33], v7 offset:4096
    ds_read_b64_tr_b16 v[34:35], v7 offset:4224
    s_waitcnt lgkmcnt(8)
    v_mfma_f32_32x32x16_bf16 v[48:63], v[40:43], v[128:131], v[48:63]
    s_add_u32 m0, s82, 40960
    s_nop 0
    buffer_load_dwordx4 v3, s[48:51], s72 offen offset:1024 sc1 lds
    v_mul_f32 v16, v16, v84
    v_mul_f32 v17, v17, v85
    v_mul_f32 v18, v18, v86
    v_mul_f32 v19, v19, v87
    ds_read_b64_tr_b16 v[36:37], v7 offset:4608
    ds_read_b64_tr_b16 v[38:39], v7 offset:4736
    s_waitcnt lgkmcnt(8)
    v_mfma_f32_32x32x16_bf16 v[48:63], v[44:47], v[132:135], v[48:63]
    s_add_u32 s73, s44, 5
    s_lshr_b32 s12, s73, 2
    s_lshl_b32 s73, s73, 1
    s_add_u32 s73, s73, s12
    s_lshl_b32 s73, s73, 1
    s_add_u32 s73, s73, s10
    s_mul_i32 s73, s73, 36864
    s_add_u32 s73, s73, s80
    s_add_u32 m0, s83, 81920
    s_nop 0
    buffer_load_dwordx4 v8, s[56:59], s73 offen lds
    v_exp_f32 v16, v16
    v_exp_f32 v17, v17
    v_exp_f32 v18, v18
    v_exp_f32 v19, v19
    ds_read_b64_tr_b16 v[40:41], v7 offset:5120
    ds_read_b64_tr_b16 v[42:43], v7 offset:5248
    s_waitcnt lgkmcnt(8)
    v_mfma_f32_32x32x16_bf16 v[48:63], v[24:27], v[136:139], v[48:63]
    s_add_u32 m0, s83, 82944
    s_nop 0
    buffer_load_dwordx4 v9, s[56:59], s73 offen lds
    v_mul_f32 v84, v84, v92
    v_mul_f32 v85, v85, v93
    v_mul_f32 v86, v86, v94
    v_mul_f32 v87, v87, v95
    ds_read_b64_tr_b16 v[44:45], v7 offset:5632
    ds_read_b64_tr_b16 v[46:47], v7 offset:5760
    s_waitcnt lgkmcnt(8)
    v_mfma_f32_32x32x16_bf16 v[48:63], v[28:31], v[140:143], v[48:63]
    s_add_u32 m0, s83, 83968
    s_nop 0
    buffer_load_dwordx4 v10, s[56:59], s73 offen lds
    v_add_f32 v16, 1.0, v16
    v_add_f32 v17, 1.0, v17
    v_add_f32 v18, 1.0, v18
    v_add_f32 v19, 1.0, v19
    ds_read_b64_tr_b16 v[24:25], v7 offset:6144
    ds_read_b64_tr_b16 v[26:27], v7 offset:6272
    s_waitcnt lgkmcnt(8)
    v_mfma_f32_32x32x16_bf16 v[48:63], v[32:35], v[144:147], v[48:63]
    s_add_u32 s72, s44, 5
    s_lshr_b32 s12, s72, 2
    s_lshl_b32 s72, s72, 1
    s_add_u32 s72, s72, s12
    s_lshl_b32 s72, s72, 1
    s_add_u32 s72, s72, s9
    s_lshl_b32 s72, s72, 11
    s_add_u32 s72, s72, s76
    s_add_u32 m0, s82, 81920
    s_nop 0
    buffer_load_dwordx4 v3, s[48:51], s72 offen sc1 lds
    v_rcp_f32 v16, v16
    v_rcp_f32 v17, v17
    v_rcp_f32 v18, v18
    v_rcp_f32 v19, v19
    ds_read_b64_tr_b16 v[28:29], v7 offset:6656
    ds_read_b64_tr_b16 v[30:31], v7 offset:6784
    s_waitcnt lgkmcnt(8)
    v_mfma_f32_32x32x16_bf16 v[48:63], v[36:39], v[148:151], v[48:63]
    s_add_u32 m0, s82, 81920
    s_nop 0
    buffer_load_dwordx4 v3, s[48:51], s72 offen offset:1024 sc1 lds
    s_nop 0
    v_mul_f32 v84, v84, v16
    v_mul_f32 v85, v85, v17
    v_mul_f32 v86, v86, v18
    ds_read_b64_tr_b16 v[32:33], v7 offset:7168
    ds_read_b64_tr_b16 v[34:35], v7 offset:7296
    s_waitcnt lgkmcnt(8)
    v_mfma_f32_32x32x16_bf16 v[48:63], v[40:43], v[152:155], v[48:63]
    s_add_u32 s73, s44, 10
    s_lshr_b32 s12, s73, 2
    s_lshl_b32 s73, s73, 1
    s_add_u32 s73, s73, s12
    s_lshl_b32 s73, s73, 1
    s_add_u32 s73, s73, s10
    s_mul_i32 s73, s73, 36864
    s_add_u32 s73, s73, s80
    s_add_u32 m0, s83, 122880
    s_nop 0
    buffer_load_dwordx4 v8, s[56:59], s73 offen lds
    v_mul_f32 v87, v87, v19
    v_cvt_pk_bf16_f32 v22, v84, v85
    v_cvt_pk_bf16_f32 v23, v86, v87
    s_add_u32 s12, s43, 4096
    buffer_store_dwordx4 v[20:23], v3, s[48:51], s12 offen offset:2048 sc1
    ds_read_b64_tr_b16 v[36:37], v7 offset:7680
    ds_read_b64_tr_b16 v[38:39], v7 offset:7808
    s_waitcnt lgkmcnt(8)
    v_mfma_f32_32x32x16_bf16 v[48:63], v[44:47], v[156:159], v[48:63]
    s_add_u32 m0, s83, 123904
    s_nop 0
    buffer_load_dwordx4 v9, s[56:59], s73 offen lds
    v_mul_f32 v16, v96, v96
    v_mul_f32 v17, v97, v97
    v_mul_f32 v18, v98, v98
    v_mul_f32 v19, v99, v99
    ds_read_b64_tr_b16 v[40:41], v7 offset:8192
    ds_read_b64_tr_b16 v[42:43], v7 offset:8320
    s_waitcnt lgkmcnt(8)
    v_mfma_f32_32x32x16_bf16 v[48:63], v[24:27], v[160:163], v[48:63]
    s_add_u32 m0, s83, 124928
    s_nop 0
    buffer_load_dwordx4 v10, s[56:59], s73 offen lds
    v_fma_f32 v16, v16, s42, v11
    v_fma_f32 v17, v17, s42, v11
    v_fma_f32 v18, v18, s42, v11
    v_fma_f32 v19, v19, s42, v11
    ds_read_b64_tr_b16 v[44:45], v7 offset:8704
    ds_read_b64_tr_b16 v[46:47], v7 offset:8832
    s_waitcnt lgkmcnt(8)
    v_mfma_f32_32x32x16_bf16 v[48:63], v[28:31], v[164:167], v[48:63]
    s_add_u32 s72, s44, 10
    s_lshr_b32 s12, s72, 2
    s_lshl_b32 s72, s72, 1
    s_add_u32 s72, s72, s12
    s_lshl_b32 s72, s72, 1
    s_add_u32 s72, s72, s9
    s_lshl_b32 s72, s72, 11
    s_add_u32 s72, s72, s76
    s_add_u32 m0, s82, 122880
    s_nop 0
    buffer_load_dwordx4 v3, s[48:51], s72 offen sc1 lds
    v_mul_f32 v16, v16, v96
    v_mul_f32 v17, v17, v97
    v_mul_f32 v18, v18, v98
    v_mul_f32 v19, v19, v99
    ds_read_b64_tr_b16 v[24:25], v7 offset:9216
    ds_read_b64_tr_b16 v[26:27], v7 offset:9344
    s_waitcnt lgkmcnt(8)
    v_mfma_f32_32x32x16_bf16 v[48:63], v[32:35], v[168:171], v[48:63]
    s_add_u32 m0, s82, 122880
    s_nop 0
    buffer_load_dwordx4 v3, s[48:51], s72 offen offset:1024 sc1 lds
    v_exp_f32 v16, v16
    v_exp_f32 v17, v17
    v_exp_f32 v18, v18
    v_exp_f32 v19, v19
    ds_read_b64_tr_b16 v[28:29], v7 offset:9728
    ds_read_b64_tr_b16 v[30:31], v7 offset:9856
    s_waitcnt lgkmcnt(8)
    v_mfma_f32_32x32x16_bf16 v[48:63], v[36:39], v[172:175], v[48:63]
    v_mul_f32 v96, v96, v104
    v_mul_f32 v97, v97, v105
    v_mul_f32 v98, v98, v106
    v_mul_f32 v99, v99, v107
    ds_read_b64_tr_b16 v[32:33], v7 offset:10240
    ds_read_b64_tr_b16 v[34:35], v7 offset:10368
    s_waitcnt lgkmcnt(8)
    v_mfma_f32_32x32x16_bf16 v[48:63], v[40:43], v[176:179], v[48:63]
    v_add_f32 v16, 1.0, v16
    v_add_f32 v17, 1.0, v17
    v_add_f32 v18, 1.0, v18
    v_add_f32 v19, 1.0, v19
    ds_read_b64_tr_b16 v[36:37], v7 offset:10752
    ds_read_b64_tr_b16 v[38:39], v7 offset:10880
    s_waitcnt lgkmcnt(8)
    v_mfma_f32_32x32x16_bf16 v[48:63], v[44:47], v[180:183], v[48:63]
    v_rcp_f32 v16, v16
    v_rcp_f32 v17, v17
    v_rcp_f32 v18, v18
    v_rcp_f32 v19, v19
    ds_read_b64_tr_b16 v[40:41], v7 offset:11264
    ds_read_b64_tr_b16 v[42:43], v7 offset:11392
    s_waitcnt lgkmcnt(8)
    v_mfma_f32_32x32x16_bf16 v[48:63], v[24:27], v[184:187], v[48:63]
    s_nop 0
    v_mul_f32 v96, v96, v16
    v_mul_f32 v97, v97, v17
    v_mul_f32 v98, v98, v18
    ds_read_b64_tr_b16 v[44:45], v7 offset:11776
    ds_read_b64_tr_b16 v[46:47], v7 offset:11904
    s_waitcnt lgkmcnt(8)
    v_mfma_f32_32x32x16_bf16 v[48:63], v[28:31], v[188:191], v[48:63]
    v_mul_f32 v99, v99, v19
    v_cvt_pk_bf16_f32 v20, v96, v97
    v_cvt_pk_bf16_f32 v21, v98, v99
    v_mul_f32 v16, v100, v100
    ds_read_b64_tr_b16 v[24:25], v7 offset:12288
    ds_read_b64_tr_b16 v[26:27], v7 offset:12416
    s_waitcnt lgkmcnt(8)
    v_mfma_f32_32x32x16_bf16 v[48:63], v[32:35], v[192:195], v[48:63]
    v_mul_f32 v17, v101, v101
    v_mul_f32 v18, v102, v102
    v_mul_f32 v19, v103, v103
    v_fma_f32 v16, v16, s42, v11
    ds_read_b64_tr_b16 v[28:29], v7 offset:12800
    ds_read_b64_tr_b16 v[30:31], v7 offset:12928
    s_waitcnt lgkmcnt(8)
    v_mfma_f32_32x32x16_bf16 v[48:63], v[36:39], v[196:199], v[48:63]
    v_fma_f32 v17, v17, s42, v11
    v_fma_f32 v18, v18, s42, v11
    v_fma_f32 v19, v19, s42, v11
    v_mul_f32 v16, v16, v100
    ds_read_b64_tr_b16 v[32:33], v7 offset:13312
    ds_read_b64_tr_b16 v[34:35], v7 offset:13440
    s_waitcnt lgkmcnt(8)
    v_mfma_f32_32x32x16_bf16 v[48:63], v[40:43], v[200:203], v[48:63]
    s_mul_i32 s16, s11, 9
    s_add_u32 s16, s16, s7
    s_mul_i32 s17, s16, 4352
    s_add_u32 s17, s17, 25165824
    s_and_b32 s12, s11, 7
    s_lshl_b32 s12, s12, 3
    s_add_u32 s12, s12, s7
    s_lshl_b32 s12, s12, 3
    v_and_b32 v198, 7, v1
    v_add_u32 v196, s12, v198
    v_lshlrev_b32 v198, 1, v196
    s_lshr_b32 s22, s11, 3
    s_mul_i32 s22, s22, 147456
    s_lshl_b32 s12, s12, 8
    s_add_u32 s22, s22, s12
    s_add_u32 s22, s22, 37748736
    global_load_ushort v193, v198, s[18:19]
    global_load_ushort v194, v198, s[20:21]
    global_load_ushort v195, v198, s[30:31]
    v_mul_f32 v17, v17, v101
    v_mul_f32 v18, v18, v102
    v_mul_f32 v19, v19, v103
    v_exp_f32 v16, v16
    ds_read_b64_tr_b16 v[36:37], v7 offset:13824
    ds_read_b64_tr_b16 v[38:39], v7 offset:13952
    s_waitcnt lgkmcnt(8)
    v_mfma_f32_32x32x16_bf16 v[48:63], v[44:47], v[204:207], v[48:63]
    s_lshl_b32 s16, s16, 6
    v_lshrrev_b32 v198, 4, v1
    v_mul_u32_u24 v198, 36864, v198
    v_and_b32 v197, 15, v1
    v_lshl_add_u32 v197, v197, 2, s16
    v_sub_u32 v197, v197, v198
    v_subrev_u32 v197, 4608, v197
    buffer_load_dword v185, v197, s[60:63], 0 offen sc1
    v_subrev_u32 v197, 4608, v197
    buffer_load_dword v186, v197, s[60:63], 0 offen sc1
    v_exp_f32 v17, v17
    v_exp_f32 v18, v18
    v_exp_f32 v19, v19
    v_mul_f32 v100, v100, v108
    ds_read_b64_tr_b16 v[40:41], v7 offset:14336
    ds_read_b64_tr_b16 v[42:43], v7 offset:14464
    s_waitcnt lgkmcnt(8)
    v_mfma_f32_32x32x16_bf16 v[48:63], v[24:27], v[208:211], v[48:63]
    v_subrev_u32 v197, 4608, v197
    buffer_load_dword v187, v197, s[60:63], 0 offen sc1
    v_subrev_u32 v197, 4608, v197
    buffer_load_dword v188, v197, s[60:63], 0 offen sc1
    v_mul_f32 v101, v101, v109
    v_mul_f32 v102, v102, v110
    v_mul_f32 v103, v103, v111
    v_add_f32 v16, 1.0, v16
    ds_read_b64_tr_b16 v[44:45], v7 offset:14848
    ds_read_b64_tr_b16 v[46:47], v7 offset:14976
    s_waitcnt lgkmcnt(8)
    v_mfma_f32_32x32x16_bf16 v[48:63], v[28:31], v[212:215], v[48:63]
    v_subrev_u32 v197, 4608, v197
    buffer_load_dword v189, v197, s[60:63], 0 offen sc1
    v_subrev_u32 v197, 4608, v197
    buffer_load_dword v190, v197, s[60:63], 0 offen sc1
    v_add_f32 v17, 1.0, v17
    v_add_f32 v18, 1.0, v18
    v_add_f32 v19, 1.0, v19
    v_rcp_f32 v16, v16
    ds_read_b64_tr_b16 v[24:25], v7 offset:15360
    ds_read_b64_tr_b16 v[26:27], v7 offset:15488
    s_waitcnt lgkmcnt(8)
    v_mfma_f32_32x32x16_bf16 v[48:63], v[32:35], v[216:219], v[48:63]
    v_subrev_u32 v197, 4608, v197
    buffer_load_dword v191, v197, s[60:63], 0 offen sc1
    v_subrev_u32 v197, 4608, v197
    buffer_load_dword v192, v197, s[60:63], 0 offen sc1
    v_rcp_f32 v17, v17
    v_rcp_f32 v18, v18
    v_rcp_f32 v19, v19
    s_nop 0
    ds_read_b64_tr_b16 v[28:29], v7 offset:15872
    ds_read_b64_tr_b16 v[30:31], v7 offset:16000
    s_waitcnt lgkmcnt(8)
    v_mfma_f32_32x32x16_bf16 v[48:63], v[36:39], v[220:223], v[48:63]
    buffer_load_dwordx4 v[168:171], v3, s[48:51], s17 offen offset:0 sc1
    v_mul_f32 v100, v100, v16
    v_mul_f32 v101, v101, v17
    v_mul_f32 v102, v102, v18
    v_mul_f32 v103, v103, v19
    ds_read_b64_tr_b16 v[32:33], v7 offset:16384
    ds_read_b64_tr_b16 v[34:35], v7 offset:16512
    s_waitcnt lgkmcnt(8)
    v_mfma_f32_32x32x16_bf16 v[48:63], v[40:43], v[224:227], v[48:63]
    buffer_load_dwordx4 v[172:175], v3, s[48:51], s17 offen offset:1024 sc1
    v_cvt_pk_bf16_f32 v22, v100, v101
    v_cvt_pk_bf16_f32 v23, v102, v103
    s_add_u32 s12, s43, 4096
    buffer_store_dwordx4 v[20:23], v3, s[48:51], s12 offen offset:3072 sc1
    ds_read_b64_tr_b16 v[36:37], v7 offset:16896
    ds_read_b64_tr_b16 v[38:39], v7 offset:17024
    s_waitcnt lgkmcnt(8)
    v_mfma_f32_32x32x16_bf16 v[48:63], v[44:47], v[228:231], v[48:63]
    buffer_load_dwordx4 v[176:179], v3, s[48:51], s17 offen offset:2048 sc1
    ds_read_b64_tr_b16 v[40:41], v7 offset:17408
    ds_read_b64_tr_b16 v[42:43], v7 offset:17536
    s_waitcnt lgkmcnt(8)
    v_mfma_f32_32x32x16_bf16 v[48:63], v[24:27], v[232:235], v[48:63]
    buffer_load_dwordx4 v[180:183], v3, s[48:51], s17 offen offset:3072 sc1
    ds_read_b64_tr_b16 v[44:45], v7 offset:17920
    ds_read_b64_tr_b16 v[46:47], v7 offset:18048
    s_waitcnt lgkmcnt(8)
    v_mfma_f32_32x32x16_bf16 v[48:63], v[28:31], v[236:239], v[48:63]
    v_lshlrev_b32 v198, 2, v1
    s_add_u32 s12, s17, 4096
    buffer_load_dword v184, v198, s[48:51], s12 offen sc1
    s_waitcnt lgkmcnt(6)
    v_mfma_f32_32x32x16_bf16 v[48:63], v[32:35], v[240:243], v[48:63]
    s_waitcnt lgkmcnt(4)
    v_mfma_f32_32x32x16_bf16 v[48:63], v[36:39], v[244:247], v[48:63]
    s_waitcnt lgkmcnt(2)
    v_mfma_f32_32x32x16_bf16 v[48:63], v[40:43], v[248:251], v[48:63]
    s_waitcnt lgkmcnt(0)
    v_mfma_f32_32x32x16_bf16 v[48:63], v[44:47], v[252:255], v[48:63]
    s_and_b32 s14, s44, 3
    s_lshl_b32 s14, s14, 7
    v_xor_b32 v224, s14, v3
    s_and_b32 s13, s7, 3
    s_lshl_b32 s12, s13, 12
    v_add_u32 v224, s12, v224
    v_add_u32 v225, 81920, v224
    v_lshrrev_b32 v12, 5, v1
    v_lshlrev_b32 v13, 2, v12
    v_bfe_u32 v14, v1, 2, 2
    v_add_u32 v13, v13, v14
    v_mul_u32_u24 v13, 384, v13
    v_bfe_u32 v14, v1, 4, 1
    v_lshl_add_u32 v13, v14, 5, v13
    v_and_b32 v14, 3, v1
    v_lshl_add_u32 v13, v14, 3, v13
    v_add_u32 v13, 16384, v13
    v_bfe_u32 v14, v1, 3, 1
    s_lshr_b32 s77, s7, 2
    s_mul_i32 s77, s77, 3
    s_add_u32 s14, s77, 0
    v_xor_b32 v2, s14, v14
    v_lshl_add_u32 v226, v2, 6, v13
    v_add_u32 v229, 81920, v226
    s_add_u32 s14, s77, 1
    v_xor_b32 v2, s14, v14
    v_lshl_add_u32 v227, v2, 6, v13
    v_add_u32 v230, 81920, v227
    s_add_u32 s14, s77, 2
    v_xor_b32 v2, s14, v14
    v_lshl_add_u32 v228, v2, 6, v13
    v_add_u32 v231, 81920, v228
    s_waitcnt vmcnt(28)
    s_barrier
    s_cmp_lt_u32 s4, 30
    s_cbranch_scc1 K2_GO
    v_lshlrev_b32 v14, 2, v1
    s_mov_b32 s24, 65015808
    buffer_load_dword v24, v14, s[48:51], s24 offen sc1
    s_mov_b32 s25, 65016064
    buffer_load_dword v25, v14, s[48:51], s25 offen sc1
    s_mov_b32 s26, 65016320
    buffer_load_dword v26, v14, s[48:51], s26 offen sc1
    s_mov_b32 s27, 65016576
    buffer_load_dword v27, v14, s[48:51], s27 offen sc1
    v_mul_f32 v16, v48, v48
    v_mul_f32 v17, v49, v49
    v_mul_f32 v18, v50, v50
    v_mul_f32 v19, v51, v51
    v_fma_f32 v16, v16, s42, v11
    v_fma_f32 v17, v17, s42, v11
    v_fma_f32 v18, v18, s42, v11
    v_fma_f32 v19, v19, s42, v11
    v_mul_f32 v16, v16, v48
    v_mul_f32 v17, v17, v49
    v_mul_f32 v18, v18, v50
    v_mul_f32 v19, v19, v51
    v_exp_f32 v16, v16
    v_exp_f32 v17, v17
    v_exp_f32 v18, v18
    v_exp_f32 v19, v19
    v_mul_f32 v48, v48, v56
    v_mul_f32 v49, v49, v57
    v_mul_f32 v50, v50, v58
    v_mul_f32 v51, v51, v59
    v_add_f32 v16, 1.0, v16
    v_add_f32 v17, 1.0, v17
    v_add_f32 v18, 1.0, v18
    v_add_f32 v19, 1.0, v19
    v_rcp_f32 v16, v16
    v_rcp_f32 v17, v17
    v_rcp_f32 v18, v18
    v_rcp_f32 v19, v19
    s_nop 0
    v_mul_f32 v48, v48, v16
    v_mul_f32 v49, v49, v17
    v_mul_f32 v50, v50, v18
    v_mul_f32 v51, v51, v19
    v_cvt_pk_bf16_f32 v20, v48, v49
    v_cvt_pk_bf16_f32 v21, v50, v51
    v_mul_f32 v16, v52, v52
    v_mul_f32 v17, v53, v53
    v_mul_f32 v18, v54, v54
    v_mul_f32 v19, v55, v55
    v_fma_f32 v16, v16, s42, v11
    v_fma_f32 v17, v17, s42, v11
    v_fma_f32 v18, v18, s42, v11
    v_fma_f32 v19, v19, s42, v11
    v_mul_f32 v16, v16, v52
    v_mul_f32 v17, v17, v53
    v_mul_f32 v18, v18, v54
    v_mul_f32 v19, v19, v55
    v_exp_f32 v16, v16
    v_exp_f32 v17, v17
    v_exp_f32 v18, v18
    v_exp_f32 v19, v19
    v_mul_f32 v52, v52, v60
    v_mul_f32 v53, v53, v61
    v_mul_f32 v54, v54, v62
    v_mul_f32 v55, v55, v63
    v_add_f32 v16, 1.0, v16
    v_add_f32 v17, 1.0, v17
    v_add_f32 v18, 1.0, v18
    v_add_f32 v19, 1.0, v19
    v_rcp_f32 v16, v16
    v_rcp_f32 v17, v17
    v_rcp_f32 v18, v18
    v_rcp_f32 v19, v19
    s_nop 0
    v_mul_f32 v52, v52, v16
    v_mul_f32 v53, v53, v17
    v_mul_f32 v54, v54, v18
    v_mul_f32 v55, v55, v19
    v_cvt_pk_bf16_f32 v22, v52, v53
    v_cvt_pk_bf16_f32 v23, v54, v55
    buffer_store_dwordx4 v[20:23], v3, s[48:51], s35 offen sc1
    s_waitcnt vmcnt(8)
    s_barrier
    s_cmp_lg_u32 s7, 0
    s_cbranch_scc1 NOFLAG_18
    s_add_u32 s14, s34, 2048
    v_mov_b32 v2, s15
    s_mov_b64 exec, 1
    buffer_store_dword v2, off, s[48:51], s14 sc1
    s_mov_b64 exec, -1
NOFLAG_18:
    s_waitcnt vmcnt(5)
    v_lshlrev_b32 v193, 16, v193
    v_lshlrev_b32 v194, 16, v194
    v_lshlrev_b32 v195, 16, v195
    v_mul_f32 v208, 0x3fb8aa3b, v195
    v_exp_f32 v208, v208
    s_nop 0
    v_cvt_pk_bf16_f32 v208, v208, v208
    v_lshlrev_b32 v208, 16, v208
    v_mul_f32 v209, v208, v193
    v_mul_f32 v210, v208, v194
    v_mul_f32 v209, 0x3fb8aa3b, v209
    v_exp_f32 v209, v209
    v_mul_f32 v210, 0x3e22f983, v210
    v_rndne_f32 v211, v210
    v_sub_f32 v210, v210, v211
    v_cos_f32 v211, v210
    v_sin_f32 v210, v210
    s_nop 0
    v_mul_f32 v199, v209, v211
    v_mul_f32 v200, v209, v210
    v_and_b32 v201, 8, v1
    v_lshlrev_b32 v201, 28, v201
    v_mul_f32 v208, v200, v200
    v_mul_f32 v223, v199, v200
    v_fma_f32 v222, v199, v199, -v208
    v_add_f32 v223, v223, v223
    v_mul_f32 v208, v223, v223
    v_mul_f32 v203, v222, v223
    v_fma_f32 v202, v222, v222, -v208
    v_add_f32 v203, v203, v203
    v_xor_b32 v223, v201, v223
    v_mul_f32 v208, v203, v203
    v_mul_f32 v203, v202, v203
    v_fma_f32 v202, v202, v202, -v208
    v_add_f32 v203, v203, v203
    v_mul_f32 v208, v203, v203
    v_mul_f32 v203, v202, v203
    v_fma_f32 v202, v202, v202, -v208
    v_add_f32 v203, v203, v203
    v_mov_b32 v212, v202
    v_mov_b32 v213, v203
    v_mul_f32 v208, v203, v203
    v_mul_f32 v203, v202, v203
    v_fma_f32 v202, v202, v202, -v208
    v_add_f32 v203, v203, v203
    v_mul_f32 v214, v202, v212
    v_mul_f32 v215, v202, v213
    v_fma_f32 v214, -v203, v213, v214
    v_fmac_f32 v215, v203, v212
    v_lshrrev_b32 v220, 4, v1
    v_mov_b32 v204, 1.0
    v_mov_b32 v205, 0
    v_cmp_eq_u32 vcc, 1, v220
    s_nop 1
    v_cndmask_b32 v204, v204, v212, vcc
    v_cndmask_b32 v205, v205, v213, vcc
    v_cmp_eq_u32 vcc, 2, v220
    s_nop 1
    v_cndmask_b32 v204, v204, v202, vcc
    v_cndmask_b32 v205, v205, v203, vcc
    v_cmp_eq_u32 vcc, 3, v220
    s_nop 1
    v_cndmask_b32 v204, v204, v214, vcc
    v_cndmask_b32 v205, v205, v215, vcc
    v_xor_b32 v205, v201, v205
    v_mul_f32 v208, v203, v203
    v_mul_f32 v207, v202, v203
    v_fma_f32 v206, v202, v202, -v208
    v_add_f32 v207, v207, v207
    v_mul_f32 v208, v207, v207
    v_mul_f32 v203, v206, v207
    v_fma_f32 v202, v206, v206, -v208
    v_add_f32 v203, v203, v203
    v_mul_f32 v208, v203, v203
    v_mul_f32 v203, v202, v203
    v_fma_f32 v202, v202, v202, -v208
    v_add_f32 v203, v203, v203
    v_mul_f32 v208, v203, v203
    v_mul_f32 v203, v202, v203
    v_fma_f32 v202, v202, v202, -v208
    v_add_f32 v203, v203, v203
    v_xor_b32 v207, v201, v207
    v_xor_b32 v203, v201, v203
    v_xor_b32 v200, v201, v200
    v_fma_f32 v191, v206, v192, v191
    s_nop 0
    v_fmac_f32_dpp v191, v192, v207 row_ror:8 row_mask:0xf bank_mask:0xf
    v_fma_f32 v190, v206, v191, v190
    s_nop 0
    v_fmac_f32_dpp v190, v191, v207 row_ror:8 row_mask:0xf bank_mask:0xf
    v_fma_f32 v189, v206, v190, v189
    s_nop 0
    v_fmac_f32_dpp v189, v190, v207 row_ror:8 row_mask:0xf bank_mask:0xf
    v_fma_f32 v188, v206, v189, v188
    s_nop 0
    v_fmac_f32_dpp v188, v189, v207 row_ror:8 row_mask:0xf bank_mask:0xf
    v_fma_f32 v187, v206, v188, v187
    s_nop 0
    v_fmac_f32_dpp v187, v188, v207 row_ror:8 row_mask:0xf bank_mask:0xf
    v_fma_f32 v186, v206, v187, v186
    s_nop 0
    v_fmac_f32_dpp v186, v187, v207 row_ror:8 row_mask:0xf bank_mask:0xf
    v_fma_f32 v185, v206, v186, v185
    s_nop 0
    v_fmac_f32_dpp v185, v186, v207 row_ror:8 row_mask:0xf bank_mask:0xf
    v_and_b32 v216, 15, v1
    v_lshlrev_b32 v216, 2, v216
    v_add_u32 v217, 64, v216
    v_add_u32 v218, 128, v216
    v_add_u32 v219, 192, v216
    ds_bpermute_b32 v186, v216, v185
    ds_bpermute_b32 v187, v217, v185
    ds_bpermute_b32 v188, v218, v185
    ds_bpermute_b32 v189, v219, v185
    s_waitcnt lgkmcnt(0)
    v_fma_f32 v188, v202, v189, v188
    s_nop 0
    v_fmac_f32_dpp v188, v189, v203 row_ror:8 row_mask:0xf bank_mask:0xf
    v_fma_f32 v187, v202, v188, v187
    s_nop 0
    v_fmac_f32_dpp v187, v188, v203 row_ror:8 row_mask:0xf bank_mask:0xf
    v_fma_f32 v186, v202, v187, v186
    s_nop 0
    v_fmac_f32_dpp v186, v187, v203 row_ror:8 row_mask:0xf bank_mask:0xf
    v_fma_f32 v184, v204, v186, v184
    s_nop 0
    v_fmac_f32_dpp v184, v186, v205 row_ror:8 row_mask:0xf bank_mask:0xf
    v_mul_f32 v185, v199, v184
    s_nop 0
    v_fmac_f32_dpp v185, v184, v200 row_ror:8 row_mask:0xf bank_mask:0xf
    v_mul_f32 v186, v222, v184
    s_nop 0
    v_fmac_f32_dpp v186, v184, v223 row_ror:8 row_mask:0xf bank_mask:0xf
    v_add_f32 v168, v168, v185
    v_mul_f32 v187, v222, v185
    v_mul_f32 v188, v222, v186
    v_add_f32 v169, v169, v186
    v_fmac_f32_dpp v187, v185, v223 row_ror:8 row_mask:0xf bank_mask:0xf
    v_fmac_f32_dpp v188, v186, v223 row_ror:8 row_mask:0xf bank_mask:0xf
    v_add_f32 v170, v170, v187
    v_mul_f32 v185, v222, v187
    v_mul_f32 v186, v222, v188
    v_add_f32 v171, v171, v188
    v_fmac_f32_dpp v185, v187, v223 row_ror:8 row_mask:0xf bank_mask:0xf
    v_fmac_f32_dpp v186, v188, v223 row_ror:8 row_mask:0xf bank_mask:0xf
    v_add_f32 v172, v172, v185
    v_mul_f32 v187, v222, v185
    v_mul_f32 v188, v222, v186
    v_add_f32 v173, v173, v186
    v_fmac_f32_dpp v187, v185, v223 row_ror:8 row_mask:0xf bank_mask:0xf
    v_fmac_f32_dpp v188, v186, v223 row_ror:8 row_mask:0xf bank_mask:0xf
    v_add_f32 v174, v174, v187
    v_mul_f32 v185, v222, v187
    v_mul_f32 v186, v222, v188
    v_add_f32 v175, v175, v188
    v_fmac_f32_dpp v185, v187, v223 row_ror:8 row_mask:0xf bank_mask:0xf
    v_fmac_f32_dpp v186, v188, v223 row_ror:8 row_mask:0xf bank_mask:0xf
    v_add_f32 v176, v176, v185
    v_mul_f32 v187, v222, v185
    v_mul_f32 v188, v222, v186
    v_add_f32 v177, v177, v186
    v_fmac_f32_dpp v187, v185, v223 row_ror:8 row_mask:0xf bank_mask:0xf
    v_fmac_f32_dpp v188, v186, v223 row_ror:8 row_mask:0xf bank_mask:0xf
    v_add_f32 v178, v178, v187
    v_mul_f32 v185, v222, v187
    v_mul_f32 v186, v222, v188
    v_add_f32 v179, v179, v188
    v_fmac_f32_dpp v185, v187, v223 row_ror:8 row_mask:0xf bank_mask:0xf
    v_fmac_f32_dpp v186, v188, v223 row_ror:8 row_mask:0xf bank_mask:0xf
    v_add_f32 v180, v180, v185
    v_mul_f32 v187, v222, v185
    v_mul_f32 v188, v222, v186
    v_add_f32 v181, v181, v186
    v_fmac_f32_dpp v187, v185, v223 row_ror:8 row_mask:0xf bank_mask:0xf
    v_fmac_f32_dpp v188, v186, v223 row_ror:8 row_mask:0xf bank_mask:0xf
    v_add_f32 v182, v182, v187
    v_add_f32 v183, v183, v188
    v_cvt_pk_bf16_f32 v168, v168, v169
    v_cvt_pk_bf16_f32 v169, v170, v171
    v_cvt_pk_bf16_f32 v170, v172, v173
    v_cvt_pk_bf16_f32 v171, v174, v175
    v_cvt_pk_bf16_f32 v172, v176, v177
    v_cvt_pk_bf16_f32 v173, v178, v179
    v_cvt_pk_bf16_f32 v174, v180, v181
    v_cvt_pk_bf16_f32 v175, v182, v183
    buffer_store_dwordx4 v[168:171], v3, s[48:51], s22 offen sc1
    buffer_store_dwordx4 v[172:175], v3, s[48:51], s22 offen offset:1024 sc1
    s_waitcnt vmcnt(6)
    v_cmp_ne_u32 vcc, s15, v24
    s_cbranch_vccnz SLOW_20
BACK_21:
    s_waitcnt vmcnt(5)
    v_cmp_ne_u32 vcc, s15, v25
    s_cbranch_vccnz SLOW_22
BACK_23:
    s_waitcnt vmcnt(4)
    v_cmp_ne_u32 vcc, s15, v26
    s_cbranch_vccnz SLOW_24
BACK_25:
    s_waitcnt vmcnt(3)
    v_cmp_ne_u32 vcc, s15, v27
    s_cbranch_vccnz SLOW_26
BACK_27:
    s_lshl_b32 s75, s3, 1
    s_add_u32 s75, s75, s4
    s_sub_u32 s75, s75, 30
    s_lshl_b32 s75, s75, 3
    s_add_u32 s75, s75, s7
    s_lshl_b32 s75, s75, 1
    s_add_u32 s73, s75, 1
    s_mov_b32 s74, 8
    s_mul_i32 s16, s75, 9
    s_add_u32 s16, s16, s74
    s_mul_i32 s17, s16, 4352
    s_add_u32 s17, s17, 25165824
    s_and_b32 s12, s75, 7
    s_lshl_b32 s12, s12, 3
    s_add_u32 s12, s12, 512
    v_and_b32 v198, 7, v1
    v_add_u32 v196, s12, v198
    v_lshlrev_b32 v198, 1, v196
    s_lshr_b32 s22, s75, 3
    s_mul_i32 s22, s22, 147456
    s_lshl_b32 s12, s12, 8
    s_add_u32 s22, s22, s12
    s_add_u32 s22, s22, 37748736
    global_load_ushort v193, v198, s[18:19]
    global_load_ushort v194, v198, s[20:21]
    global_load_ushort v195, v198, s[30:31]
    s_lshl_b32 s16, s16, 6
    v_lshrrev_b32 v198, 4, v1
    v_mul_u32_u24 v198, 36864, v198
    v_and_b32 v197, 15, v1
    v_lshl_add_u32 v197, v197, 2, s16
    v_sub_u32 v197, v197, v198
    v_subrev_u32 v197, 4608, v197
    buffer_load_dword v185, v197, s[60:63], 0 offen sc1
    v_subrev_u32 v197, 4608, v197
    buffer_load_dword v186, v197, s[60:63], 0 offen sc1
    v_subrev_u32 v197, 4608, v197
    buffer_load_dword v187, v197, s[60:63], 0 offen sc1
    v_subrev_u32 v197, 4608, v197
    buffer_load_dword v188, v197, s[60:63], 0 offen sc1
    v_subrev_u32 v197, 4608, v197
    buffer_load_dword v189, v197, s[60:63], 0 offen sc1
    v_subrev_u32 v197, 4608, v197
    buffer_load_dword v190, v197, s[60:63], 0 offen sc1
    v_subrev_u32 v197, 4608, v197
    buffer_load_dword v191, v197, s[60:63], 0 offen sc1
    v_subrev_u32 v197, 4608, v197
    buffer_load_dword v192, v197, s[60:63], 0 offen sc1
    buffer_load_dwordx4 v[168:171], v3, s[48:51], s17 offen offset:0 sc1
    buffer_load_dwordx4 v[172:175], v3, s[48:51], s17 offen offset:1024 sc1
    buffer_load_dwordx4 v[176:179], v3, s[48:51], s17 offen offset:2048 sc1
    buffer_load_dwordx4 v[180:183], v3, s[48:51], s17 offen offset:3072 sc1
    v_lshlrev_b32 v198, 2, v1
    s_add_u32 s12, s17, 4096
    buffer_load_dword v184, v198, s[48:51], s12 offen sc1
    s_mul_i32 s16, s73, 9
    s_add_u32 s16, s16, s74
    s_mul_i32 s17, s16, 4352
    s_add_u32 s17, s17, 25165824
    s_and_b32 s12, s73, 7
    s_lshl_b32 s12, s12, 3
    s_add_u32 s12, s12, 512
    v_and_b32 v142, 7, v1
    v_add_u32 v140, s12, v142
    v_lshlrev_b32 v142, 1, v140
    s_lshr_b32 s72, s73, 3
    s_mul_i32 s72, s72, 147456
    s_lshl_b32 s12, s12, 8
    s_add_u32 s72, s72, s12
    s_add_u32 s72, s72, 37748736
    global_load_ushort v137, v142, s[18:19]
    global_load_ushort v138, v142, s[20:21]
    global_load_ushort v139, v142, s[30:31]
    s_lshl_b32 s16, s16, 6
    v_lshrrev_b32 v142, 4, v1
    v_mul_u32_u24 v142, 36864, v142
    v_and_b32 v141, 15, v1
    v_lshl_add_u32 v141, v141, 2, s16
    v_sub_u32 v141, v141, v142
    v_subrev_u32 v141, 4608, v141
    buffer_load_dword v129, v141, s[60:63], 0 offen sc1
    v_subrev_u32 v141, 4608, v141
    buffer_load_dword v130, v141, s[60:63], 0 offen sc1
    v_subrev_u32 v141, 4608, v141
    buffer_load_dword v131, v141, s[60:63], 0 offen sc1
    v_subrev_u32 v141, 4608, v141
    buffer_load_dword v132, v141, s[60:63], 0 offen sc1
    v_subrev_u32 v141, 4608, v141
    buffer_load_dword v133, v141, s[60:63], 0 offen sc1
    v_subrev_u32 v141, 4608, v141
    buffer_load_dword v134, v141, s[60:63], 0 offen sc1
    v_subrev_u32 v141, 4608, v141
    buffer_load_dword v135, v141, s[60:63], 0 offen sc1
    v_subrev_u32 v141, 4608, v141
    buffer_load_dword v136, v141, s[60:63], 0 offen sc1
    buffer_load_dwordx4 v[112:115], v3, s[48:51], s17 offen offset:0 sc1
    buffer_load_dwordx4 v[116:119], v3, s[48:51], s17 offen offset:1024 sc1
    buffer_load_dwordx4 v[120:123], v3, s[48:51], s17 offen offset:2048 sc1
    buffer_load_dwordx4 v[124:127], v3, s[48:51], s17 offen offset:3072 sc1
    v_lshlrev_b32 v142, 2, v1
    s_add_u32 s12, s17, 4096
    buffer_load_dword v128, v142, s[48:51], s12 offen sc1
    s_waitcnt vmcnt(32)
    s_barrier
    s_cmp_lg_u32 s7, 1
    s_cbranch_scc1 NOFLAG_28
    s_add_u32 s14, s34, 3072
    v_mov_b32 v2, s15
    s_mov_b64 exec, 1
    buffer_store_dword v2, off, s[48:51], s14 sc1
    s_mov_b64 exec, -1
NOFLAG_28:
    s_cmp_lg_u32 s7, 2
    s_cbranch_scc1 NOFLAG_29
    s_lshr_b32 s14, s11, 4
    s_lshl_b32 s14, s14, 7
    s_and_b32 s12, s11, 15
    s_lshl_b32 s12, s12, 2
    s_add_u32 s14, s14, s12
    s_add_u32 s14, s14, 65024000
    v_mov_b32 v2, s15
    s_mov_b64 exec, 1
    buffer_store_dword v2, off, s[48:51], s14 sc1
    s_mov_b64 exec, -1
NOFLAG_29:
IDLE_LOOP:
    s_waitcnt vmcnt(0)
    v_lshlrev_b32 v193, 16, v193
    v_lshlrev_b32 v194, 16, v194
    v_lshlrev_b32 v195, 16, v195
    v_mul_f32 v208, 0x3fb8aa3b, v195
    v_exp_f32 v208, v208
    s_nop 0
    v_cvt_pk_bf16_f32 v208, v208, v208
    v_lshlrev_b32 v208, 16, v208
    v_mul_f32 v209, v208, v193
    v_mul_f32 v210, v208, v194
    v_mul_f32 v209, 0x3fb8aa3b, v209
    v_exp_f32 v209, v209
    v_mul_f32 v210, 0x3e22f983, v210
    v_rndne_f32 v211, v210
    v_sub_f32 v210, v210, v211
    v_cos_f32 v211, v210
    v_sin_f32 v210, v210
    s_nop 0
    v_mul_f32 v199, v209, v211
    v_mul_f32 v200, v209, v210
    v_and_b32 v201, 8, v1
    v_lshlrev_b32 v201, 28, v201
    v_mul_f32 v208, v200, v200
    v_mul_f32 v223, v199, v200
    v_fma_f32 v222, v199, v199, -v208
    v_add_f32 v223, v223, v223
    v_mul_f32 v208, v223, v223
    v_mul_f32 v203, v222, v223
    v_fma_f32 v202, v222, v222, -v208
    v_add_f32 v203, v203, v203
    v_xor_b32 v223, v201, v223
    v_mul_f32 v208, v203, v203
    v_mul_f32 v203, v202, v203
    v_fma_f32 v202, v202, v202, -v208
    v_add_f32 v203, v203, v203
    v_mul_f32 v208, v203, v203
    v_mul_f32 v203, v202, v203
    v_fma_f32 v202, v202, v202, -v208
    v_add_f32 v203, v203, v203
    v_mov_b32 v212, v202
    v_mov_b32 v213, v203
    v_mul_f32 v208, v203, v203
    v_mul_f32 v203, v202, v203
    v_fma_f32 v202, v202, v202, -v208
    v_add_f32 v203, v203, v203
    v_mul_f32 v214, v202, v212
    v_mul_f32 v215, v202, v213
    v_fma_f32 v214, -v203, v213, v214
    v_fmac_f32 v215, v203, v212
    v_lshrrev_b32 v220, 4, v1
    v_mov_b32 v204, 1.0
    v_mov_b32 v205, 0
    v_cmp_eq_u32 vcc, 1, v220
    s_nop 1
    v_cndmask_b32 v204, v204, v212, vcc
    v_cndmask_b32 v205, v205, v213, vcc
    v_cmp_eq_u32 vcc, 2, v220
    s_nop 1
    v_cndmask_b32 v204, v204, v202, vcc
    v_cndmask_b32 v205, v205, v203, vcc
    v_cmp_eq_u32 vcc, 3, v220
    s_nop 1
    v_cndmask_b32 v204, v204, v214, vcc
    v_cndmask_b32 v205, v205, v215, vcc
    v_xor_b32 v205, v201, v205
    v_mul_f32 v208, v203, v203
    v_mul_f32 v207, v202, v203
    v_fma_f32 v206, v202, v202, -v208
    v_add_f32 v207, v207, v207
    v_mul_f32 v208, v207, v207
    v_mul_f32 v203, v206, v207
    v_fma_f32 v202, v206, v206, -v208
    v_add_f32 v203, v203, v203
    v_mul_f32 v208, v203, v203
    v_mul_f32 v203, v202, v203
    v_fma_f32 v202, v202, v202, -v208
    v_add_f32 v203, v203, v203
    v_mul_f32 v208, v203, v203
    v_mul_f32 v203, v202, v203
    v_fma_f32 v202, v202, v202, -v208
    v_add_f32 v203, v203, v203
    v_xor_b32 v207, v201, v207
    v_xor_b32 v203, v201, v203
    v_xor_b32 v200, v201, v200
    v_fma_f32 v191, v206, v192, v191
    s_nop 0
    v_fmac_f32_dpp v191, v192, v207 row_ror:8 row_mask:0xf bank_mask:0xf
    v_fma_f32 v190, v206, v191, v190
    s_nop 0
    v_fmac_f32_dpp v190, v191, v207 row_ror:8 row_mask:0xf bank_mask:0xf
    v_fma_f32 v189, v206, v190, v189
    s_nop 0
    v_fmac_f32_dpp v189, v190, v207 row_ror:8 row_mask:0xf bank_mask:0xf
    v_fma_f32 v188, v206, v189, v188
    s_nop 0
    v_fmac_f32_dpp v188, v189, v207 row_ror:8 row_mask:0xf bank_mask:0xf
    v_fma_f32 v187, v206, v188, v187
    s_nop 0
    v_fmac_f32_dpp v187, v188, v207 row_ror:8 row_mask:0xf bank_mask:0xf
    v_fma_f32 v186, v206, v187, v186
    s_nop 0
    v_fmac_f32_dpp v186, v187, v207 row_ror:8 row_mask:0xf bank_mask:0xf
    v_fma_f32 v185, v206, v186, v185
    s_nop 0
    v_fmac_f32_dpp v185, v186, v207 row_ror:8 row_mask:0xf bank_mask:0xf
    v_and_b32 v216, 15, v1
    v_lshlrev_b32 v216, 2, v216
    v_add_u32 v217, 64, v216
    v_add_u32 v218, 128, v216
    v_add_u32 v219, 192, v216
    ds_bpermute_b32 v186, v216, v185
    ds_bpermute_b32 v187, v217, v185
    ds_bpermute_b32 v188, v218, v185
    ds_bpermute_b32 v189, v219, v185
    s_waitcnt lgkmcnt(0)
    v_fma_f32 v188, v202, v189, v188
    s_nop 0
    v_fmac_f32_dpp v188, v189, v203 row_ror:8 row_mask:0xf bank_mask:0xf
    v_fma_f32 v187, v202, v188, v187
    s_nop 0
    v_fmac_f32_dpp v187, v188, v203 row_ror:8 row_mask:0xf bank_mask:0xf
    v_fma_f32 v186, v202, v187, v186
    s_nop 0
    v_fmac_f32_dpp v186, v187, v203 row_ror:8 row_mask:0xf bank_mask:0xf
    v_fma_f32 v184, v204, v186, v184
    s_nop 0
    v_fmac_f32_dpp v184, v186, v205 row_ror:8 row_mask:0xf bank_mask:0xf
    v_mul_f32 v185, v199, v184
    s_nop 0
    v_fmac_f32_dpp v185, v184, v200 row_ror:8 row_mask:0xf bank_mask:0xf
    v_mul_f32 v186, v222, v184
    s_nop 0
    v_fmac_f32_dpp v186, v184, v223 row_ror:8 row_mask:0xf bank_mask:0xf
    v_add_f32 v168, v168, v185
    v_mul_f32 v187, v222, v185
    v_mul_f32 v188, v222, v186
    v_add_f32 v169, v169, v186
    v_fmac_f32_dpp v187, v185, v223 row_ror:8 row_mask:0xf bank_mask:0xf
    v_fmac_f32_dpp v188, v186, v223 row_ror:8 row_mask:0xf bank_mask:0xf
    v_add_f32 v170, v170, v187
    v_mul_f32 v185, v222, v187
    v_mul_f32 v186, v222, v188
    v_add_f32 v171, v171, v188
    v_fmac_f32_dpp v185, v187, v223 row_ror:8 row_mask:0xf bank_mask:0xf
    v_fmac_f32_dpp v186, v188, v223 row_ror:8 row_mask:0xf bank_mask:0xf
    v_add_f32 v172, v172, v185
    v_mul_f32 v187, v222, v185
    v_mul_f32 v188, v222, v186
    v_add_f32 v173, v173, v186
    v_fmac_f32_dpp v187, v185, v223 row_ror:8 row_mask:0xf bank_mask:0xf
    v_fmac_f32_dpp v188, v186, v223 row_ror:8 row_mask:0xf bank_mask:0xf
    v_add_f32 v174, v174, v187
    v_mul_f32 v185, v222, v187
    v_mul_f32 v186, v222, v188
    v_add_f32 v175, v175, v188
    v_fmac_f32_dpp v185, v187, v223 row_ror:8 row_mask:0xf bank_mask:0xf
    v_fmac_f32_dpp v186, v188, v223 row_ror:8 row_mask:0xf bank_mask:0xf
    v_add_f32 v176, v176, v185
    v_mul_f32 v187, v222, v185
    v_mul_f32 v188, v222, v186
    v_add_f32 v177, v177, v186
    v_fmac_f32_dpp v187, v185, v223 row_ror:8 row_mask:0xf bank_mask:0xf
    v_fmac_f32_dpp v188, v186, v223 row_ror:8 row_mask:0xf bank_mask:0xf
    v_add_f32 v178, v178, v187
    v_mul_f32 v185, v222, v187
    v_mul_f32 v186, v222, v188
    v_add_f32 v179, v179, v188
    v_fmac_f32_dpp v185, v187, v223 row_ror:8 row_mask:0xf bank_mask:0xf
    v_fmac_f32_dpp v186, v188, v223 row_ror:8 row_mask:0xf bank_mask:0xf
    v_add_f32 v180, v180, v185
    v_mul_f32 v187, v222, v185
    v_mul_f32 v188, v222, v186
    v_add_f32 v181, v181, v186
    v_fmac_f32_dpp v187, v185, v223 row_ror:8 row_mask:0xf bank_mask:0xf
    v_fmac_f32_dpp v188, v186, v223 row_ror:8 row_mask:0xf bank_mask:0xf
    v_add_f32 v182, v182, v187
    v_add_f32 v183, v183, v188
    v_cvt_pk_bf16_f32 v168, v168, v169
    v_cvt_pk_bf16_f32 v169, v170, v171
    v_cvt_pk_bf16_f32 v170, v172, v173
    v_cvt_pk_bf16_f32 v171, v174, v175
    v_cvt_pk_bf16_f32 v172, v176, v177
    v_cvt_pk_bf16_f32 v173, v178, v179
    v_cvt_pk_bf16_f32 v174, v180, v181
    v_cvt_pk_bf16_f32 v175, v182, v183
    buffer_store_dwordx4 v[168:171], v3, s[48:51], s22 offen sc1
    buffer_store_dwordx4 v[172:175], v3, s[48:51], s22 offen offset:1024 sc1
    s_cmp_eq_u32 s74, 0
    s_cbranch_scc1 IDLE_DONE
    s_mov_b32 s74, 0
    s_mov_b32 s22, s72
    v_mov_b32 v168, v112
    v_mov_b32 v169, v113
    v_mov_b32 v170, v114
    v_mov_b32 v171, v115
    v_mov_b32 v172, v116
    v_mov_b32 v173, v117
    v_mov_b32 v174, v118
    v_mov_b32 v175, v119
    v_mov_b32 v176, v120
    v_mov_b32 v177, v121
    v_mov_b32 v178, v122
    v_mov_b32 v179, v123
    v_mov_b32 v180, v124
    v_mov_b32 v181, v125
    v_mov_b32 v182, v126
    v_mov_b32 v183, v127
    v_mov_b32 v184, v128
    v_mov_b32 v185, v129
    v_mov_b32 v186, v130
    v_mov_b32 v187, v131
    v_mov_b32 v188, v132
    v_mov_b32 v189, v133
    v_mov_b32 v190, v134
    v_mov_b32 v191, v135
    v_mov_b32 v192, v136
    v_mov_b32 v193, v137
    v_mov_b32 v194, v138
    v_mov_b32 v195, v139
    v_mov_b32 v196, v140
    s_branch IDLE_LOOP
IDLE_DONE:
    s_lshr_b32 s14, s75, 4
    s_lshl_b32 s14, s14, 7
    s_and_b32 s12, s75, 15
    s_lshl_b32 s12, s12, 2
    s_add_u32 s14, s14, s12
    s_add_u32 s14, s14, 65024064
    v_mov_b32 v12, s15
    v_mov_b32 v13, s15
    s_mov_b64 exec, 1
    s_waitcnt vmcnt(0)
    buffer_store_dwordx2 v[12:13], off, s[48:51], s14 sc1
    s_mov_b64 exec, -1
    s_branch K_FIN
K2_GO:
    s_add_u32 s78, s32, 1024
    s_add_u32 s79, s32, 2048
    s_add_u32 s8, s32, 3072
    ds_read_b128 v[24:27], v224 offset:40960
    ds_read_b64_tr_b16 v[32:33], v226 offset:40960
    ds_read_b64_tr_b16 v[34:35], v226 offset:44032
    ds_read_b64_tr_b16 v[36:37], v227 offset:40960
    ds_read_b64_tr_b16 v[38:39], v227 offset:44032
    ds_read_b64_tr_b16 v[40:41], v228 offset:40960
    ds_read_b64_tr_b16 v[42:43], v228 offset:44032
    ds_read_b128 v[28:31], v224 offset:41984
    ds_read_b64_tr_b16 v[44:45], v226 offset:47104
    ds_read_b64_tr_b16 v[46:47], v226 offset:50176
    s_waitcnt lgkmcnt(7)
    v_mfma_f32_32x32x16_bf16 v[64:79], v[24:27], v[32:35], 0
    v_mul_f32 v16, v48, v48
    v_mul_f32 v17, v49, v49
    v_mul_f32 v18, v50, v50
    v_mul_f32 v19, v51, v51
    ds_read_b64_tr_b16 v[128:129], v227 offset:47104
    ds_read_b64_tr_b16 v[130:131], v227 offset:50176
    s_waitcnt lgkmcnt(7)
    v_mfma_f32_32x32x16_bf16 v[80:95], v[24:27], v[36:39], 0
    s_add_u32 s73, s44, 15
    s_lshr_b32 s12, s73, 2
    s_lshl_b32 s73, s73, 1
    s_add_u32 s73, s73, s12
    s_lshl_b32 s73, s73, 1
    s_add_u32 s73, s73, s10
    s_mul_i32 s73, s73, 36864
    s_add_u32 s73, s73, s80
    s_add_u32 m0, s83, 0
    s_nop 0
    buffer_load_dwordx4 v8, s[56:59], s73 offen lds
    v_fma_f32 v16, v16, s42, v11
    v_fma_f32 v17, v17, s42, v11
    v_fma_f32 v18, v18, s42, v11
    v_fma_f32 v19, v19, s42, v11
    ds_read_b64_tr_b16 v[132:133], v228 offset:47104
    ds_read_b64_tr_b16 v[134:135], v228 offset:50176
    s_waitcnt lgkmcnt(7)
    v_mfma_f32_32x32x16_bf16 v[96:111], v[24:27], v[40:43], 0
    v_mul_f32 v16, v16, v48
    v_mul_f32 v17, v17, v49
    v_mul_f32 v18, v18, v50
    v_mul_f32 v19, v19, v51
    ds_read_b128 v[24:27], v224 offset:43008
    ds_read_b64_tr_b16 v[32:33], v226 offset:53248
    ds_read_b64_tr_b16 v[34:35], v226 offset:56320
    s_waitcnt lgkmcnt(7)
    v_mfma_f32_32x32x16_bf16 v[64:79], v[28:31], v[44:47], v[64:79]
    s_add_u32 m0, s83, 1024
    s_nop 0
    buffer_load_dwordx4 v9, s[56:59], s73 offen lds
    v_exp_f32 v16, v16
    v_exp_f32 v17, v17
    v_exp_f32 v18, v18
    v_exp_f32 v19, v19
    ds_read_b64_tr_b16 v[36:37], v227 offset:53248
    ds_read_b64_tr_b16 v[38:39], v227 offset:56320
    s_waitcnt lgkmcnt(7)
    v_mfma_f32_32x32x16_bf16 v[80:95], v[28:31], v[128:131], v[80:95]
    v_mul_f32 v48, v48, v56
    v_mul_f32 v49, v49, v57
    v_mul_f32 v50, v50, v58
    v_mul_f32 v51, v51, v59
    ds_read_b64_tr_b16 v[40:41], v228 offset:53248
    ds_read_b64_tr_b16 v[42:43], v228 offset:56320
    s_waitcnt lgkmcnt(7)
    v_mfma_f32_32x32x16_bf16 v[96:111], v[28:31], v[132:135], v[96:111]
    s_add_u32 m0, s83, 2048
    s_nop 0
    buffer_load_dwordx4 v10, s[56:59], s73 offen lds
    v_add_f32 v16, 1.0, v16
    v_add_f32 v17, 1.0, v17
    v_add_f32 v18, 1.0, v18
    v_add_f32 v19, 1.0, v19
    ds_read_b128 v[28:31], v224 offset:44032
    ds_read_b64_tr_b16 v[44:45], v226 offset:59392
    ds_read_b64_tr_b16 v[46:47], v226 offset:62464
    s_waitcnt lgkmcnt(7)
    v_mfma_f32_32x32x16_bf16 v[64:79], v[24:27], v[32:35], v[64:79]
    v_rcp_f32 v16, v16
    v_rcp_f32 v17, v17
    v_rcp_f32 v18, v18
    v_rcp_f32 v19, v19
    ds_read_b64_tr_b16 v[128:129], v227 offset:59392
    ds_read_b64_tr_b16 v[130:131], v227 offset:62464
    s_waitcnt lgkmcnt(7)
    v_mfma_f32_32x32x16_bf16 v[80:95], v[24:27], v[36:39], v[80:95]
    s_add_u32 s72, s44, 15
    s_lshr_b32 s12, s72, 2
    s_lshl_b32 s72, s72, 1
    s_add_u32 s72, s72, s12
    s_lshl_b32 s72, s72, 1
    s_add_u32 s72, s72, s9
    s_lshl_b32 s72, s72, 11
    s_add_u32 s72, s72, s76
    s_add_u32 m0, s82, 0
    s_nop 0
    buffer_load_dwordx4 v3, s[48:51], s72 offen sc1 lds
    s_nop 0
    v_mul_f32 v48, v48, v16
    v_mul_f32 v49, v49, v17
    v_mul_f32 v50, v50, v18
    ds_read_b64_tr_b16 v[132:133], v228 offset:59392
    ds_read_b64_tr_b16 v[134:135], v228 offset:62464
    s_waitcnt lgkmcnt(7)
    v_mfma_f32_32x32x16_bf16 v[96:111], v[24:27], v[40:43], v[96:111]
    v_mul_f32 v51, v51, v19
    v_cvt_pk_bf16_f32 v20, v48, v49
    v_cvt_pk_bf16_f32 v21, v50, v51
    v_mul_f32 v16, v52, v52
    s_waitcnt vmcnt(27)
    s_barrier
    ds_read_b128 v[24:27], v225 offset:0
    ds_read_b64_tr_b16 v[32:33], v229 offset:0
    ds_read_b64_tr_b16 v[34:35], v229 offset:3072
    s_waitcnt lgkmcnt(7)
    v_mfma_f32_32x32x16_bf16 v[64:79], v[28:31], v[44:47], v[64:79]
    s_add_u32 m0, s82, 0
    s_nop 0
    buffer_load_dwordx4 v3, s[48:51], s72 offen offset:1024 sc1 lds
    v_mul_f32 v17, v53, v53
    v_mul_f32 v18, v54, v54
    v_mul_f32 v19, v55, v55
    v_fma_f32 v16, v16, s42, v11
    ds_read_b64_tr_b16 v[36:37], v230 offset:0
    ds_read_b64_tr_b16 v[38:39], v230 offset:3072
    s_waitcnt lgkmcnt(7)
    v_mfma_f32_32x32x16_bf16 v[80:95], v[28:31], v[128:131], v[80:95]
    v_fma_f32 v17, v17, s42, v11
    v_fma_f32 v18, v18, s42, v11
    v_fma_f32 v19, v19, s42, v11
    v_mul_f32 v16, v16, v52
    ds_read_b64_tr_b16 v[40:41], v231 offset:0
    ds_read_b64_tr_b16 v[42:43], v231 offset:3072
    s_waitcnt lgkmcnt(7)
    v_mfma_f32_32x32x16_bf16 v[96:111], v[28:31], v[132:135], v[96:111]
    v_mul_f32 v17, v17, v53
    v_mul_f32 v18, v18, v54
    v_mul_f32 v19, v19, v55
    v_exp_f32 v16, v16
    ds_read_b128 v[28:31], v225 offset:1024
    ds_read_b64_tr_b16 v[44:45], v229 offset:6144
    ds_read_b64_tr_b16 v[46:47], v229 offset:9216
    s_waitcnt lgkmcnt(7)
    v_mfma_f32_32x32x16_bf16 v[64:79], v[24:27], v[32:35], v[64:79]
    v_exp_f32 v17, v17
    v_exp_f32 v18, v18
    v_exp_f32 v19, v19
    v_mul_f32 v52, v52, v60
    ds_read_b64_tr_b16 v[128:129], v230 offset:6144
    ds_read_b64_tr_b16 v[130:131], v230 offset:9216
    s_waitcnt lgkmcnt(7)
    v_mfma_f32_32x32x16_bf16 v[80:95], v[24:27], v[36:39], v[80:95]
    v_mul_f32 v53, v53, v61
    v_mul_f32 v54, v54, v62
    v_mul_f32 v55, v55, v63
    v_add_f32 v16, 1.0, v16
    ds_read_b64_tr_b16 v[132:133], v231 offset:6144
    ds_read_b64_tr_b16 v[134:135], v231 offset:9216
    s_waitcnt lgkmcnt(7)
    v_mfma_f32_32x32x16_bf16 v[96:111], v[24:27], v[40:43], v[96:111]
    v_add_f32 v17, 1.0, v17
    v_add_f32 v18, 1.0, v18
    v_add_f32 v19, 1.0, v19
    v_rcp_f32 v16, v16
    ds_read_b128 v[24:27], v225 offset:2048
    ds_read_b64_tr_b16 v[32:33], v229 offset:12288
    ds_read_b64_tr_b16 v[34:35], v229 offset:15360
    s_waitcnt lgkmcnt(7)
    v_mfma_f32_32x32x16_bf16 v[64:79], v[28:31], v[44:47], v[64:79]
    v_rcp_f32 v17, v17
    v_rcp_f32 v18, v18
    v_rcp_f32 v19, v19
    s_nop 0
    ds_read_b64_tr_b16 v[36:37], v230 offset:12288
    ds_read_b64_tr_b16 v[38:39], v230 offset:15360
    s_waitcnt lgkmcnt(7)
    v_mfma_f32_32x32x16_bf16 v[80:95], v[28:31], v[128:131], v[80:95]
    v_mul_f32 v52, v52, v16
    v_mul_f32 v53, v53, v17
    v_mul_f32 v54, v54, v18
    v_mul_f32 v55, v55, v19
    ds_read_b64_tr_b16 v[40:41], v231 offset:12288
    ds_read_b64_tr_b16 v[42:43], v231 offset:15360
    s_waitcnt lgkmcnt(7)
    v_mfma_f32_32x32x16_bf16 v[96:111], v[28:31], v[132:135], v[96:111]
    v_cvt_pk_bf16_f32 v22, v52, v53
    v_cvt_pk_bf16_f32 v23, v54, v55
    buffer_store_dwordx4 v[20:23], v3, s[48:51], s35 offen sc1
    ds_read_b128 v[28:31], v225 offset:3072
    ds_read_b64_tr_b16 v[44:45], v229 offset:18432
    ds_read_b64_tr_b16 v[46:47], v229 offset:21504
    s_waitcnt lgkmcnt(7)
    v_mfma_f32_32x32x16_bf16 v[64:79], v[24:27], v[32:35], v[64:79]
    s_waitcnt vmcnt(6)
    v_lshlrev_b32 v193, 16, v193
    v_lshlrev_b32 v194, 16, v194
    v_lshlrev_b32 v195, 16, v195
    v_mul_f32 v208, 0x3fb8aa3b, v195
    ds_read_b64_tr_b16 v[128:129], v230 offset:18432
    ds_read_b64_tr_b16 v[130:131], v230 offset:21504
    s_waitcnt lgkmcnt(7)
    v_mfma_f32_32x32x16_bf16 v[80:95], v[24:27], v[36:39], v[80:95]
    v_exp_f32 v208, v208
    s_nop 0
    v_cvt_pk_bf16_f32 v208, v208, v208
    v_lshlrev_b32 v208, 16, v208
    ds_read_b64_tr_b16 v[132:133], v231 offset:18432
    ds_read_b64_tr_b16 v[134:135], v231 offset:21504
    s_waitcnt lgkmcnt(7)
    v_mfma_f32_32x32x16_bf16 v[96:111], v[24:27], v[40:43], v[96:111]
    v_mul_f32 v209, v208, v193
    v_mul_f32 v210, v208, v194
    v_mul_f32 v209, 0x3fb8aa3b, v209
    v_exp_f32 v209, v209
    s_barrier
    s_cmp_lg_u32 s7, 0
    s_cbranch_scc1 NOFLAG_32
    s_add_u32 s14, s34, 2048
    v_mov_b32 v2, s15
    s_mov_b64 exec, 1
    buffer_store_dword v2, off, s[48:51], s14 sc1
    s_mov_b64 exec, -1
NOFLAG_32:
    ds_read_b128 v[24:27], v225 offset:40960
    ds_read_b64_tr_b16 v[32:33], v229 offset:40960
    ds_read_b64_tr_b16 v[34:35], v229 offset:44032
    s_waitcnt lgkmcnt(7)
    v_mfma_f32_32x32x16_bf16 v[64:79], v[28:31], v[44:47], v[64:79]
    s_add_u32 s73, s44, 20
    s_lshr_b32 s12, s73, 2
    s_lshl_b32 s73, s73, 1
    s_add_u32 s73, s73, s12
    s_lshl_b32 s73, s73, 1
    s_add_u32 s73, s73, s10
    s_mul_i32 s73, s73, 36864
    s_add_u32 s73, s73, s80
    s_add_u32 m0, s83, 40960
    s_nop 0
    buffer_load_dwordx4 v8, s[56:59], s73 offen lds
    v_mul_f32 v210, 0x3e22f983, v210
    v_rndne_f32 v211, v210
    v_sub_f32 v210, v210, v211
    v_cos_f32 v211, v210
    ds_read_b64_tr_b16 v[36:37], v230 offset:40960
    ds_read_b64_tr_b16 v[38:39], v230 offset:44032
    s_waitcnt lgkmcnt(7)
    v_mfma_f32_32x32x16_bf16 v[80:95], v[28:31], v[128:131], v[80:95]
    v_sin_f32 v210, v210
    s_nop 0
    v_mul_f32 v199, v209, v211
    v_mul_f32 v200, v209, v210
    ds_read_b64_tr_b16 v[40:41], v231 offset:40960
    ds_read_b64_tr_b16 v[42:43], v231 offset:44032
    s_waitcnt lgkmcnt(7)
    v_mfma_f32_32x32x16_bf16 v[96:111], v[28:31], v[132:135], v[96:111]
    s_add_u32 m0, s83, 41984
    s_nop 0
    buffer_load_dwordx4 v9, s[56:59], s73 offen lds
    v_and_b32 v201, 8, v1
    v_lshlrev_b32 v201, 28, v201
    v_mul_f32 v208, v200, v200
    v_mul_f32 v223, v199, v200
    ds_read_b128 v[28:31], v225 offset:41984
    ds_read_b64_tr_b16 v[44:45], v229 offset:47104
    ds_read_b64_tr_b16 v[46:47], v229 offset:50176
    s_waitcnt lgkmcnt(7)
    v_mfma_f32_32x32x16_bf16 v[64:79], v[24:27], v[32:35], v[64:79]
    v_fma_f32 v222, v199, v199, -v208
    v_add_f32 v223, v223, v223
    v_mul_f32 v208, v223, v223
    v_mul_f32 v203, v222, v223
    ds_read_b64_tr_b16 v[128:129], v230 offset:47104
    ds_read_b64_tr_b16 v[130:131], v230 offset:50176
    s_waitcnt lgkmcnt(7)
    v_mfma_f32_32x32x16_bf16 v[80:95], v[24:27], v[36:39], v[80:95]
    s_add_u32 m0, s83, 43008
    s_nop 0
    buffer_load_dwordx4 v10, s[56:59], s73 offen lds
    v_fma_f32 v202, v222, v222, -v208
    v_add_f32 v203, v203, v203
    v_xor_b32 v223, v201, v223
    v_mul_f32 v208, v203, v203
    ds_read_b64_tr_b16 v[132:133], v231 offset:47104
    ds_read_b64_tr_b16 v[134:135], v231 offset:50176
    s_waitcnt lgkmcnt(7)
    v_mfma_f32_32x32x16_bf16 v[96:111], v[24:27], v[40:43], v[96:111]
    v_mul_f32 v203, v202, v203
    v_fma_f32 v202, v202, v202, -v208
    v_add_f32 v203, v203, v203
    v_mul_f32 v208, v203, v203
    ds_read_b128 v[24:27], v225 offset:43008
    ds_read_b64_tr_b16 v[32:33], v229 offset:53248
    ds_read_b64_tr_b16 v[34:35], v229 offset:56320
    s_waitcnt lgkmcnt(7)
    v_mfma_f32_32x32x16_bf16 v[64:79], v[28:31], v[44:47], v[64:79]
    s_add_u32 s72, s44, 20
    s_lshr_b32 s12, s72, 2
    s_lshl_b32 s72, s72, 1
    s_add_u32 s72, s72, s12
    s_lshl_b32 s72, s72, 1
    s_add_u32 s72, s72, s9
    s_lshl_b32 s72, s72, 11
    s_add_u32 s72, s72, s76
    s_add_u32 m0, s82, 40960
    s_nop 0
    buffer_load_dwordx4 v3, s[48:51], s72 offen sc1 lds
    v_mul_f32 v203, v202, v203
    v_fma_f32 v202, v202, v202, -v208
    v_add_f32 v203, v203, v203
    v_mov_b32 v212, v202
    ds_read_b64_tr_b16 v[36:37], v230 offset:53248
    ds_read_b64_tr_b16 v[38:39], v230 offset:56320
    s_waitcnt lgkmcnt(7)
    v_mfma_f32_32x32x16_bf16 v[80:95], v[28:31], v[128:131], v[80:95]
    v_mov_b32 v213, v203
    v_mul_f32 v208, v203, v203
    v_mul_f32 v203, v202, v203
    v_fma_f32 v202, v202, v202, -v208
    ds_read_b64_tr_b16 v[40:41], v231 offset:53248
    ds_read_b64_tr_b16 v[42:43], v231 offset:56320
    s_waitcnt lgkmcnt(7)
    v_mfma_f32_32x32x16_bf16 v[96:111], v[28:31], v[132:135], v[96:111]
    s_add_u32 m0, s82, 40960
    s_nop 0
    buffer_load_dwordx4 v3, s[48:51], s72 offen offset:1024 sc1 lds
    v_add_f32 v203, v203, v203
    v_mul_f32 v214, v202, v212
    v_mul_f32 v215, v202, v213
    v_fma_f32 v214, -v203, v213, v214
    ds_read_b128 v[28:31], v225 offset:44032
    ds_read_b64_tr_b16 v[44:45], v229 offset:59392
    ds_read_b64_tr_b16 v[46:47], v229 offset:62464
    s_waitcnt lgkmcnt(7)
    v_mfma_f32_32x32x16_bf16 v[64:79], v[24:27], v[32:35], v[64:79]
    v_fmac_f32 v215, v203, v212
    v_lshrrev_b32 v220, 4, v1
    v_mov_b32 v204, 1.0
    v_mov_b32 v205, 0
    ds_read_b64_tr_b16 v[128:129], v230 offset:59392
    ds_read_b64_tr_b16 v[130:131], v230 offset:62464
    s_waitcnt lgkmcnt(7)
    v_mfma_f32_32x32x16_bf16 v[80:95], v[24:27], v[36:39], v[80:95]
    v_cmp_eq_u32 vcc, 1, v220
    s_nop 1
    v_cndmask_b32 v204, v204, v212, vcc
    v_cndmask_b32 v205, v205, v213, vcc
    ds_read_b64_tr_b16 v[132:133], v231 offset:59392
    ds_read_b64_tr_b16 v[134:135], v231 offset:62464
    s_waitcnt lgkmcnt(7)
    v_mfma_f32_32x32x16_bf16 v[96:111], v[24:27], v[40:43], v[96:111]
    v_cmp_eq_u32 vcc, 2, v220
    s_nop 1
    v_cndmask_b32 v204, v204, v202, vcc
    v_cndmask_b32 v205, v205, v203, vcc
    s_waitcnt vmcnt(6)
    s_barrier
    ds_read_b128 v[24:27], v224 offset:0
    ds_read_b64_tr_b16 v[32:33], v226 offset:0
    ds_read_b64_tr_b16 v[34:35], v226 offset:3072
    s_waitcnt lgkmcnt(7)
    v_mfma_f32_32x32x16_bf16 v[64:79], v[28:31], v[44:47], v[64:79]
    buffer_load_dword v12, v15, s[48:51], s78 offen sc1
    v_cmp_eq_u32 vcc, 3, v220
    s_nop 1
    v_cndmask_b32 v204, v204, v214, vcc
    v_cndmask_b32 v205, v205, v215, vcc
    ds_read_b64_tr_b16 v[36:37], v227 offset:0
    ds_read_b64_tr_b16 v[38:39], v227 offset:3072
    s_waitcnt lgkmcnt(7)
    v_mfma_f32_32x32x16_bf16 v[80:95], v[28:31], v[128:131], v[80:95]
    v_xor_b32 v205, v201, v205
    v_mul_f32 v208, v203, v203
    v_mul_f32 v207, v202, v203
    v_fma_f32 v206, v202, v202, -v208
    ds_read_b64_tr_b16 v[40:41], v228 offset:0
    ds_read_b64_tr_b16 v[42:43], v228 offset:3072
    s_waitcnt lgkmcnt(7)
    v_mfma_f32_32x32x16_bf16 v[96:111], v[28:31], v[132:135], v[96:111]
    s_add_u32 s73, s44, 25
    s_lshr_b32 s12, s73, 2
    s_lshl_b32 s73, s73, 1
    s_add_u32 s73, s73, s12
    s_lshl_b32 s73, s73, 1
    s_add_u32 s73, s73, s10
    s_mul_i32 s73, s73, 36864
    s_add_u32 s73, s73, s80
    s_add_u32 m0, s83, 81920
    s_nop 0
    buffer_load_dwordx4 v8, s[56:59], s73 offen lds
    v_add_f32 v207, v207, v207
    v_mul_f32 v208, v207, v207
    v_mul_f32 v203, v206, v207
    v_fma_f32 v202, v206, v206, -v208
    ds_read_b128 v[28:31], v224 offset:1024
    ds_read_b64_tr_b16 v[44:45], v226 offset:6144
    ds_read_b64_tr_b16 v[46:47], v226 offset:9216
    s_waitcnt lgkmcnt(7)
    v_mfma_f32_32x32x16_bf16 v[64:79], v[24:27], v[32:35], v[64:79]
    v_add_f32 v203, v203, v203
    v_mul_f32 v208, v203, v203
    v_mul_f32 v203, v202, v203
    v_fma_f32 v202, v202, v202, -v208
    ds_read_b64_tr_b16 v[128:129], v227 offset:6144
    ds_read_b64_tr_b16 v[130:131], v227 offset:9216
    s_waitcnt lgkmcnt(7)
    v_mfma_f32_32x32x16_bf16 v[80:95], v[24:27], v[36:39], v[80:95]
    s_add_u32 m0, s83, 82944
    s_nop 0
    buffer_load_dwordx4 v9, s[56:59], s73 offen lds
    v_add_f32 v203, v203, v203
    v_mul_f32 v208, v203, v203
    v_mul_f32 v203, v202, v203
    v_fma_f32 v202, v202, v202, -v208
    ds_read_b64_tr_b16 v[132:133], v228 offset:6144
    ds_read_b64_tr_b16 v[134:135], v228 offset:9216
    s_waitcnt lgkmcnt(7)
    v_mfma_f32_32x32x16_bf16 v[96:111], v[24:27], v[40:43], v[96:111]
    v_add_f32 v203, v203, v203
    v_xor_b32 v207, v201, v207
    v_xor_b32 v203, v201, v203
    v_xor_b32 v200, v201, v200
    ds_read_b128 v[24:27], v224 offset:2048
    ds_read_b64_tr_b16 v[32:33], v226 offset:12288
    ds_read_b64_tr_b16 v[34:35], v226 offset:15360
    s_waitcnt lgkmcnt(7)
    v_mfma_f32_32x32x16_bf16 v[64:79], v[28:31], v[44:47], v[64:79]
    s_add_u32 m0, s83, 83968
    s_nop 0
    buffer_load_dwordx4 v10, s[56:59], s73 offen lds
    v_fma_f32 v191, v206, v192, v191
    s_nop 0
    v_fmac_f32_dpp v191, v192, v207 row_ror:8 row_mask:0xf bank_mask:0xf
    v_fma_f32 v190, v206, v191, v190
    ds_read_b64_tr_b16 v[36:37], v227 offset:12288
    ds_read_b64_tr_b16 v[38:39], v227 offset:15360
    s_waitcnt lgkmcnt(7)
    v_mfma_f32_32x32x16_bf16 v[80:95], v[28:31], v[128:131], v[80:95]
    s_nop 0
    v_fmac_f32_dpp v190, v191, v207 row_ror:8 row_mask:0xf bank_mask:0xf
    v_fma_f32 v189, v206, v190, v189
    s_nop 0
    ds_read_b64_tr_b16 v[40:41], v228 offset:12288
    ds_read_b64_tr_b16 v[42:43], v228 offset:15360
    s_waitcnt lgkmcnt(7)
    v_mfma_f32_32x32x16_bf16 v[96:111], v[28:31], v[132:135], v[96:111]
    s_add_u32 s72, s44, 25
    s_lshr_b32 s12, s72, 2
    s_lshl_b32 s72, s72, 1
    s_add_u32 s72, s72, s12
    s_lshl_b32 s72, s72, 1
    s_add_u32 s72, s72, s9
    s_lshl_b32 s72, s72, 11
    s_add_u32 s72, s72, s76
    s_add_u32 m0, s82, 81920
    s_nop 0
    buffer_load_dwordx4 v3, s[48:51], s72 offen sc1 lds
    v_fmac_f32_dpp v189, v190, v207 row_ror:8 row_mask:0xf bank_mask:0xf
    v_fma_f32 v188, v206, v189, v188
    s_nop 0
    v_fmac_f32_dpp v188, v189, v207 row_ror:8 row_mask:0xf bank_mask:0xf
    ds_read_b128 v[28:31], v224 offset:3072
    ds_read_b64_tr_b16 v[44:45], v226 offset:18432
    ds_read_b64_tr_b16 v[46:47], v226 offset:21504
    s_waitcnt lgkmcnt(7)
    v_mfma_f32_32x32x16_bf16 v[64:79], v[24:27], v[32:35], v[64:79]
    v_fma_f32 v187, v206, v188, v187
    s_nop 0
    v_fmac_f32_dpp v187, v188, v207 row_ror:8 row_mask:0xf bank_mask:0xf
    v_fma_f32 v186, v206, v187, v186
    ds_read_b64_tr_b16 v[128:129], v227 offset:18432
    ds_read_b64_tr_b16 v[130:131], v227 offset:21504
    s_waitcnt lgkmcnt(7)
    v_mfma_f32_32x32x16_bf16 v[80:95], v[24:27], v[36:39], v[80:95]
    s_add_u32 m0, s82, 81920
    s_nop 0
    buffer_load_dwordx4 v3, s[48:51], s72 offen offset:1024 sc1 lds
    s_nop 0
    v_fmac_f32_dpp v186, v187, v207 row_ror:8 row_mask:0xf bank_mask:0xf
    v_fma_f32 v185, v206, v186, v185
    s_nop 0
    ds_read_b64_tr_b16 v[132:133], v228 offset:18432
    ds_read_b64_tr_b16 v[134:135], v228 offset:21504
    s_waitcnt lgkmcnt(7)
    v_mfma_f32_32x32x16_bf16 v[96:111], v[24:27], v[40:43], v[96:111]
    v_fmac_f32_dpp v185, v186, v207 row_ror:8 row_mask:0xf bank_mask:0xf
    v_and_b32 v216, 15, v1
    v_lshlrev_b32 v216, 2, v216
    v_add_u32 v217, 64, v216
    s_waitcnt vmcnt(6)
    s_barrier
    s_waitcnt vmcnt(5)
    v_cmp_ne_u32 vcc, s15, v12
    s_cbranch_vccnz SLOW_33
BACK_34:
    ds_read_b128 v[24:27], v224 offset:40960
    ds_read_b64_tr_b16 v[32:33], v226 offset:40960
    ds_read_b64_tr_b16 v[34:35], v226 offset:44032
    s_waitcnt lgkmcnt(7)
    v_mfma_f32_32x32x16_bf16 v[64:79], v[28:31], v[44:47], v[64:79]
    s_add_u32 s14, s44, 30
    s_lshr_b32 s12, s14, 2
    s_lshl_b32 s14, s14, 1
    s_add_u32 s14, s14, s12
    s_lshl_b32 s14, s14, 1
    s_add_u32 s14, s14, s10
    s_add_u32 s73, s44, -2
    s_lshr_b32 s13, s73, 4
    s_and_b32 s73, s73, 15
    s_lshl_b32 s73, s73, 1
    s_add_u32 s73, s73, s10
    s_lshr_b32 s12, s73, 2
    s_lshl_b32 s73, s73, 1
    s_add_u32 s73, s73, s12
    s_lshl_b32 s73, s73, 1
    s_add_u32 s73, s73, s13
    s_add_u32 s73, s73, 2
    s_cmp_lt_u32 s44, 2
    s_cselect_b32 s73, s14, s73
    s_mul_i32 s73, s73, 36864
    s_add_u32 s73, s73, s80
    s_add_u32 m0, s83, 122880
    s_nop 0
    buffer_load_dwordx4 v8, s[56:59], s73 offen lds
    v_add_u32 v218, 128, v216
    v_add_u32 v219, 192, v216
    ds_bpermute_b32 v186, v216, v185
    ds_bpermute_b32 v187, v217, v185
    ds_read_b64_tr_b16 v[36:37], v227 offset:40960
    ds_read_b64_tr_b16 v[38:39], v227 offset:44032
    s_waitcnt lgkmcnt(9)
    v_mfma_f32_32x32x16_bf16 v[80:95], v[28:31], v[128:131], v[80:95]
    ds_bpermute_b32 v188, v218, v185
    ds_bpermute_b32 v189, v219, v185
    s_waitcnt lgkmcnt(0)
    v_fma_f32 v188, v202, v189, v188
    s_nop 0
    ds_read_b64_tr_b16 v[40:41], v228 offset:40960
    ds_read_b64_tr_b16 v[42:43], v228 offset:44032
    v_mfma_f32_32x32x16_bf16 v[96:111], v[28:31], v[132:135], v[96:111]
    s_add_u32 m0, s83, 123904
    s_nop 0
    buffer_load_dwordx4 v9, s[56:59], s73 offen lds
    v_fmac_f32_dpp v188, v189, v203 row_ror:8 row_mask:0xf bank_mask:0xf
    v_fma_f32 v187, v202, v188, v187
    s_nop 0
    v_fmac_f32_dpp v187, v188, v203 row_ror:8 row_mask:0xf bank_mask:0xf
    ds_read_b128 v[28:31], v224 offset:41984
    ds_read_b64_tr_b16 v[44:45], v226 offset:47104
    ds_read_b64_tr_b16 v[46:47], v226 offset:50176
    v_mfma_f32_32x32x16_bf16 v[64:79], v[24:27], v[32:35], v[64:79]
    v_fma_f32 v186, v202, v187, v186
    s_nop 0
    v_fmac_f32_dpp v186, v187, v203 row_ror:8 row_mask:0xf bank_mask:0xf
    v_fma_f32 v184, v204, v186, v184
    ds_read_b64_tr_b16 v[128:129], v227 offset:47104
    ds_read_b64_tr_b16 v[130:131], v227 offset:50176
    v_mfma_f32_32x32x16_bf16 v[80:95], v[24:27], v[36:39], v[80:95]
    s_add_u32 m0, s83, 124928
    s_nop 0
    buffer_load_dwordx4 v10, s[56:59], s73 offen lds
    s_nop 0
    v_fmac_f32_dpp v184, v186, v205 row_ror:8 row_mask:0xf bank_mask:0xf
    v_mul_f32 v185, v199, v184
    s_nop 0
    ds_read_b64_tr_b16 v[132:133], v228 offset:47104
    ds_read_b64_tr_b16 v[134:135], v228 offset:50176
    s_waitcnt lgkmcnt(7)
    v_mfma_f32_32x32x16_bf16 v[96:111], v[24:27], v[40:43], v[96:111]
    v_fmac_f32_dpp v185, v184, v200 row_ror:8 row_mask:0xf bank_mask:0xf
    v_mul_f32 v186, v222, v184
    s_nop 0
    v_fmac_f32_dpp v186, v184, v223 row_ror:8 row_mask:0xf bank_mask:0xf
    ds_read_b128 v[24:27], v224 offset:43008
    ds_read_b64_tr_b16 v[32:33], v226 offset:53248
    ds_read_b64_tr_b16 v[34:35], v226 offset:56320
    s_waitcnt lgkmcnt(7)
    v_mfma_f32_32x32x16_bf16 v[64:79], v[28:31], v[44:47], v[64:79]
    s_add_u32 s14, s44, 30
    s_lshr_b32 s12, s14, 2
    s_lshl_b32 s14, s14, 1
    s_add_u32 s14, s14, s12
    s_lshl_b32 s14, s14, 1
    s_add_u32 s14, s14, s9
    s_add_u32 s72, s44, -2
    s_lshr_b32 s13, s72, 4
    s_and_b32 s72, s72, 15
    s_lshl_b32 s72, s72, 1
    s_add_u32 s72, s72, s9
    s_lshr_b32 s12, s72, 2
    s_lshl_b32 s72, s72, 1
    s_add_u32 s72, s72, s12
    s_lshl_b32 s72, s72, 1
    s_add_u32 s72, s72, s13
    s_add_u32 s72, s72, 2
    s_cmp_lt_u32 s44, 2
    s_cselect_b32 s72, s14, s72
    s_lshl_b32 s72, s72, 11
    s_add_u32 s72, s72, s76
    s_add_u32 m0, s82, 122880
    s_nop 0
    buffer_load_dwordx4 v3, s[48:51], s72 offen sc1 lds
    v_add_f32 v168, v168, v185
    v_mul_f32 v187, v222, v185
    v_mul_f32 v188, v222, v186
    v_add_f32 v169, v169, v186
    ds_read_b64_tr_b16 v[36:37], v227 offset:53248
    ds_read_b64_tr_b16 v[38:39], v227 offset:56320
    s_waitcnt lgkmcnt(7)
    v_mfma_f32_32x32x16_bf16 v[80:95], v[28:31], v[128:131], v[80:95]
    v_fmac_f32_dpp v187, v185, v223 row_ror:8 row_mask:0xf bank_mask:0xf
    v_fmac_f32_dpp v188, v186, v223 row_ror:8 row_mask:0xf bank_mask:0xf
    v_add_f32 v170, v170, v187
    v_mul_f32 v185, v222, v187
    ds_read_b64_tr_b16 v[40:41], v228 offset:53248
    ds_read_b64_tr_b16 v[42:43], v228 offset:56320
    s_waitcnt lgkmcnt(7)
    v_mfma_f32_32x32x16_bf16 v[96:111], v[28:31], v[132:135], v[96:111]
    s_add_u32 m0, s82, 122880
    s_nop 0
    buffer_load_dwordx4 v3, s[48:51], s72 offen offset:1024 sc1 lds
    v_mul_f32 v186, v222, v188
    v_add_f32 v171, v171, v188
    v_fmac_f32_dpp v185, v187, v223 row_ror:8 row_mask:0xf bank_mask:0xf
    v_fmac_f32_dpp v186, v188, v223 row_ror:8 row_mask:0xf bank_mask:0xf
    ds_read_b128 v[28:31], v224 offset:44032
    ds_read_b64_tr_b16 v[44:45], v226 offset:59392
    ds_read_b64_tr_b16 v[46:47], v226 offset:62464
    s_waitcnt lgkmcnt(7)
    v_mfma_f32_32x32x16_bf16 v[64:79], v[24:27], v[32:35], v[64:79]
    v_add_f32 v172, v172, v185
    v_mul_f32 v187, v222, v185
    v_mul_f32 v188, v222, v186
    v_add_f32 v173, v173, v186
    ds_read_b64_tr_b16 v[128:129], v227 offset:59392
    ds_read_b64_tr_b16 v[130:131], v227 offset:62464
    s_waitcnt lgkmcnt(7)
    v_mfma_f32_32x32x16_bf16 v[80:95], v[24:27], v[36:39], v[80:95]
    v_fmac_f32_dpp v187, v185, v223 row_ror:8 row_mask:0xf bank_mask:0xf
    v_fmac_f32_dpp v188, v186, v223 row_ror:8 row_mask:0xf bank_mask:0xf
    v_add_f32 v174, v174, v187
    v_mul_f32 v185, v222, v187
    ds_read_b64_tr_b16 v[132:133], v228 offset:59392
    ds_read_b64_tr_b16 v[134:135], v228 offset:62464
    s_waitcnt lgkmcnt(7)
    v_mfma_f32_32x32x16_bf16 v[96:111], v[24:27], v[40:43], v[96:111]
    v_mul_f32 v186, v222, v188
    v_add_f32 v175, v175, v188
    v_fmac_f32_dpp v185, v187, v223 row_ror:8 row_mask:0xf bank_mask:0xf
    v_fmac_f32_dpp v186, v188, v223 row_ror:8 row_mask:0xf bank_mask:0xf
    s_waitcnt vmcnt(5)
    s_barrier
    s_cmp_lg_u32 s7, 1
    s_cbranch_scc1 NOFLAG_35
    s_add_u32 s14, s34, 3072
    v_mov_b32 v2, s15
    s_mov_b64 exec, 1
    buffer_store_dword v2, off, s[48:51], s14 sc1
    s_mov_b64 exec, -1
NOFLAG_35:
    ds_read_b128 v[24:27], v225 offset:0
    ds_read_b64_tr_b16 v[32:33], v229 offset:0
    ds_read_b64_tr_b16 v[34:35], v229 offset:3072
    s_waitcnt lgkmcnt(7)
    v_mfma_f32_32x32x16_bf16 v[64:79], v[28:31], v[44:47], v[64:79]
    s_add_u32 s73, s44, 3
    s_lshr_b32 s13, s73, 4
    s_and_b32 s73, s73, 15
    s_lshl_b32 s73, s73, 1
    s_add_u32 s73, s73, s10
    s_lshr_b32 s12, s73, 2
    s_lshl_b32 s73, s73, 1
    s_add_u32 s73, s73, s12
    s_lshl_b32 s73, s73, 1
    s_add_u32 s73, s73, s13
    s_add_u32 s73, s73, 2
    s_mul_i32 s73, s73, 36864
    s_add_u32 s73, s73, s80
    s_add_u32 m0, s83, 0
    s_nop 0
    buffer_load_dwordx4 v8, s[56:59], s73 offen lds
    v_add_f32 v176, v176, v185
    v_mul_f32 v187, v222, v185
    v_mul_f32 v188, v222, v186
    v_add_f32 v177, v177, v186
    ds_read_b64_tr_b16 v[36:37], v230 offset:0
    ds_read_b64_tr_b16 v[38:39], v230 offset:3072
    s_waitcnt lgkmcnt(7)
    v_mfma_f32_32x32x16_bf16 v[80:95], v[28:31], v[128:131], v[80:95]
    v_fmac_f32_dpp v187, v185, v223 row_ror:8 row_mask:0xf bank_mask:0xf
    v_fmac_f32_dpp v188, v186, v223 row_ror:8 row_mask:0xf bank_mask:0xf
    v_add_f32 v178, v178, v187
    v_mul_f32 v185, v222, v187
    ds_read_b64_tr_b16 v[40:41], v231 offset:0
    ds_read_b64_tr_b16 v[42:43], v231 offset:3072
    s_waitcnt lgkmcnt(7)
    v_mfma_f32_32x32x16_bf16 v[96:111], v[28:31], v[132:135], v[96:111]
    s_add_u32 m0, s83, 1024
    s_nop 0
    buffer_load_dwordx4 v9, s[56:59], s73 offen lds
    v_mul_f32 v186, v222, v188
    v_add_f32 v179, v179, v188
    v_fmac_f32_dpp v185, v187, v223 row_ror:8 row_mask:0xf bank_mask:0xf
    v_fmac_f32_dpp v186, v188, v223 row_ror:8 row_mask:0xf bank_mask:0xf
    ds_read_b128 v[28:31], v225 offset:1024
    ds_read_b64_tr_b16 v[44:45], v229 offset:6144
    ds_read_b64_tr_b16 v[46:47], v229 offset:9216
    s_waitcnt lgkmcnt(7)
    v_mfma_f32_32x32x16_bf16 v[64:79], v[24:27], v[32:35], v[64:79]
    v_add_f32 v180, v180, v185
    v_mul_f32 v187, v222, v185
    v_mul_f32 v188, v222, v186
    v_add_f32 v181, v181, v186
    ds_read_b64_tr_b16 v[128:129], v230 offset:6144
    ds_read_b64_tr_b16 v[130:131], v230 offset:9216
    s_waitcnt lgkmcnt(7)
    v_mfma_f32_32x32x16_bf16 v[80:95], v[24:27], v[36:39], v[80:95]
    s_add_u32 m0, s83, 2048
    s_nop 0
    buffer_load_dwordx4 v10, s[56:59], s73 offen lds
    v_fmac_f32_dpp v187, v185, v223 row_ror:8 row_mask:0xf bank_mask:0xf
    v_fmac_f32_dpp v188, v186, v223 row_ror:8 row_mask:0xf bank_mask:0xf
    v_add_f32 v182, v182, v187
    v_add_f32 v183, v183, v188
    ds_read_b64_tr_b16 v[132:133], v231 offset:6144
    ds_read_b64_tr_b16 v[134:135], v231 offset:9216
    s_waitcnt lgkmcnt(7)
    v_mfma_f32_32x32x16_bf16 v[96:111], v[24:27], v[40:43], v[96:111]
    v_cvt_pk_bf16_f32 v168, v168, v169
    v_cvt_pk_bf16_f32 v169, v170, v171
    v_cvt_pk_bf16_f32 v170, v172, v173
    v_cvt_pk_bf16_f32 v171, v174, v175
    ds_read_b128 v[24:27], v225 offset:2048
    ds_read_b64_tr_b16 v[32:33], v229 offset:12288
    ds_read_b64_tr_b16 v[34:35], v229 offset:15360
    s_waitcnt lgkmcnt(7)
    v_mfma_f32_32x32x16_bf16 v[64:79], v[28:31], v[44:47], v[64:79]
    s_add_u32 s72, s44, 3
    s_lshr_b32 s13, s72, 4
    s_and_b32 s72, s72, 15
    s_lshl_b32 s72, s72, 1
    s_add_u32 s72, s72, s9
    s_lshr_b32 s12, s72, 2
    s_lshl_b32 s72, s72, 1
    s_add_u32 s72, s72, s12
    s_lshl_b32 s72, s72, 1
    s_add_u32 s72, s72, s13
    s_add_u32 s72, s72, 2
    s_lshl_b32 s72, s72, 11
    s_add_u32 s72, s72, s76
    s_add_u32 m0, s82, 0
    s_nop 0
    buffer_load_dwordx4 v3, s[48:51], s72 offen sc1 lds
    v_cvt_pk_bf16_f32 v172, v176, v177
    v_cvt_pk_bf16_f32 v173, v178, v179
    v_cvt_pk_bf16_f32 v174, v180, v181
    v_cvt_pk_bf16_f32 v175, v182, v183
    ds_read_b64_tr_b16 v[36:37], v230 offset:12288
    ds_read_b64_tr_b16 v[38:39], v230 offset:15360
    s_waitcnt lgkmcnt(7)
    v_mfma_f32_32x32x16_bf16 v[80:95], v[28:31], v[128:131], v[80:95]
    buffer_store_dwordx4 v[168:171], v3, s[48:51], s22 offen sc1
    buffer_store_dwordx4 v[172:175], v3, s[48:51], s22 offen offset:1024 sc1
    v_lshrrev_b32 v252, 5, v1
    v_lshrrev_b32 v253, 4, v1
    ds_read_b64_tr_b16 v[40:41], v231 offset:12288
    ds_read_b64_tr_b16 v[42:43], v231 offset:15360
    s_waitcnt lgkmcnt(7)
    v_mfma_f32_32x32x16_bf16 v[96:111], v[28:31], v[132:135], v[96:111]
    s_add_u32 m0, s82, 0
    s_nop 0
    buffer_load_dwordx4 v3, s[48:51], s72 offen offset:1024 sc1 lds
    v_lshlrev_b32 v254, 2, v252
    v_and_b32 v255, 7, v1
    v_xor_b32 v254, v254, v255
    v_lshlrev_b32 v254, 4, v254
    ds_read_b128 v[28:31], v225 offset:3072
    ds_read_b64_tr_b16 v[44:45], v229 offset:18432
    ds_read_b64_tr_b16 v[46:47], v229 offset:21504
    s_waitcnt lgkmcnt(7)
    v_mfma_f32_32x32x16_bf16 v[64:79], v[24:27], v[32:35], v[64:79]
    v_lshrrev_b32 v255, 3, v1
    v_lshl_add_u32 v4, v255, 8, v254
    v_lshrrev_b32 v254, 3, v1
    v_mul_u32_u24 v254, 1152, v254
    ds_read_b64_tr_b16 v[128:129], v230 offset:18432
    ds_read_b64_tr_b16 v[130:131], v230 offset:21504
    s_waitcnt lgkmcnt(7)
    v_mfma_f32_32x32x16_bf16 v[80:95], v[24:27], v[36:39], v[80:95]
    v_and_b32 v255, 7, v1
    v_xor_b32 v255, v255, v253
    v_lshl_add_u32 v5, v255, 4, v254
    s_and_b32 s75, s7, 1
    ds_read_b64_tr_b16 v[132:133], v231 offset:18432
    ds_read_b64_tr_b16 v[134:135], v231 offset:21504
    s_waitcnt lgkmcnt(7)
    v_mfma_f32_32x32x16_bf16 v[96:111], v[24:27], v[40:43], v[96:111]
    s_lshl_b32 s75, s75, 6
    v_xor_b32 v5, s75, v5
    v_xor_b32 v6, 64, v5
    s_lshl_b32 s29, s7, 11
    s_waitcnt vmcnt(7)
    s_barrier
    ds_read_b128 v[24:27], v225 offset:40960
    ds_read_b64_tr_b16 v[32:33], v229 offset:40960
    ds_read_b64_tr_b16 v[34:35], v229 offset:44032
    s_waitcnt lgkmcnt(7)
    v_mfma_f32_32x32x16_bf16 v[64:79], v[28:31], v[44:47], v[64:79]
    buffer_load_dword v12, v15, s[48:51], s79 offen sc1
    s_mul_i32 s75, s45, 294912
    s_add_u32 s29, s29, s75
    s_add_u32 s29, s29, 37748736
    s_mul_i32 s74, s46, 192
    ds_read_b64_tr_b16 v[36:37], v230 offset:40960
    ds_read_b64_tr_b16 v[38:39], v230 offset:44032
    s_waitcnt lgkmcnt(7)
    v_mfma_f32_32x32x16_bf16 v[80:95], v[28:31], v[128:131], v[80:95]
    s_mul_i32 s75, s7, 24
    s_add_u32 s74, s74, s75
    s_mul_i32 s74, s74, 1152
    s_mov_b32 s66, 663552
    ds_read_b64_tr_b16 v[40:41], v231 offset:40960
    ds_read_b64_tr_b16 v[42:43], v231 offset:44032
    s_waitcnt lgkmcnt(7)
    v_mfma_f32_32x32x16_bf16 v[96:111], v[28:31], v[132:135], v[96:111]
    s_add_u32 s73, s44, 8
    s_lshr_b32 s13, s73, 4
    s_and_b32 s73, s73, 15
    s_lshl_b32 s73, s73, 1
    s_add_u32 s73, s73, s10
    s_lshr_b32 s12, s73, 2
    s_lshl_b32 s73, s73, 1
    s_add_u32 s73, s73, s12
    s_lshl_b32 s73, s73, 1
    s_add_u32 s73, s73, s13
    s_add_u32 s73, s73, 2
    s_mul_i32 s73, s73, 36864
    s_add_u32 s73, s73, s80
    s_add_u32 m0, s83, 40960
    s_nop 0
    buffer_load_dwordx4 v8, s[56:59], s73 offen lds
    s_mov_b32 s67, 0x20000
    s_mov_b32 s64, s68
    s_mov_b32 s65, s69
    v_bfe_u32 v253, v1, 1, 1
    ds_read_b128 v[28:31], v225 offset:41984
    ds_read_b64_tr_b16 v[44:45], v229 offset:47104
    ds_read_b64_tr_b16 v[46:47], v229 offset:50176
    s_waitcnt lgkmcnt(7)
    v_mfma_f32_32x32x16_bf16 v[64:79], v[24:27], v[32:35], v[64:79]
    s_and_b32 s75, s44, 1
    v_xor_b32 v253, s75, v253
    v_bfe_u32 v254, v1, 4, 1
    s_bfe_u32 s75, s44, 0x10001
    ds_read_b64_tr_b16 v[128:129], v230 offset:47104
    ds_read_b64_tr_b16 v[130:131], v230 offset:50176
    s_waitcnt lgkmcnt(7)
    v_mfma_f32_32x32x16_bf16 v[80:95], v[24:27], v[36:39], v[80:95]
    s_add_u32 m0, s83, 41984
    s_nop 0
    buffer_load_dwordx4 v9, s[56:59], s73 offen lds
    v_xor_b32 v254, s75, v254
    v_lshlrev_b32 v255, 11, v252
    v_lshl_add_u32 v255, v254, 7, v255
    v_mul_u32_u24 v253, 576, v253
    ds_read_b64_tr_b16 v[132:133], v231 offset:47104
    ds_read_b64_tr_b16 v[134:135], v231 offset:50176
    s_waitcnt lgkmcnt(7)
    v_mfma_f32_32x32x16_bf16 v[96:111], v[24:27], v[40:43], v[96:111]
    v_add_u32 v255, v255, v253
    v_bfe_u32 v254, v1, 2, 2
    v_lshl_add_u32 v255, v254, 4, v255
    v_and_b32 v254, 1, v1
    ds_read_b128 v[24:27], v225 offset:43008
    ds_read_b64_tr_b16 v[32:33], v229 offset:53248
    ds_read_b64_tr_b16 v[34:35], v229 offset:56320
    s_waitcnt lgkmcnt(7)
    v_mfma_f32_32x32x16_bf16 v[64:79], v[28:31], v[44:47], v[64:79]
    s_add_u32 m0, s83, 43008
    s_nop 0
    buffer_load_dwordx4 v10, s[56:59], s73 offen lds
    v_lshl_add_u32 v255, v254, 3, v255
    s_bfe_u32 s75, s7, 0x10001
    s_lshl_b32 s75, s75, 10
    v_add_u32 v255, s75, v255
    ds_read_b64_tr_b16 v[36:37], v230 offset:53248
    ds_read_b64_tr_b16 v[38:39], v230 offset:56320
    s_waitcnt lgkmcnt(7)
    v_mfma_f32_32x32x16_bf16 v[80:95], v[28:31], v[128:131], v[80:95]
    s_and_b32 s75, s7, 1
    s_lshl_b32 s75, s75, 8
    v_add_u32 v232, s75, v255
    v_add_u32 v233, 81920, v232
    ds_read_b64_tr_b16 v[40:41], v231 offset:53248
    ds_read_b64_tr_b16 v[42:43], v231 offset:56320
    s_waitcnt lgkmcnt(7)
    v_mfma_f32_32x32x16_bf16 v[96:111], v[28:31], v[132:135], v[96:111]
    s_add_u32 s72, s44, 8
    s_lshr_b32 s13, s72, 4
    s_and_b32 s72, s72, 15
    s_lshl_b32 s72, s72, 1
    s_add_u32 s72, s72, s9
    s_lshr_b32 s12, s72, 2
    s_lshl_b32 s72, s72, 1
    s_add_u32 s72, s72, s12
    s_lshl_b32 s72, s72, 1
    s_add_u32 s72, s72, s13
    s_add_u32 s72, s72, 2
    s_lshl_b32 s72, s72, 11
    s_add_u32 s72, s72, s76
    s_add_u32 m0, s82, 40960
    s_nop 0
    buffer_load_dwordx4 v3, s[48:51], s72 offen sc1 lds
    v_xor_b32 v244, 64, v232
    v_xor_b32 v245, 64, v233
    v_and_b32 v253, 31, v1
    v_bfe_u32 v254, v1, 1, 3
    ds_read_b128 v[28:31], v225 offset:44032
    ds_read_b64_tr_b16 v[44:45], v229 offset:59392
    ds_read_b64_tr_b16 v[46:47], v229 offset:62464
    s_waitcnt lgkmcnt(7)
    v_mfma_f32_32x32x16_bf16 v[64:79], v[24:27], v[32:35], v[64:79]
    v_xor_b32 v254, v254, v252
    v_lshlrev_b32 v254, 4, v254
    v_lshl_add_u32 v253, v253, 7, v254
    s_lshl_b32 s75, s77, 12
    ds_read_b64_tr_b16 v[128:129], v230 offset:59392
    ds_read_b64_tr_b16 v[130:131], v230 offset:62464
    s_waitcnt lgkmcnt(7)
    v_mfma_f32_32x32x16_bf16 v[80:95], v[24:27], v[36:39], v[80:95]
    s_add_u32 m0, s82, 40960
    s_nop 0
    buffer_load_dwordx4 v3, s[48:51], s72 offen offset:1024 sc1 lds
    s_add_u32 s75, s75, 16384
    v_add_u32 v253, s75, v253
    v_xor_b32 v234, 0, v253
    v_add_u32 v238, 81920, v234
    ds_read_b64_tr_b16 v[132:133], v231 offset:59392
    ds_read_b64_tr_b16 v[134:135], v231 offset:62464
    s_waitcnt lgkmcnt(7)
    v_mfma_f32_32x32x16_bf16 v[96:111], v[24:27], v[40:43], v[96:111]
    v_xor_b32 v235, 32, v253
    v_add_u32 v239, 81920, v235
    v_xor_b32 v236, 64, v253
    v_add_u32 v240, 81920, v236
    s_waitcnt vmcnt(6)
    s_barrier
    s_waitcnt vmcnt(5)
    v_cmp_ne_u32 vcc, s15, v12
    s_cbranch_vccnz SLOW_36
BACK_37:
    ds_read_b128 v[24:27], v224 offset:0
    ds_read_b64_tr_b16 v[32:33], v226 offset:0
    ds_read_b64_tr_b16 v[34:35], v226 offset:3072
    s_waitcnt lgkmcnt(7)
    v_mfma_f32_32x32x16_bf16 v[64:79], v[28:31], v[44:47], v[64:79]
    s_add_u32 s73, s44, 13
    s_lshr_b32 s13, s73, 4
    s_and_b32 s73, s73, 15
    s_lshl_b32 s73, s73, 1
    s_add_u32 s73, s73, s10
    s_lshr_b32 s12, s73, 2
    s_lshl_b32 s73, s73, 1
    s_add_u32 s73, s73, s12
    s_lshl_b32 s73, s73, 1
    s_add_u32 s73, s73, s13
    s_add_u32 s73, s73, 2
    s_mul_i32 s73, s73, 36864
    s_add_u32 s73, s73, s80
    s_add_u32 m0, s83, 81920
    s_nop 0
    buffer_load_dwordx4 v8, s[56:59], s73 offen lds
    v_xor_b32 v237, 96, v253
    v_add_u32 v241, 81920, v237
    s_lshl_b32 s75, s45, 2
    s_and_b32 s31, s7, 3
    ds_read_b64_tr_b16 v[36:37], v227 offset:0
    ds_read_b64_tr_b16 v[38:39], v227 offset:3072
    s_waitcnt lgkmcnt(7)
    v_mfma_f32_32x32x16_bf16 v[80:95], v[28:31], v[128:131], v[80:95]
    s_add_u32 s75, s75, s31
    s_lshl_b32 s75, s75, 2
    s_and_b32 s31, s44, 3
    s_add_u32 s75, s75, s31
    ds_read_b64_tr_b16 v[40:41], v228 offset:0
    ds_read_b64_tr_b16 v[42:43], v228 offset:3072
    s_waitcnt lgkmcnt(7)
    v_mfma_f32_32x32x16_bf16 v[96:111], v[28:31], v[132:135], v[96:111]
    s_add_u32 m0, s83, 82944
    s_nop 0
    buffer_load_dwordx4 v9, s[56:59], s73 offen lds
    s_lshl_b32 s30, s75, 6
    s_add_u32 s30, s30, 63963136
    s_mul_i32 s31, s75, 18432
    s_mul_i32 s75, s46, 768
    ds_read_b128 v[28:31], v224 offset:1024
    ds_read_b64_tr_b16 v[44:45], v226 offset:6144
    ds_read_b64_tr_b16 v[46:47], v226 offset:9216
    s_waitcnt lgkmcnt(7)
    v_mfma_f32_32x32x16_bf16 v[64:79], v[24:27], v[32:35], v[64:79]
    s_add_u32 s31, s31, s75
    s_lshl_b32 s75, s77, 7
    s_add_u32 s31, s31, s75
    v_mul_u32_u24 v7, 9216, v252
    ds_read_b64_tr_b16 v[128:129], v227 offset:6144
    ds_read_b64_tr_b16 v[130:131], v227 offset:9216
    s_waitcnt lgkmcnt(7)
    v_mfma_f32_32x32x16_bf16 v[80:95], v[24:27], v[36:39], v[80:95]
    s_add_u32 m0, s83, 83968
    s_nop 0
    buffer_load_dwordx4 v10, s[56:59], s73 offen lds
    v_and_b32 v255, 31, v1
    v_lshl_add_u32 v7, v255, 2, v7
    s_lshl_b32 s33, s45, 7
    s_add_u32 s33, s33, 65024000
    ds_read_b64_tr_b16 v[132:133], v228 offset:6144
    ds_read_b64_tr_b16 v[134:135], v228 offset:9216
    s_waitcnt lgkmcnt(7)
    v_mfma_f32_32x32x16_bf16 v[96:111], v[24:27], v[40:43], v[96:111]
    s_add_u32 s28, s33, 64
    v_and_b32 v242, 63, v15
    ds_read_b128 v[24:27], v224 offset:2048
    ds_read_b64_tr_b16 v[32:33], v226 offset:12288
    ds_read_b64_tr_b16 v[34:35], v226 offset:15360
    s_waitcnt lgkmcnt(7)
    v_mfma_f32_32x32x16_bf16 v[64:79], v[28:31], v[44:47], v[64:79]
    s_add_u32 s72, s44, 13
    s_lshr_b32 s13, s72, 4
    s_and_b32 s72, s72, 15
    s_lshl_b32 s72, s72, 1
    s_add_u32 s72, s72, s9
    s_lshr_b32 s12, s72, 2
    s_lshl_b32 s72, s72, 1
    s_add_u32 s72, s72, s12
    s_lshl_b32 s72, s72, 1
    s_add_u32 s72, s72, s13
    s_add_u32 s72, s72, 2
    s_lshl_b32 s72, s72, 11
    s_add_u32 s72, s72, s76
    s_add_u32 m0, s82, 81920
    s_nop 0
    buffer_load_dwordx4 v3, s[48:51], s72 offen sc1 lds
    ds_read_b64_tr_b16 v[36:37], v227 offset:12288
    ds_read_b64_tr_b16 v[38:39], v227 offset:15360
    s_waitcnt lgkmcnt(7)
    v_mfma_f32_32x32x16_bf16 v[80:95], v[28:31], v[128:131], v[80:95]
    ds_read_b64_tr_b16 v[40:41], v228 offset:12288
    ds_read_b64_tr_b16 v[42:43], v228 offset:15360
    s_waitcnt lgkmcnt(7)
    v_mfma_f32_32x32x16_bf16 v[96:111], v[28:31], v[132:135], v[96:111]
    s_add_u32 m0, s82, 81920
    s_nop 0
    buffer_load_dwordx4 v3, s[48:51], s72 offen offset:1024 sc1 lds
    ds_read_b128 v[28:31], v224 offset:3072
    ds_read_b64_tr_b16 v[44:45], v226 offset:18432
    ds_read_b64_tr_b16 v[46:47], v226 offset:21504
    s_waitcnt lgkmcnt(7)
    v_mfma_f32_32x32x16_bf16 v[64:79], v[24:27], v[32:35], v[64:79]
    ds_read_b64_tr_b16 v[128:129], v227 offset:18432
    ds_read_b64_tr_b16 v[130:131], v227 offset:21504
    s_waitcnt lgkmcnt(7)
    v_mfma_f32_32x32x16_bf16 v[80:95], v[24:27], v[36:39], v[80:95]
    ds_read_b64_tr_b16 v[132:133], v228 offset:18432
    ds_read_b64_tr_b16 v[134:135], v228 offset:21504
    s_waitcnt lgkmcnt(7)
    v_mfma_f32_32x32x16_bf16 v[96:111], v[24:27], v[40:43], v[96:111]
    s_waitcnt vmcnt(5)
    s_barrier
    s_cmp_lg_u32 s7, 2
    s_cbranch_scc1 NOFLAG_38
    s_lshr_b32 s14, s11, 4
    s_lshl_b32 s14, s14, 7
    s_and_b32 s12, s11, 15
    s_lshl_b32 s12, s12, 2
    s_add_u32 s14, s14, s12
    s_add_u32 s14, s14, 65024000
    v_mov_b32 v2, s15
    s_mov_b64 exec, 1
    buffer_store_dword v2, off, s[48:51], s14 sc1
    s_mov_b64 exec, -1
NOFLAG_38:
    ds_read_b128 v[24:27], v224 offset:40960
    ds_read_b64_tr_b16 v[32:33], v226 offset:40960
    ds_read_b64_tr_b16 v[34:35], v226 offset:44032
    s_waitcnt lgkmcnt(7)
    v_mfma_f32_32x32x16_bf16 v[64:79], v[28:31], v[44:47], v[64:79]
    s_add_u32 s73, s44, 18
    s_lshr_b32 s13, s73, 4
    s_and_b32 s73, s73, 15
    s_lshl_b32 s73, s73, 1
    s_add_u32 s73, s73, s10
    s_lshr_b32 s12, s73, 2
    s_lshl_b32 s73, s73, 1
    s_add_u32 s73, s73, s12
    s_lshl_b32 s73, s73, 1
    s_add_u32 s73, s73, s13
    s_add_u32 s73, s73, 2
    s_mul_i32 s73, s73, 36864
    s_add_u32 s73, s73, s80
    s_add_u32 m0, s83, 122880
    s_nop 0
    buffer_load_dwordx4 v8, s[56:59], s73 offen lds
    ds_read_b64_tr_b16 v[36:37], v227 offset:40960
    ds_read_b64_tr_b16 v[38:39], v227 offset:44032
    s_waitcnt lgkmcnt(7)
    v_mfma_f32_32x32x16_bf16 v[80:95], v[28:31], v[128:131], v[80:95]
    ds_read_b64_tr_b16 v[40:41], v228 offset:40960
    ds_read_b64_tr_b16 v[42:43], v228 offset:44032
    s_waitcnt lgkmcnt(7)
    v_mfma_f32_32x32x16_bf16 v[96:111], v[28:31], v[132:135], v[96:111]
    s_add_u32 m0, s83, 123904
    s_nop 0
    buffer_load_dwordx4 v9, s[56:59], s73 offen lds
    ds_read_b128 v[28:31], v224 offset:41984
    ds_read_b64_tr_b16 v[44:45], v226 offset:47104
    ds_read_b64_tr_b16 v[46:47], v226 offset:50176
    s_waitcnt lgkmcnt(7)
    v_mfma_f32_32x32x16_bf16 v[64:79], v[24:27], v[32:35], v[64:79]
    ds_read_b64_tr_b16 v[128:129], v227 offset:47104
    ds_read_b64_tr_b16 v[130:131], v227 offset:50176
    s_waitcnt lgkmcnt(7)
    v_mfma_f32_32x32x16_bf16 v[80:95], v[24:27], v[36:39], v[80:95]
    s_add_u32 m0, s83, 124928
    s_nop 0
    buffer_load_dwordx4 v10, s[56:59], s73 offen lds
    ds_read_b64_tr_b16 v[132:133], v228 offset:47104
    ds_read_b64_tr_b16 v[134:135], v228 offset:50176
    s_waitcnt lgkmcnt(7)
    v_mfma_f32_32x32x16_bf16 v[96:111], v[24:27], v[40:43], v[96:111]
    ds_read_b128 v[24:27], v224 offset:43008
    ds_read_b64_tr_b16 v[32:33], v226 offset:53248
    ds_read_b64_tr_b16 v[34:35], v226 offset:56320
    s_waitcnt lgkmcnt(7)
    v_mfma_f32_32x32x16_bf16 v[64:79], v[28:31], v[44:47], v[64:79]
    s_add_u32 s72, s44, 18
    s_lshr_b32 s13, s72, 4
    s_and_b32 s72, s72, 15
    s_lshl_b32 s72, s72, 1
    s_add_u32 s72, s72, s9
    s_lshr_b32 s12, s72, 2
    s_lshl_b32 s72, s72, 1
    s_add_u32 s72, s72, s12
    s_lshl_b32 s72, s72, 1
    s_add_u32 s72, s72, s13
    s_add_u32 s72, s72, 2
    s_lshl_b32 s72, s72, 11
    s_add_u32 s72, s72, s76
    s_add_u32 m0, s82, 122880
    s_nop 0
    buffer_load_dwordx4 v3, s[48:51], s72 offen sc1 lds
    ds_read_b64_tr_b16 v[36:37], v227 offset:53248
    ds_read_b64_tr_b16 v[38:39], v227 offset:56320
    s_waitcnt lgkmcnt(7)
    v_mfma_f32_32x32x16_bf16 v[80:95], v[28:31], v[128:131], v[80:95]
    ds_read_b64_tr_b16 v[40:41], v228 offset:53248
    ds_read_b64_tr_b16 v[42:43], v228 offset:56320
    s_waitcnt lgkmcnt(7)
    v_mfma_f32_32x32x16_bf16 v[96:111], v[28:31], v[132:135], v[96:111]
    s_add_u32 m0, s82, 122880
    s_nop 0
    buffer_load_dwordx4 v3, s[48:51], s72 offen offset:1024 sc1 lds
    ds_read_b128 v[28:31], v224 offset:44032
    ds_read_b64_tr_b16 v[44:45], v226 offset:59392
    ds_read_b64_tr_b16 v[46:47], v226 offset:62464
    s_waitcnt lgkmcnt(7)
    v_mfma_f32_32x32x16_bf16 v[64:79], v[24:27], v[32:35], v[64:79]
    ds_read_b64_tr_b16 v[128:129], v227 offset:59392
    ds_read_b64_tr_b16 v[130:131], v227 offset:62464
    s_waitcnt lgkmcnt(7)
    v_mfma_f32_32x32x16_bf16 v[80:95], v[24:27], v[36:39], v[80:95]
    ds_read_b64_tr_b16 v[132:133], v228 offset:59392
    ds_read_b64_tr_b16 v[134:135], v228 offset:62464
    s_waitcnt lgkmcnt(7)
    v_mfma_f32_32x32x16_bf16 v[96:111], v[24:27], v[40:43], v[96:111]
    s_waitcnt vmcnt(5)
    s_barrier
    ds_read_b128 v[24:27], v225 offset:0
    ds_read_b64_tr_b16 v[32:33], v229 offset:0
    ds_read_b64_tr_b16 v[34:35], v229 offset:3072
    s_waitcnt lgkmcnt(7)
    v_mfma_f32_32x32x16_bf16 v[64:79], v[28:31], v[44:47], v[64:79]
    buffer_load_dword v12, v15, s[48:51], s8 offen sc1
    ds_read_b64_tr_b16 v[36:37], v230 offset:0
    ds_read_b64_tr_b16 v[38:39], v230 offset:3072
    s_waitcnt lgkmcnt(7)
    v_mfma_f32_32x32x16_bf16 v[80:95], v[28:31], v[128:131], v[80:95]
    ds_read_b64_tr_b16 v[40:41], v231 offset:0
    ds_read_b64_tr_b16 v[42:43], v231 offset:3072
    s_waitcnt lgkmcnt(7)
    v_mfma_f32_32x32x16_bf16 v[96:111], v[28:31], v[132:135], v[96:111]
    s_add_u32 s73, s44, 23
    s_lshr_b32 s13, s73, 4
    s_and_b32 s73, s73, 15
    s_lshl_b32 s73, s73, 1
    s_add_u32 s73, s73, s10
    s_lshr_b32 s12, s73, 2
    s_lshl_b32 s73, s73, 1
    s_add_u32 s73, s73, s12
    s_lshl_b32 s73, s73, 1
    s_add_u32 s73, s73, s13
    s_add_u32 s73, s73, 2
    s_mul_i32 s73, s73, 36864
    s_add_u32 s73, s73, s80
    s_add_u32 m0, s83, 0
    s_nop 0
    buffer_load_dwordx4 v8, s[56:59], s73 offen lds
    ds_read_b128 v[28:31], v225 offset:1024
    ds_read_b64_tr_b16 v[44:45], v229 offset:6144
    ds_read_b64_tr_b16 v[46:47], v229 offset:9216
    s_waitcnt lgkmcnt(7)
    v_mfma_f32_32x32x16_bf16 v[64:79], v[24:27], v[32:35], v[64:79]
    ds_read_b64_tr_b16 v[128:129], v230 offset:6144
    ds_read_b64_tr_b16 v[130:131], v230 offset:9216
    s_waitcnt lgkmcnt(7)
    v_mfma_f32_32x32x16_bf16 v[80:95], v[24:27], v[36:39], v[80:95]
    s_add_u32 m0, s83, 1024
    s_nop 0
    buffer_load_dwordx4 v9, s[56:59], s73 offen lds
    ds_read_b64_tr_b16 v[132:133], v231 offset:6144
    ds_read_b64_tr_b16 v[134:135], v231 offset:9216
    s_waitcnt lgkmcnt(7)
    v_mfma_f32_32x32x16_bf16 v[96:111], v[24:27], v[40:43], v[96:111]
    ds_read_b128 v[24:27], v225 offset:2048
    ds_read_b64_tr_b16 v[32:33], v229 offset:12288
    ds_read_b64_tr_b16 v[34:35], v229 offset:15360
    s_waitcnt lgkmcnt(7)
    v_mfma_f32_32x32x16_bf16 v[64:79], v[28:31], v[44:47], v[64:79]
    s_add_u32 m0, s83, 2048
    s_nop 0
    buffer_load_dwordx4 v10, s[56:59], s73 offen lds
    ds_read_b64_tr_b16 v[36:37], v230 offset:12288
    ds_read_b64_tr_b16 v[38:39], v230 offset:15360
    s_waitcnt lgkmcnt(7)
    v_mfma_f32_32x32x16_bf16 v[80:95], v[28:31], v[128:131], v[80:95]
    ds_read_b64_tr_b16 v[40:41], v231 offset:12288
    ds_read_b64_tr_b16 v[42:43], v231 offset:15360
    s_waitcnt lgkmcnt(7)
    v_mfma_f32_32x32x16_bf16 v[96:111], v[28:31], v[132:135], v[96:111]
    s_add_u32 s72, s44, 23
    s_lshr_b32 s13, s72, 4
    s_and_b32 s72, s72, 15
    s_lshl_b32 s72, s72, 1
    s_add_u32 s72, s72, s9
    s_lshr_b32 s12, s72, 2
    s_lshl_b32 s72, s72, 1
    s_add_u32 s72, s72, s12
    s_lshl_b32 s72, s72, 1
    s_add_u32 s72, s72, s13
    s_add_u32 s72, s72, 2
    s_lshl_b32 s72, s72, 11
    s_add_u32 s72, s72, s76
    s_add_u32 m0, s82, 0
    s_nop 0
    buffer_load_dwordx4 v3, s[48:51], s72 offen sc1 lds
    ds_read_b128 v[28:31], v225 offset:3072
    ds_read_b64_tr_b16 v[44:45], v229 offset:18432
    ds_read_b64_tr_b16 v[46:47], v229 offset:21504
    s_waitcnt lgkmcnt(7)
    v_mfma_f32_32x32x16_bf16 v[64:79], v[24:27], v[32:35], v[64:79]
    ds_read_b64_tr_b16 v[128:129], v230 offset:18432
    ds_read_b64_tr_b16 v[130:131], v230 offset:21504
    s_waitcnt lgkmcnt(7)
    v_mfma_f32_32x32x16_bf16 v[80:95], v[24:27], v[36:39], v[80:95]
    s_add_u32 m0, s82, 0
    s_nop 0
    buffer_load_dwordx4 v3, s[48:51], s72 offen offset:1024 sc1 lds
    ds_read_b64_tr_b16 v[132:133], v231 offset:18432
    ds_read_b64_tr_b16 v[134:135], v231 offset:21504
    s_waitcnt lgkmcnt(7)
    v_mfma_f32_32x32x16_bf16 v[96:111], v[24:27], v[40:43], v[96:111]
    s_waitcnt vmcnt(6)
    s_barrier
    s_waitcnt vmcnt(5)
    v_cmp_ne_u32 vcc, s15, v12
    s_cbranch_vccnz SLOW_39
BACK_40:
    ds_read_b128 v[24:27], v225 offset:40960
    ds_read_b64_tr_b16 v[32:33], v229 offset:40960
    ds_read_b64_tr_b16 v[34:35], v229 offset:44032
    s_waitcnt lgkmcnt(7)
    v_mfma_f32_32x32x16_bf16 v[64:79], v[28:31], v[44:47], v[64:79]
    s_add_u32 s14, s44, 28
    s_lshr_b32 s13, s14, 4
    s_and_b32 s14, s14, 15
    s_lshl_b32 s14, s14, 1
    s_add_u32 s14, s14, s10
    s_lshr_b32 s12, s14, 2
    s_lshl_b32 s14, s14, 1
    s_add_u32 s14, s14, s12
    s_lshl_b32 s14, s14, 1
    s_add_u32 s14, s14, s13
    s_add_u32 s14, s14, 2
    s_add_u32 s73, s44, -4
    s_mul_i32 s73, s73, 18
    s_add_u32 s73, s73, 16
    s_add_u32 s73, s73, s10
    s_cmp_lt_u32 s44, 4
    s_cselect_b32 s73, s14, s73
    s_mul_i32 s73, s73, 36864
    s_add_u32 s73, s73, s80
    s_add_u32 m0, s83, 40960
    s_nop 0
    buffer_load_dwordx4 v8, s[56:59], s73 offen lds
    ds_read_b64_tr_b16 v[36:37], v230 offset:40960
    ds_read_b64_tr_b16 v[38:39], v230 offset:44032
    s_waitcnt lgkmcnt(7)
    v_mfma_f32_32x32x16_bf16 v[80:95], v[28:31], v[128:131], v[80:95]
    ds_read_b64_tr_b16 v[40:41], v231 offset:40960
    ds_read_b64_tr_b16 v[42:43], v231 offset:44032
    s_waitcnt lgkmcnt(7)
    v_mfma_f32_32x32x16_bf16 v[96:111], v[28:31], v[132:135], v[96:111]
    s_add_u32 m0, s83, 41984
    s_nop 0
    buffer_load_dwordx4 v9, s[56:59], s73 offen lds
    ds_read_b128 v[28:31], v225 offset:41984
    ds_read_b64_tr_b16 v[44:45], v229 offset:47104
    ds_read_b64_tr_b16 v[46:47], v229 offset:50176
    s_waitcnt lgkmcnt(7)
    v_mfma_f32_32x32x16_bf16 v[64:79], v[24:27], v[32:35], v[64:79]
    ds_read_b64_tr_b16 v[128:129], v230 offset:47104
    ds_read_b64_tr_b16 v[130:131], v230 offset:50176
    s_waitcnt lgkmcnt(7)
    v_mfma_f32_32x32x16_bf16 v[80:95], v[24:27], v[36:39], v[80:95]
    s_add_u32 m0, s83, 43008
    s_nop 0
    buffer_load_dwordx4 v10, s[56:59], s73 offen lds
    ds_read_b64_tr_b16 v[132:133], v231 offset:47104
    ds_read_b64_tr_b16 v[134:135], v231 offset:50176
    s_waitcnt lgkmcnt(7)
    v_mfma_f32_32x32x16_bf16 v[96:111], v[24:27], v[40:43], v[96:111]
    ds_read_b128 v[24:27], v225 offset:43008
    ds_read_b64_tr_b16 v[32:33], v229 offset:53248
    ds_read_b64_tr_b16 v[34:35], v229 offset:56320
    s_waitcnt lgkmcnt(7)
    v_mfma_f32_32x32x16_bf16 v[64:79], v[28:31], v[44:47], v[64:79]
    s_add_u32 s14, s44, 28
    s_lshr_b32 s13, s14, 4
    s_and_b32 s14, s14, 15
    s_lshl_b32 s14, s14, 1
    s_add_u32 s14, s14, s9
    s_lshr_b32 s12, s14, 2
    s_lshl_b32 s14, s14, 1
    s_add_u32 s14, s14, s12
    s_lshl_b32 s14, s14, 1
    s_add_u32 s14, s14, s13
    s_add_u32 s14, s14, 2
    s_add_u32 s72, s44, -4
    s_mul_i32 s72, s72, 18
    s_add_u32 s72, s72, 16
    s_add_u32 s72, s72, s9
    s_cmp_lt_u32 s44, 4
    s_cselect_b32 s72, s14, s72
    s_lshl_b32 s72, s72, 11
    s_add_u32 s72, s72, s76
    s_add_u32 m0, s82, 40960
    s_nop 0
    buffer_load_dwordx4 v3, s[48:51], s72 offen sc1 lds
    ds_read_b64_tr_b16 v[36:37], v230 offset:53248
    ds_read_b64_tr_b16 v[38:39], v230 offset:56320
    s_waitcnt lgkmcnt(7)
    v_mfma_f32_32x32x16_bf16 v[80:95], v[28:31], v[128:131], v[80:95]
    ds_read_b64_tr_b16 v[40:41], v231 offset:53248
    ds_read_b64_tr_b16 v[42:43], v231 offset:56320
    s_waitcnt lgkmcnt(7)
    v_mfma_f32_32x32x16_bf16 v[96:111], v[28:31], v[132:135], v[96:111]
    s_add_u32 m0, s82, 40960
    s_nop 0
    buffer_load_dwordx4 v3, s[48:51], s72 offen offset:1024 sc1 lds
    ds_read_b128 v[28:31], v225 offset:44032
    ds_read_b64_tr_b16 v[44:45], v229 offset:59392
    ds_read_b64_tr_b16 v[46:47], v229 offset:62464
    s_waitcnt lgkmcnt(7)
    v_mfma_f32_32x32x16_bf16 v[64:79], v[24:27], v[32:35], v[64:79]
    ds_read_b64_tr_b16 v[128:129], v230 offset:59392
    ds_read_b64_tr_b16 v[130:131], v230 offset:62464
    s_waitcnt lgkmcnt(7)
    v_mfma_f32_32x32x16_bf16 v[80:95], v[24:27], v[36:39], v[80:95]
    ds_read_b64_tr_b16 v[132:133], v231 offset:59392
    ds_read_b64_tr_b16 v[134:135], v231 offset:62464
    s_waitcnt lgkmcnt(7)
    v_mfma_f32_32x32x16_bf16 v[96:111], v[24:27], v[40:43], v[96:111]
    s_waitcnt vmcnt(5)
    s_barrier
    ds_read_b128 v[24:27], v224 offset:0
    ds_read_b64_tr_b16 v[32:33], v226 offset:0
    ds_read_b64_tr_b16 v[34:35], v226 offset:3072
    s_waitcnt lgkmcnt(7)
    v_mfma_f32_32x32x16_bf16 v[64:79], v[28:31], v[44:47], v[64:79]
    buffer_load_dword v13, v242, s[48:51], s33 offen sc1
    ds_read_b64_tr_b16 v[36:37], v227 offset:0
    ds_read_b64_tr_b16 v[38:39], v227 offset:3072
    s_waitcnt lgkmcnt(7)
    v_mfma_f32_32x32x16_bf16 v[80:95], v[28:31], v[128:131], v[80:95]
    ds_read_b64_tr_b16 v[40:41], v228 offset:0
    ds_read_b64_tr_b16 v[42:43], v228 offset:3072
    s_waitcnt lgkmcnt(7)
    v_mfma_f32_32x32x16_bf16 v[96:111], v[28:31], v[132:135], v[96:111]
    s_add_u32 s73, s44, 1
    s_mul_i32 s73, s73, 18
    s_add_u32 s73, s73, 16
    s_add_u32 s73, s73, s10
    s_mul_i32 s73, s73, 36864
    s_add_u32 s73, s73, s80
    s_add_u32 m0, s83, 81920
    s_nop 0
    buffer_load_dwordx4 v8, s[56:59], s73 offen lds
    ds_read_b128 v[28:31], v224 offset:1024
    ds_read_b64_tr_b16 v[44:45], v226 offset:6144
    ds_read_b64_tr_b16 v[46:47], v226 offset:9216
    s_waitcnt lgkmcnt(7)
    v_mfma_f32_32x32x16_bf16 v[64:79], v[24:27], v[32:35], v[64:79]
    ds_read_b64_tr_b16 v[128:129], v227 offset:6144
    ds_read_b64_tr_b16 v[130:131], v227 offset:9216
    s_waitcnt lgkmcnt(7)
    v_mfma_f32_32x32x16_bf16 v[80:95], v[24:27], v[36:39], v[80:95]
    s_add_u32 m0, s83, 82944
    s_nop 0
    buffer_load_dwordx4 v9, s[56:59], s73 offen lds
    ds_read_b64_tr_b16 v[132:133], v228 offset:6144
    ds_read_b64_tr_b16 v[134:135], v228 offset:9216
    s_waitcnt lgkmcnt(7)
    v_mfma_f32_32x32x16_bf16 v[96:111], v[24:27], v[40:43], v[96:111]
    ds_read_b128 v[24:27], v224 offset:2048
    ds_read_b64_tr_b16 v[32:33], v226 offset:12288
    ds_read_b64_tr_b16 v[34:35], v226 offset:15360
    s_waitcnt lgkmcnt(7)
    v_mfma_f32_32x32x16_bf16 v[64:79], v[28:31], v[44:47], v[64:79]
    s_add_u32 m0, s83, 83968
    s_nop 0
    buffer_load_dwordx4 v10, s[56:59], s73 offen lds
    ds_read_b64_tr_b16 v[36:37], v227 offset:12288
    ds_read_b64_tr_b16 v[38:39], v227 offset:15360
    s_waitcnt lgkmcnt(7)
    v_mfma_f32_32x32x16_bf16 v[80:95], v[28:31], v[128:131], v[80:95]
    ds_read_b64_tr_b16 v[40:41], v228 offset:12288
    ds_read_b64_tr_b16 v[42:43], v228 offset:15360
    s_waitcnt lgkmcnt(7)
    v_mfma_f32_32x32x16_bf16 v[96:111], v[28:31], v[132:135], v[96:111]
    s_add_u32 s72, s44, 1
    s_mul_i32 s72, s72, 18
    s_add_u32 s72, s72, 16
    s_add_u32 s72, s72, s9
    s_lshl_b32 s72, s72, 11
    s_add_u32 s72, s72, s76
    s_add_u32 m0, s82, 81920
    s_nop 0
    buffer_load_dwordx4 v3, s[48:51], s72 offen sc1 lds
    ds_read_b128 v[28:31], v224 offset:3072
    ds_read_b64_tr_b16 v[44:45], v226 offset:18432
    ds_read_b64_tr_b16 v[46:47], v226 offset:21504
    s_waitcnt lgkmcnt(7)
    v_mfma_f32_32x32x16_bf16 v[64:79], v[24:27], v[32:35], v[64:79]
    ds_read_b64_tr_b16 v[128:129], v227 offset:18432
    ds_read_b64_tr_b16 v[130:131], v227 offset:21504
    s_waitcnt lgkmcnt(7)
    v_mfma_f32_32x32x16_bf16 v[80:95], v[24:27], v[36:39], v[80:95]
    s_add_u32 m0, s82, 81920
    s_nop 0
    buffer_load_dwordx4 v3, s[48:51], s72 offen offset:1024 sc1 lds
    ds_read_b64_tr_b16 v[132:133], v228 offset:18432
    ds_read_b64_tr_b16 v[134:135], v228 offset:21504
    s_waitcnt lgkmcnt(7)
    v_mfma_f32_32x32x16_bf16 v[96:111], v[24:27], v[40:43], v[96:111]
    s_cmp_ge_u32 s44, 2
    s_cbranch_scc1 K2_V1
    s_waitcnt vmcnt(6)
    s_barrier
    s_waitcnt vmcnt(5)
    v_cmp_ne_u32 vcc, s15, v13
    s_cbranch_vccnz SLOW_41
BACK_42:
    ds_read_b128 v[24:27], v224 offset:40960
    ds_read_b64_tr_b16 v[32:33], v226 offset:40960
    ds_read_b64_tr_b16 v[34:35], v226 offset:44032
    s_waitcnt lgkmcnt(7)
    v_mfma_f32_32x32x16_bf16 v[64:79], v[28:31], v[44:47], v[64:79]
    s_add_u32 s73, s44, 6
    s_mul_i32 s73, s73, 18
    s_add_u32 s73, s73, 16
    s_add_u32 s73, s73, s10
    s_mul_i32 s73, s73, 36864
    s_add_u32 s73, s73, s80
    s_add_u32 m0, s83, 122880
    s_nop 0
    buffer_load_dwordx4 v8, s[56:59], s73 offen lds
    ds_read_b64_tr_b16 v[36:37], v227 offset:40960
    ds_read_b64_tr_b16 v[38:39], v227 offset:44032
    s_waitcnt lgkmcnt(7)
    v_mfma_f32_32x32x16_bf16 v[80:95], v[28:31], v[128:131], v[80:95]
    ds_read_b64_tr_b16 v[40:41], v228 offset:40960
    ds_read_b64_tr_b16 v[42:43], v228 offset:44032
    s_waitcnt lgkmcnt(7)
    v_mfma_f32_32x32x16_bf16 v[96:111], v[28:31], v[132:135], v[96:111]
    s_add_u32 m0, s83, 123904
    s_nop 0
    buffer_load_dwordx4 v9, s[56:59], s73 offen lds
    ds_read_b128 v[28:31], v224 offset:41984
    ds_read_b64_tr_b16 v[44:45], v226 offset:47104
    ds_read_b64_tr_b16 v[46:47], v226 offset:50176
    s_waitcnt lgkmcnt(7)
    v_mfma_f32_32x32x16_bf16 v[64:79], v[24:27], v[32:35], v[64:79]
    ds_read_b64_tr_b16 v[128:129], v227 offset:47104
    ds_read_b64_tr_b16 v[130:131], v227 offset:50176
    s_waitcnt lgkmcnt(7)
    v_mfma_f32_32x32x16_bf16 v[80:95], v[24:27], v[36:39], v[80:95]
    s_add_u32 m0, s83, 124928
    s_nop 0
    buffer_load_dwordx4 v10, s[56:59], s73 offen lds
    ds_read_b64_tr_b16 v[132:133], v228 offset:47104
    ds_read_b64_tr_b16 v[134:135], v228 offset:50176
    s_waitcnt lgkmcnt(7)
    v_mfma_f32_32x32x16_bf16 v[96:111], v[24:27], v[40:43], v[96:111]
    ds_read_b128 v[24:27], v224 offset:43008
    ds_read_b64_tr_b16 v[32:33], v226 offset:53248
    ds_read_b64_tr_b16 v[34:35], v226 offset:56320
    s_waitcnt lgkmcnt(7)
    v_mfma_f32_32x32x16_bf16 v[64:79], v[28:31], v[44:47], v[64:79]
    s_add_u32 s72, s44, 6
    s_mul_i32 s72, s72, 18
    s_add_u32 s72, s72, 16
    s_add_u32 s72, s72, s9
    s_lshl_b32 s72, s72, 11
    s_add_u32 s72, s72, s76
    s_add_u32 m0, s82, 122880
    s_nop 0
    buffer_load_dwordx4 v3, s[48:51], s72 offen sc1 lds
    ds_read_b64_tr_b16 v[36:37], v227 offset:53248
    ds_read_b64_tr_b16 v[38:39], v227 offset:56320
    s_waitcnt lgkmcnt(7)
    v_mfma_f32_32x32x16_bf16 v[80:95], v[28:31], v[128:131], v[80:95]
    ds_read_b64_tr_b16 v[40:41], v228 offset:53248
    ds_read_b64_tr_b16 v[42:43], v228 offset:56320
    s_waitcnt lgkmcnt(7)
    v_mfma_f32_32x32x16_bf16 v[96:111], v[28:31], v[132:135], v[96:111]
    s_add_u32 m0, s82, 122880
    s_nop 0
    buffer_load_dwordx4 v3, s[48:51], s72 offen offset:1024 sc1 lds
    ds_read_b128 v[28:31], v224 offset:44032
    ds_read_b64_tr_b16 v[44:45], v226 offset:59392
    ds_read_b64_tr_b16 v[46:47], v226 offset:62464
    s_waitcnt lgkmcnt(7)
    v_mfma_f32_32x32x16_bf16 v[64:79], v[24:27], v[32:35], v[64:79]
    ds_read_b64_tr_b16 v[128:129], v227 offset:59392
    ds_read_b64_tr_b16 v[130:131], v227 offset:62464
    s_waitcnt lgkmcnt(7)
    v_mfma_f32_32x32x16_bf16 v[80:95], v[24:27], v[36:39], v[80:95]
    ds_read_b64_tr_b16 v[132:133], v228 offset:59392
    ds_read_b64_tr_b16 v[134:135], v228 offset:62464
    s_waitcnt lgkmcnt(7)
    v_mfma_f32_32x32x16_bf16 v[96:111], v[24:27], v[40:43], v[96:111]
    s_waitcnt vmcnt(5)
    s_barrier
    ds_read_b128 v[24:27], v225 offset:0
    ds_read_b64_tr_b16 v[32:33], v229 offset:0
    ds_read_b64_tr_b16 v[34:35], v229 offset:3072
    s_waitcnt lgkmcnt(7)
    v_mfma_f32_32x32x16_bf16 v[64:79], v[28:31], v[44:47], v[64:79]
    s_add_i32 s73, s44, 3
    s_cmp_lt_u32 s73, 9
    s_cselect_b32 s64, s68, s70
    s_cselect_b32 s65, s69, s71
    s_cselect_b32 s72, 0, 128
    s_cselect_b32 s12, 0, 9
    s_sub_u32 s73, s73, s12
    s_add_u32 s72, s72, s29
    s_lshl_b32 s12, s73, 14
    s_add_u32 s72, s72, s12
    s_lshl_b32 s73, s73, 7
    s_add_u32 s73, s73, s74
    s_add_u32 s12, s73, 0
    s_add_u32 m0, s83, 0
    s_nop 0
    buffer_load_dwordx4 v5, s[64:67], s12 offen lds
    ds_read_b64_tr_b16 v[36:37], v230 offset:0
    ds_read_b64_tr_b16 v[38:39], v230 offset:3072
    s_waitcnt lgkmcnt(7)
    v_mfma_f32_32x32x16_bf16 v[80:95], v[28:31], v[128:131], v[80:95]
    ds_read_b64_tr_b16 v[40:41], v231 offset:0
    ds_read_b64_tr_b16 v[42:43], v231 offset:3072
    s_waitcnt lgkmcnt(7)
    v_mfma_f32_32x32x16_bf16 v[96:111], v[28:31], v[132:135], v[96:111]
    s_add_u32 s12, s73, 9216
    s_add_u32 m0, s83, 1024
    s_nop 0
    buffer_load_dwordx4 v6, s[64:67], s12 offen lds
    ds_read_b128 v[28:31], v225 offset:1024
    ds_read_b64_tr_b16 v[44:45], v229 offset:6144
    ds_read_b64_tr_b16 v[46:47], v229 offset:9216
    s_waitcnt lgkmcnt(7)
    v_mfma_f32_32x32x16_bf16 v[64:79], v[24:27], v[32:35], v[64:79]
    ds_read_b64_tr_b16 v[128:129], v230 offset:6144
    ds_read_b64_tr_b16 v[130:131], v230 offset:9216
    s_waitcnt lgkmcnt(7)
    v_mfma_f32_32x32x16_bf16 v[80:95], v[24:27], v[36:39], v[80:95]
    s_add_u32 s12, s73, 18432
    s_add_u32 m0, s83, 2048
    s_nop 0
    buffer_load_dwordx4 v5, s[64:67], s12 offen lds
    ds_read_b64_tr_b16 v[132:133], v231 offset:6144
    ds_read_b64_tr_b16 v[134:135], v231 offset:9216
    s_waitcnt lgkmcnt(7)
    v_mfma_f32_32x32x16_bf16 v[96:111], v[24:27], v[40:43], v[96:111]
    ds_read_b128 v[24:27], v225 offset:2048
    ds_read_b64_tr_b16 v[32:33], v229 offset:12288
    ds_read_b64_tr_b16 v[34:35], v229 offset:15360
    s_waitcnt lgkmcnt(7)
    v_mfma_f32_32x32x16_bf16 v[64:79], v[28:31], v[44:47], v[64:79]
    s_add_u32 m0, s82, 0
    s_nop 0
    buffer_load_dwordx4 v4, s[48:51], s72 offen sc1 lds
    ds_read_b64_tr_b16 v[36:37], v230 offset:12288
    ds_read_b64_tr_b16 v[38:39], v230 offset:15360
    s_waitcnt lgkmcnt(7)
    v_mfma_f32_32x32x16_bf16 v[80:95], v[28:31], v[128:131], v[80:95]
    ds_read_b64_tr_b16 v[40:41], v231 offset:12288
    ds_read_b64_tr_b16 v[42:43], v231 offset:15360
    s_waitcnt lgkmcnt(7)
    v_mfma_f32_32x32x16_bf16 v[96:111], v[28:31], v[132:135], v[96:111]
    s_add_u32 s12, s72, 147456
    s_add_u32 m0, s82, 1024
    s_nop 0
    buffer_load_dwordx4 v4, s[48:51], s12 offen sc1 lds
    ds_read_b128 v[28:31], v225 offset:3072
    ds_read_b64_tr_b16 v[44:45], v229 offset:18432
    ds_read_b64_tr_b16 v[46:47], v229 offset:21504
    s_waitcnt lgkmcnt(7)
    v_mfma_f32_32x32x16_bf16 v[64:79], v[24:27], v[32:35], v[64:79]
    ds_read_b64_tr_b16 v[128:129], v230 offset:18432
    ds_read_b64_tr_b16 v[130:131], v230 offset:21504
    s_waitcnt lgkmcnt(7)
    v_mfma_f32_32x32x16_bf16 v[80:95], v[24:27], v[36:39], v[80:95]
    s_load_dwordx2 s[24:25], s[0:1], 0
    s_load_dwordx2 s[26:27], s[0:1], 64
    v_add_u32 v176, s31, v7
    v_lshrrev_b32 v176, 1, v176
    v_and_b32 v177, 31, v1
    s_mul_i32 s12, s46, 6
    s_add_u32 s12, s12, s77
    s_lshl_b32 s12, s12, 6
    v_lshl_add_u32 v177, v177, 1, s12
    v_lshrrev_b32 v178, 5, v1
    v_lshlrev_b32 v178, 5, v178
    s_waitcnt lgkmcnt(0)
    buffer_load_dwordx4 v[168:171], v178, s[48:51], s30 offen sc1
    buffer_load_dwordx4 v[172:175], v178, s[48:51], s30 offen offset:16 sc1
    ds_read_b64_tr_b16 v[132:133], v231 offset:18432
    ds_read_b64_tr_b16 v[134:135], v231 offset:21504
    s_waitcnt lgkmcnt(7)
    v_mfma_f32_32x32x16_bf16 v[96:111], v[24:27], v[40:43], v[96:111]
    s_waitcnt vmcnt(7)
    s_barrier
    ds_read_b128 v[24:27], v225 offset:40960
    ds_read_b64_tr_b16 v[32:33], v229 offset:40960
    ds_read_b64_tr_b16 v[34:35], v229 offset:44032
    s_waitcnt lgkmcnt(7)
    v_mfma_f32_32x32x16_bf16 v[64:79], v[28:31], v[44:47], v[64:79]
    buffer_load_dword v13, v242, s[48:51], s28 offen sc1
    ds_read_b64_tr_b16 v[36:37], v230 offset:40960
    ds_read_b64_tr_b16 v[38:39], v230 offset:44032
    s_waitcnt lgkmcnt(7)
    v_mfma_f32_32x32x16_bf16 v[80:95], v[28:31], v[128:131], v[80:95]
    ds_read_b64_tr_b16 v[40:41], v231 offset:40960
    ds_read_b64_tr_b16 v[42:43], v231 offset:44032
    s_waitcnt lgkmcnt(7)
    v_mfma_f32_32x32x16_bf16 v[96:111], v[28:31], v[132:135], v[96:111]
    global_load_ushort v124, v177, s[26:27] offset:0
    global_load_ushort v125, v177, s[26:27] offset:64
    global_load_ushort v126, v177, s[26:27] offset:128
    ds_read_b128 v[28:31], v225 offset:41984
    ds_read_b64_tr_b16 v[44:45], v229 offset:47104
    ds_read_b64_tr_b16 v[46:47], v229 offset:50176
    s_waitcnt lgkmcnt(7)
    v_mfma_f32_32x32x16_bf16 v[64:79], v[24:27], v[32:35], v[64:79]
    ds_read_b64_tr_b16 v[128:129], v230 offset:47104
    ds_read_b64_tr_b16 v[130:131], v230 offset:50176
    s_waitcnt lgkmcnt(7)
    v_mfma_f32_32x32x16_bf16 v[80:95], v[24:27], v[36:39], v[80:95]
    s_add_i32 s73, s44, 9
    s_cmp_lt_u32 s73, 9
    s_cselect_b32 s64, s68, s70
    s_cselect_b32 s65, s69, s71
    s_cselect_b32 s72, 0, 128
    s_cselect_b32 s12, 0, 9
    s_sub_u32 s73, s73, s12
    s_add_u32 s72, s72, s29
    s_lshl_b32 s12, s73, 14
    s_add_u32 s72, s72, s12
    s_lshl_b32 s73, s73, 7
    s_add_u32 s73, s73, s74
    s_add_u32 s12, s73, 0
    s_add_u32 m0, s83, 40960
    s_nop 0
    buffer_load_dwordx4 v5, s[64:67], s12 offen lds
    ds_read_b64_tr_b16 v[132:133], v231 offset:47104
    ds_read_b64_tr_b16 v[134:135], v231 offset:50176
    s_waitcnt lgkmcnt(7)
    v_mfma_f32_32x32x16_bf16 v[96:111], v[24:27], v[40:43], v[96:111]
    ds_read_b128 v[24:27], v225 offset:43008
    ds_read_b64_tr_b16 v[32:33], v229 offset:53248
    ds_read_b64_tr_b16 v[34:35], v229 offset:56320
    s_waitcnt lgkmcnt(7)
    v_mfma_f32_32x32x16_bf16 v[64:79], v[28:31], v[44:47], v[64:79]
    s_add_u32 s12, s73, 9216
    s_add_u32 m0, s83, 41984
    s_nop 0
    buffer_load_dwordx4 v6, s[64:67], s12 offen lds
    ds_read_b64_tr_b16 v[36:37], v230 offset:53248
    ds_read_b64_tr_b16 v[38:39], v230 offset:56320
    s_waitcnt lgkmcnt(7)
    v_mfma_f32_32x32x16_bf16 v[80:95], v[28:31], v[128:131], v[80:95]
    ds_read_b64_tr_b16 v[40:41], v231 offset:53248
    ds_read_b64_tr_b16 v[42:43], v231 offset:56320
    s_waitcnt lgkmcnt(7)
    v_mfma_f32_32x32x16_bf16 v[96:111], v[28:31], v[132:135], v[96:111]
    s_add_u32 s12, s73, 18432
    s_add_u32 m0, s83, 43008
    s_nop 0
    buffer_load_dwordx4 v5, s[64:67], s12 offen lds
    ds_read_b128 v[28:31], v225 offset:44032
    ds_read_b64_tr_b16 v[44:45], v229 offset:59392
    ds_read_b64_tr_b16 v[46:47], v229 offset:62464
    s_waitcnt lgkmcnt(7)
    v_mfma_f32_32x32x16_bf16 v[64:79], v[24:27], v[32:35], v[64:79]
    ds_read_b64_tr_b16 v[128:129], v230 offset:59392
    ds_read_b64_tr_b16 v[130:131], v230 offset:62464
    s_waitcnt lgkmcnt(7)
    v_mfma_f32_32x32x16_bf16 v[80:95], v[24:27], v[36:39], v[80:95]
    s_add_u32 m0, s82, 40960
    s_nop 0
    buffer_load_dwordx4 v4, s[48:51], s72 offen sc1 lds
    ds_read_b64_tr_b16 v[132:133], v231 offset:59392
    ds_read_b64_tr_b16 v[134:135], v231 offset:62464
    s_waitcnt lgkmcnt(7)
    v_mfma_f32_32x32x16_bf16 v[96:111], v[24:27], v[40:43], v[96:111]
    s_waitcnt vmcnt(10)
    s_barrier
    s_waitcnt vmcnt(7)
    s_cmp_lt_u32 s44, 3
    s_cbranch_scc1 NOF8_43
    v_cmp_ne_u32 vcc, s15, v13
    s_cbranch_vccnz SLOW_44
BACK_45:
NOF8_43:
    ds_read_b64_tr_b16 v[24:25], v232 offset:0
    ds_read_b64_tr_b16 v[26:27], v244 offset:0
    ds_read_b128 v[32:35], v234 offset:0
    s_waitcnt lgkmcnt(7)
    v_mfma_f32_32x32x16_bf16 v[64:79], v[28:31], v[44:47], v[64:79]
    s_add_u32 s12, s72, 147456
    s_add_u32 m0, s82, 41984
    s_nop 0
    buffer_load_dwordx4 v4, s[48:51], s12 offen sc1 lds
    ds_read_b128 v[36:39], v234 offset:4096
    s_waitcnt lgkmcnt(6)
    v_mfma_f32_32x32x16_bf16 v[80:95], v[28:31], v[128:131], v[80:95]
    ds_read_b128 v[40:43], v234 offset:8192
    s_waitcnt lgkmcnt(5)
    v_mfma_f32_32x32x16_bf16 v[96:111], v[28:31], v[132:135], v[96:111]
    global_load_ushort v112, v176, s[24:25] offset:0
    global_load_ushort v116, v176, s[24:25] offset:64
    global_load_ushort v120, v176, s[24:25] offset:128
    ds_read_b64_tr_b16 v[28:29], v232 offset:4096
    ds_read_b64_tr_b16 v[30:31], v244 offset:4096
    ds_read_b128 v[44:47], v235 offset:0
    s_waitcnt lgkmcnt(5)
    v_mfma_f32_32x32x16_bf16 v[64:79], v[24:27], v[32:35], v[64:79]
    ds_read_b128 v[128:131], v235 offset:4096
    s_waitcnt lgkmcnt(5)
    v_mfma_f32_32x32x16_bf16 v[80:95], v[24:27], v[36:39], v[80:95]
    global_load_ushort v113, v176, s[24:25] offset:1152
    global_load_ushort v117, v176, s[24:25] offset:1216
    global_load_ushort v121, v176, s[24:25] offset:1280
    ds_read_b128 v[132:135], v235 offset:8192
    s_waitcnt lgkmcnt(5)
    v_mfma_f32_32x32x16_bf16 v[96:111], v[24:27], v[40:43], v[96:111]
    ds_read_b64_tr_b16 v[24:25], v232 offset:8192
    ds_read_b64_tr_b16 v[26:27], v244 offset:8192
    ds_read_b128 v[32:35], v236 offset:0
    s_waitcnt lgkmcnt(5)
    v_mfma_f32_32x32x16_bf16 v[64:79], v[28:31], v[44:47], v[64:79]
    s_add_i32 s73, s44, 14
    s_cmp_eq_u32 s44, 3
    s_cselect_b32 s73, 8, s73
    s_min_u32 s73, s73, 17
    s_cmp_lt_u32 s73, 9
    s_cselect_b32 s64, s68, s70
    s_cselect_b32 s65, s69, s71
    s_cselect_b32 s72, 0, 128
    s_cselect_b32 s12, 0, 9
    s_sub_u32 s73, s73, s12
    s_add_u32 s72, s72, s29
    s_lshl_b32 s12, s73, 14
    s_add_u32 s72, s72, s12
    s_lshl_b32 s73, s73, 7
    s_add_u32 s73, s73, s74
    s_add_u32 s12, s73, 0
    s_add_u32 m0, s83, 81920
    s_nop 0
    buffer_load_dwordx4 v5, s[64:67], s12 offen lds
    ds_read_b128 v[36:39], v236 offset:4096
    s_waitcnt lgkmcnt(5)
    v_mfma_f32_32x32x16_bf16 v[80:95], v[28:31], v[128:131], v[80:95]
    ds_read_b128 v[40:43], v236 offset:8192
    s_waitcnt lgkmcnt(5)
    v_mfma_f32_32x32x16_bf16 v[96:111], v[28:31], v[132:135], v[96:111]
    s_add_u32 s12, s73, 9216
    s_add_u32 m0, s83, 82944
    s_nop 0
    buffer_load_dwordx4 v6, s[64:67], s12 offen lds
    ds_read_b64_tr_b16 v[28:29], v232 offset:12288
    ds_read_b64_tr_b16 v[30:31], v244 offset:12288
    ds_read_b128 v[44:47], v237 offset:0
    s_waitcnt lgkmcnt(5)
    v_mfma_f32_32x32x16_bf16 v[64:79], v[24:27], v[32:35], v[64:79]
    ds_read_b128 v[128:131], v237 offset:4096
    s_waitcnt lgkmcnt(5)
    v_mfma_f32_32x32x16_bf16 v[80:95], v[24:27], v[36:39], v[80:95]
    s_add_u32 s12, s73, 18432
    s_add_u32 m0, s83, 83968
    s_nop 0
    buffer_load_dwordx4 v5, s[64:67], s12 offen lds
    ds_read_b128 v[132:135], v237 offset:8192
    s_waitcnt lgkmcnt(5)
    v_mfma_f32_32x32x16_bf16 v[96:111], v[24:27], v[40:43], v[96:111]
    s_waitcnt vmcnt(9)
    s_barrier
    ds_read_b64_tr_b16 v[24:25], v232 offset:40960
    ds_read_b64_tr_b16 v[26:27], v244 offset:40960
    ds_read_b128 v[32:35], v234 offset:40960
    s_waitcnt lgkmcnt(5)
    v_mfma_f32_32x32x16_bf16 v[64:79], v[28:31], v[44:47], v[64:79]
    s_add_u32 m0, s82, 81920
    s_nop 0
    buffer_load_dwordx4 v4, s[48:51], s72 offen sc1 lds
    ds_read_b128 v[36:39], v234 offset:45056
    s_waitcnt lgkmcnt(5)
    v_mfma_f32_32x32x16_bf16 v[80:95], v[28:31], v[128:131], v[80:95]
    ds_read_b128 v[40:43], v234 offset:49152
    s_waitcnt lgkmcnt(5)
    v_mfma_f32_32x32x16_bf16 v[96:111], v[28:31], v[132:135], v[96:111]
    s_add_u32 s12, s72, 147456
    s_add_u32 m0, s82, 82944
    s_nop 0
    buffer_load_dwordx4 v4, s[48:51], s12 offen sc1 lds
    ds_read_b64_tr_b16 v[28:29], v232 offset:45056
    ds_read_b64_tr_b16 v[30:31], v244 offset:45056
    ds_read_b128 v[44:47], v235 offset:40960
    s_waitcnt lgkmcnt(5)
    v_mfma_f32_32x32x16_bf16 v[64:79], v[24:27], v[32:35], v[64:79]
    ds_read_b128 v[128:131], v235 offset:45056
    s_waitcnt lgkmcnt(5)
    v_mfma_f32_32x32x16_bf16 v[80:95], v[24:27], v[36:39], v[80:95]
    global_load_ushort v114, v176, s[24:25] offset:2304
    global_load_ushort v118, v176, s[24:25] offset:2368
    global_load_ushort v122, v176, s[24:25] offset:2432
    ds_read_b128 v[132:135], v235 offset:49152
    s_waitcnt lgkmcnt(5)
    v_mfma_f32_32x32x16_bf16 v[96:111], v[24:27], v[40:43], v[96:111]
    ds_read_b64_tr_b16 v[24:25], v232 offset:49152
    ds_read_b64_tr_b16 v[26:27], v244 offset:49152
    ds_read_b128 v[32:35], v236 offset:40960
    s_waitcnt lgkmcnt(5)
    v_mfma_f32_32x32x16_bf16 v[64:79], v[28:31], v[44:47], v[64:79]
    global_load_ushort v115, v176, s[24:25] offset:3456
    global_load_ushort v119, v176, s[24:25] offset:3520
    global_load_ushort v123, v176, s[24:25] offset:3584
    ds_read_b128 v[36:39], v236 offset:45056
    s_waitcnt lgkmcnt(5)
    v_mfma_f32_32x32x16_bf16 v[80:95], v[28:31], v[128:131], v[80:95]
    s_waitcnt vmcnt(0)
    s_mov_b32 s13, 0xffff0000
    v_lshlrev_b32 v124, 16, v124
    v_lshlrev_b32 v125, 16, v125
    v_lshlrev_b32 v126, 16, v126
    ds_read_b128 v[40:43], v236 offset:49152
    s_waitcnt lgkmcnt(5)
    v_mfma_f32_32x32x16_bf16 v[96:111], v[28:31], v[132:135], v[96:111]
    v_lshlrev_b32 v112, 16, v112
    v_lshlrev_b32 v113, 16, v113
    v_sub_f32 v180, v112, v168
    v_sub_f32 v181, v113, v170
    ds_read_b64_tr_b16 v[28:29], v232 offset:53248
    ds_read_b64_tr_b16 v[30:31], v244 offset:53248
    ds_read_b128 v[44:47], v237 offset:40960
    s_waitcnt lgkmcnt(5)
    v_mfma_f32_32x32x16_bf16 v[64:79], v[24:27], v[32:35], v[64:79]
    v_cvt_pk_bf16_f32 v181, v180, v181
    v_lshlrev_b32 v180, 16, v181
    v_and_b32 v181, s13, v181
    v_mul_f32 v180, v180, v169
    ds_read_b128 v[128:131], v237 offset:45056
    s_waitcnt lgkmcnt(5)
    v_mfma_f32_32x32x16_bf16 v[80:95], v[24:27], v[36:39], v[80:95]
    v_mul_f32 v181, v181, v171
    v_cvt_pk_bf16_f32 v181, v180, v181
    v_lshlrev_b32 v180, 16, v181
    v_and_b32 v181, s13, v181
    ds_read_b128 v[132:135], v237 offset:49152
    s_waitcnt lgkmcnt(5)
    v_mfma_f32_32x32x16_bf16 v[96:111], v[24:27], v[40:43], v[96:111]
    v_mul_f32 v180, v180, v124
    v_mul_f32 v181, v181, v124
    v_cvt_pk_bf16_f32 v181, v180, v181
    v_lshlrev_b32 v180, 16, v181
    s_barrier
    ds_read_b64_tr_b16 v[24:25], v233 offset:0
    ds_read_b64_tr_b16 v[26:27], v245 offset:0
    ds_read_b128 v[32:35], v238 offset:0
    s_waitcnt lgkmcnt(5)
    v_mfma_f32_32x32x16_bf16 v[64:79], v[28:31], v[44:47], v[64:79]
    v_and_b32 v181, s13, v181
    v_add_f32 v112, v112, v180
    v_add_f32 v113, v113, v181
    v_lshlrev_b32 v114, 16, v114
    ds_read_b128 v[36:39], v238 offset:4096
    s_waitcnt lgkmcnt(5)
    v_mfma_f32_32x32x16_bf16 v[80:95], v[28:31], v[128:131], v[80:95]
    v_lshlrev_b32 v115, 16, v115
    v_sub_f32 v180, v114, v172
    v_sub_f32 v181, v115, v174
    v_cvt_pk_bf16_f32 v181, v180, v181
    ds_read_b128 v[40:43], v238 offset:8192
    s_waitcnt lgkmcnt(5)
    v_mfma_f32_32x32x16_bf16 v[96:111], v[28:31], v[132:135], v[96:111]
    v_lshlrev_b32 v180, 16, v181
    v_and_b32 v181, s13, v181
    v_mul_f32 v180, v180, v173
    v_mul_f32 v181, v181, v175
    ds_read_b64_tr_b16 v[28:29], v233 offset:4096
    ds_read_b64_tr_b16 v[30:31], v245 offset:4096
    ds_read_b128 v[44:47], v239 offset:0
    s_waitcnt lgkmcnt(5)
    v_mfma_f32_32x32x16_bf16 v[64:79], v[24:27], v[32:35], v[64:79]
    v_cvt_pk_bf16_f32 v181, v180, v181
    v_lshlrev_b32 v180, 16, v181
    v_and_b32 v181, s13, v181
    v_mul_f32 v180, v180, v124
    ds_read_b128 v[128:131], v239 offset:4096
    s_waitcnt lgkmcnt(5)
    v_mfma_f32_32x32x16_bf16 v[80:95], v[24:27], v[36:39], v[80:95]
    v_mul_f32 v181, v181, v124
    v_cvt_pk_bf16_f32 v181, v180, v181
    v_lshlrev_b32 v180, 16, v181
    v_and_b32 v181, s13, v181
    ds_read_b128 v[132:135], v239 offset:8192
    s_waitcnt lgkmcnt(5)
    v_mfma_f32_32x32x16_bf16 v[96:111], v[24:27], v[40:43], v[96:111]
    v_add_f32 v114, v114, v180
    v_add_f32 v115, v115, v181
    v_lshlrev_b32 v116, 16, v116
    v_lshlrev_b32 v117, 16, v117
    ds_read_b64_tr_b16 v[24:25], v233 offset:8192
    ds_read_b64_tr_b16 v[26:27], v245 offset:8192
    ds_read_b128 v[32:35], v240 offset:0
    s_waitcnt lgkmcnt(5)
    v_mfma_f32_32x32x16_bf16 v[64:79], v[28:31], v[44:47], v[64:79]
    v_sub_f32 v180, v116, v168
    v_sub_f32 v181, v117, v170
    v_cvt_pk_bf16_f32 v181, v180, v181
    v_lshlrev_b32 v180, 16, v181
    ds_read_b128 v[36:39], v240 offset:4096
    s_waitcnt lgkmcnt(5)
    v_mfma_f32_32x32x16_bf16 v[80:95], v[28:31], v[128:131], v[80:95]
    v_and_b32 v181, s13, v181
    v_mul_f32 v180, v180, v169
    v_mul_f32 v181, v181, v171
    v_cvt_pk_bf16_f32 v181, v180, v181
    ds_read_b128 v[40:43], v240 offset:8192
    s_waitcnt lgkmcnt(5)
    v_mfma_f32_32x32x16_bf16 v[96:111], v[28:31], v[132:135], v[96:111]
    v_lshlrev_b32 v180, 16, v181
    v_and_b32 v181, s13, v181
    v_mul_f32 v180, v180, v125
    v_mul_f32 v181, v181, v125
    ds_read_b64_tr_b16 v[28:29], v233 offset:12288
    ds_read_b64_tr_b16 v[30:31], v245 offset:12288
    ds_read_b128 v[44:47], v241 offset:0
    s_waitcnt lgkmcnt(5)
    v_mfma_f32_32x32x16_bf16 v[64:79], v[24:27], v[32:35], v[64:79]
    v_cvt_pk_bf16_f32 v181, v180, v181
    v_lshlrev_b32 v180, 16, v181
    v_and_b32 v181, s13, v181
    v_add_f32 v116, v116, v180
    ds_read_b128 v[128:131], v241 offset:4096
    s_waitcnt lgkmcnt(5)
    v_mfma_f32_32x32x16_bf16 v[80:95], v[24:27], v[36:39], v[80:95]
    v_add_f32 v117, v117, v181
    v_lshlrev_b32 v118, 16, v118
    v_lshlrev_b32 v119, 16, v119
    v_sub_f32 v180, v118, v172
    ds_read_b128 v[132:135], v241 offset:8192
    s_waitcnt lgkmcnt(5)
    v_mfma_f32_32x32x16_bf16 v[96:111], v[24:27], v[40:43], v[96:111]
    v_sub_f32 v181, v119, v174
    v_cvt_pk_bf16_f32 v181, v180, v181
    v_lshlrev_b32 v180, 16, v181
    v_and_b32 v181, s13, v181
    s_waitcnt lgkmcnt(2)
    v_mfma_f32_32x32x16_bf16 v[64:79], v[28:31], v[44:47], v[64:79]
    v_mul_f32 v180, v180, v173
    v_mul_f32 v181, v181, v175
    v_cvt_pk_bf16_f32 v181, v180, v181
    v_lshlrev_b32 v180, 16, v181
    s_waitcnt lgkmcnt(1)
    v_mfma_f32_32x32x16_bf16 v[80:95], v[28:31], v[128:131], v[80:95]
    v_and_b32 v181, s13, v181
    v_mul_f32 v180, v180, v125
    v_mul_f32 v181, v181, v125
    v_cvt_pk_bf16_f32 v181, v180, v181
    s_waitcnt lgkmcnt(0)
    v_mfma_f32_32x32x16_bf16 v[96:111], v[28:31], v[132:135], v[96:111]
    v_lshlrev_b32 v180, 16, v181
    v_and_b32 v181, s13, v181
    v_add_f32 v118, v118, v180
    v_add_f32 v119, v119, v181
    s_branch K2_J
K2_V1:
    s_waitcnt vmcnt(6)
    s_barrier
    s_waitcnt vmcnt(5)
    v_cmp_ne_u32 vcc, s15, v13
    s_cbranch_vccnz SLOW_46
BACK_47:
    ds_read_b128 v[24:27], v224 offset:40960
    ds_read_b64_tr_b16 v[32:33], v226 offset:40960
    ds_read_b64_tr_b16 v[34:35], v226 offset:44032
    s_waitcnt lgkmcnt(7)
    v_mfma_f32_32x32x16_bf16 v[64:79], v[28:31], v[44:47], v[64:79]
    s_add_i32 s73, s44, -2
    s_cmp_lt_u32 s73, 9
    s_cselect_b32 s64, s68, s70
    s_cselect_b32 s65, s69, s71
    s_cselect_b32 s72, 0, 128
    s_cselect_b32 s12, 0, 9
    s_sub_u32 s73, s73, s12
    s_add_u32 s72, s72, s29
    s_lshl_b32 s12, s73, 14
    s_add_u32 s72, s72, s12
    s_lshl_b32 s73, s73, 7
    s_add_u32 s73, s73, s74
    s_add_u32 s12, s73, 0
    s_add_u32 m0, s83, 122880
    s_nop 0
    buffer_load_dwordx4 v5, s[64:67], s12 offen lds
    ds_read_b64_tr_b16 v[36:37], v227 offset:40960
    ds_read_b64_tr_b16 v[38:39], v227 offset:44032
    s_waitcnt lgkmcnt(7)
    v_mfma_f32_32x32x16_bf16 v[80:95], v[28:31], v[128:131], v[80:95]
    ds_read_b64_tr_b16 v[40:41], v228 offset:40960
    ds_read_b64_tr_b16 v[42:43], v228 offset:44032
    s_waitcnt lgkmcnt(7)
    v_mfma_f32_32x32x16_bf16 v[96:111], v[28:31], v[132:135], v[96:111]
    s_add_u32 s12, s73, 9216
    s_add_u32 m0, s83, 123904
    s_nop 0
    buffer_load_dwordx4 v6, s[64:67], s12 offen lds
    ds_read_b128 v[28:31], v224 offset:41984
    ds_read_b64_tr_b16 v[44:45], v226 offset:47104
    ds_read_b64_tr_b16 v[46:47], v226 offset:50176
    s_waitcnt lgkmcnt(7)
    v_mfma_f32_32x32x16_bf16 v[64:79], v[24:27], v[32:35], v[64:79]
    ds_read_b64_tr_b16 v[128:129], v227 offset:47104
    ds_read_b64_tr_b16 v[130:131], v227 offset:50176
    s_waitcnt lgkmcnt(7)
    v_mfma_f32_32x32x16_bf16 v[80:95], v[24:27], v[36:39], v[80:95]
    s_add_u32 s12, s73, 18432
    s_add_u32 m0, s83, 124928
    s_nop 0
    buffer_load_dwordx4 v5, s[64:67], s12 offen lds
    ds_read_b64_tr_b16 v[132:133], v228 offset:47104
    ds_read_b64_tr_b16 v[134:135], v228 offset:50176
    s_waitcnt lgkmcnt(7)
    v_mfma_f32_32x32x16_bf16 v[96:111], v[24:27], v[40:43], v[96:111]
    ds_read_b128 v[24:27], v224 offset:43008
    ds_read_b64_tr_b16 v[32:33], v226 offset:53248
    ds_read_b64_tr_b16 v[34:35], v226 offset:56320
    s_waitcnt lgkmcnt(7)
    v_mfma_f32_32x32x16_bf16 v[64:79], v[28:31], v[44:47], v[64:79]
    s_add_u32 m0, s82, 122880
    s_nop 0
    buffer_load_dwordx4 v4, s[48:51], s72 offen sc1 lds
    ds_read_b64_tr_b16 v[36:37], v227 offset:53248
    ds_read_b64_tr_b16 v[38:39], v227 offset:56320
    s_waitcnt lgkmcnt(7)
    v_mfma_f32_32x32x16_bf16 v[80:95], v[28:31], v[128:131], v[80:95]
    ds_read_b64_tr_b16 v[40:41], v228 offset:53248
    ds_read_b64_tr_b16 v[42:43], v228 offset:56320
    s_waitcnt lgkmcnt(7)
    v_mfma_f32_32x32x16_bf16 v[96:111], v[28:31], v[132:135], v[96:111]
    s_add_u32 s12, s72, 147456
    s_add_u32 m0, s82, 123904
    s_nop 0
    buffer_load_dwordx4 v4, s[48:51], s12 offen sc1 lds
    ds_read_b128 v[28:31], v224 offset:44032
    ds_read_b64_tr_b16 v[44:45], v226 offset:59392
    ds_read_b64_tr_b16 v[46:47], v226 offset:62464
    s_waitcnt lgkmcnt(7)
    v_mfma_f32_32x32x16_bf16 v[64:79], v[24:27], v[32:35], v[64:79]
    ds_read_b64_tr_b16 v[128:129], v227 offset:59392
    ds_read_b64_tr_b16 v[130:131], v227 offset:62464
    s_waitcnt lgkmcnt(7)
    v_mfma_f32_32x32x16_bf16 v[80:95], v[24:27], v[36:39], v[80:95]
    ds_read_b64_tr_b16 v[132:133], v228 offset:59392
    ds_read_b64_tr_b16 v[134:135], v228 offset:62464
    s_waitcnt lgkmcnt(7)
    v_mfma_f32_32x32x16_bf16 v[96:111], v[24:27], v[40:43], v[96:111]
    s_waitcnt vmcnt(5)
    s_barrier
    ds_read_b128 v[24:27], v225 offset:0
    ds_read_b64_tr_b16 v[32:33], v229 offset:0
    ds_read_b64_tr_b16 v[34:35], v229 offset:3072
    s_waitcnt lgkmcnt(7)
    v_mfma_f32_32x32x16_bf16 v[64:79], v[28:31], v[44:47], v[64:79]
    s_add_i32 s73, s44, 3
    s_cmp_lt_u32 s73, 9
    s_cselect_b32 s64, s68, s70
    s_cselect_b32 s65, s69, s71
    s_cselect_b32 s72, 0, 128
    s_cselect_b32 s12, 0, 9
    s_sub_u32 s73, s73, s12
    s_add_u32 s72, s72, s29
    s_lshl_b32 s12, s73, 14
    s_add_u32 s72, s72, s12
    s_lshl_b32 s73, s73, 7
    s_add_u32 s73, s73, s74
    s_add_u32 s12, s73, 0
    s_add_u32 m0, s83, 0
    s_nop 0
    buffer_load_dwordx4 v5, s[64:67], s12 offen lds
    ds_read_b64_tr_b16 v[36:37], v230 offset:0
    ds_read_b64_tr_b16 v[38:39], v230 offset:3072
    s_waitcnt lgkmcnt(7)
    v_mfma_f32_32x32x16_bf16 v[80:95], v[28:31], v[128:131], v[80:95]
    ds_read_b64_tr_b16 v[40:41], v231 offset:0
    ds_read_b64_tr_b16 v[42:43], v231 offset:3072
    s_waitcnt lgkmcnt(7)
    v_mfma_f32_32x32x16_bf16 v[96:111], v[28:31], v[132:135], v[96:111]
    s_add_u32 s12, s73, 9216
    s_add_u32 m0, s83, 1024
    s_nop 0
    buffer_load_dwordx4 v6, s[64:67], s12 offen lds
    ds_read_b128 v[28:31], v225 offset:1024
    ds_read_b64_tr_b16 v[44:45], v229 offset:6144
    ds_read_b64_tr_b16 v[46:47], v229 offset:9216
    s_waitcnt lgkmcnt(7)
    v_mfma_f32_32x32x16_bf16 v[64:79], v[24:27], v[32:35], v[64:79]
    ds_read_b64_tr_b16 v[128:129], v230 offset:6144
    ds_read_b64_tr_b16 v[130:131], v230 offset:9216
    s_waitcnt lgkmcnt(7)
    v_mfma_f32_32x32x16_bf16 v[80:95], v[24:27], v[36:39], v[80:95]
    s_add_u32 s12, s73, 18432
    s_add_u32 m0, s83, 2048
    s_nop 0
    buffer_load_dwordx4 v5, s[64:67], s12 offen lds
    ds_read_b64_tr_b16 v[132:133], v231 offset:6144
    ds_read_b64_tr_b16 v[134:135], v231 offset:9216
    s_waitcnt lgkmcnt(7)
    v_mfma_f32_32x32x16_bf16 v[96:111], v[24:27], v[40:43], v[96:111]
    ds_read_b128 v[24:27], v225 offset:2048
    ds_read_b64_tr_b16 v[32:33], v229 offset:12288
    ds_read_b64_tr_b16 v[34:35], v229 offset:15360
    s_waitcnt lgkmcnt(7)
    v_mfma_f32_32x32x16_bf16 v[64:79], v[28:31], v[44:47], v[64:79]
    s_add_u32 m0, s82, 0
    s_nop 0
    buffer_load_dwordx4 v4, s[48:51], s72 offen sc1 lds
    ds_read_b64_tr_b16 v[36:37], v230 offset:12288
    ds_read_b64_tr_b16 v[38:39], v230 offset:15360
    s_waitcnt lgkmcnt(7)
    v_mfma_f32_32x32x16_bf16 v[80:95], v[28:31], v[128:131], v[80:95]
    ds_read_b64_tr_b16 v[40:41], v231 offset:12288
    ds_read_b64_tr_b16 v[42:43], v231 offset:15360
    s_waitcnt lgkmcnt(7)
    v_mfma_f32_32x32x16_bf16 v[96:111], v[28:31], v[132:135], v[96:111]
    s_add_u32 s12, s72, 147456
    s_add_u32 m0, s82, 1024
    s_nop 0
    buffer_load_dwordx4 v4, s[48:51], s12 offen sc1 lds
    ds_read_b128 v[28:31], v225 offset:3072
    ds_read_b64_tr_b16 v[44:45], v229 offset:18432
    ds_read_b64_tr_b16 v[46:47], v229 offset:21504
    s_waitcnt lgkmcnt(7)
    v_mfma_f32_32x32x16_bf16 v[64:79], v[24:27], v[32:35], v[64:79]
    ds_read_b64_tr_b16 v[128:129], v230 offset:18432
    ds_read_b64_tr_b16 v[130:131], v230 offset:21504
    s_waitcnt lgkmcnt(7)
    v_mfma_f32_32x32x16_bf16 v[80:95], v[24:27], v[36:39], v[80:95]
    s_load_dwordx2 s[24:25], s[0:1], 0
    s_load_dwordx2 s[26:27], s[0:1], 64
    v_add_u32 v176, s31, v7
    v_lshrrev_b32 v176, 1, v176
    v_and_b32 v177, 31, v1
    s_mul_i32 s12, s46, 6
    s_add_u32 s12, s12, s77
    s_lshl_b32 s12, s12, 6
    v_lshl_add_u32 v177, v177, 1, s12
    v_lshrrev_b32 v178, 5, v1
    v_lshlrev_b32 v178, 5, v178
    s_waitcnt lgkmcnt(0)
    buffer_load_dwordx4 v[168:171], v178, s[48:51], s30 offen sc1
    buffer_load_dwordx4 v[172:175], v178, s[48:51], s30 offen offset:16 sc1
    ds_read_b64_tr_b16 v[132:133], v231 offset:18432
    ds_read_b64_tr_b16 v[134:135], v231 offset:21504
    s_waitcnt lgkmcnt(7)
    v_mfma_f32_32x32x16_bf16 v[96:111], v[24:27], v[40:43], v[96:111]
    s_waitcnt vmcnt(7)
    s_barrier
    ds_read_b64_tr_b16 v[24:25], v233 offset:40960
    ds_read_b64_tr_b16 v[26:27], v245 offset:40960
    ds_read_b128 v[32:35], v238 offset:40960
    s_waitcnt lgkmcnt(7)
    v_mfma_f32_32x32x16_bf16 v[64:79], v[28:31], v[44:47], v[64:79]
    buffer_load_dword v13, v242, s[48:51], s28 offen sc1
    ds_read_b128 v[36:39], v238 offset:45056
    s_waitcnt lgkmcnt(6)
    v_mfma_f32_32x32x16_bf16 v[80:95], v[28:31], v[128:131], v[80:95]
    ds_read_b128 v[40:43], v238 offset:49152
    s_waitcnt lgkmcnt(5)
    v_mfma_f32_32x32x16_bf16 v[96:111], v[28:31], v[132:135], v[96:111]
    global_load_ushort v124, v177, s[26:27] offset:0
    global_load_ushort v125, v177, s[26:27] offset:64
    global_load_ushort v126, v177, s[26:27] offset:128
    ds_read_b64_tr_b16 v[28:29], v233 offset:45056
    ds_read_b64_tr_b16 v[30:31], v245 offset:45056
    ds_read_b128 v[44:47], v239 offset:40960
    s_waitcnt lgkmcnt(5)
    v_mfma_f32_32x32x16_bf16 v[64:79], v[24:27], v[32:35], v[64:79]
    ds_read_b128 v[128:131], v239 offset:45056
    s_waitcnt lgkmcnt(5)
    v_mfma_f32_32x32x16_bf16 v[80:95], v[24:27], v[36:39], v[80:95]
    s_add_i32 s73, s44, 9
    s_cmp_lt_u32 s73, 9
    s_cselect_b32 s64, s68, s70
    s_cselect_b32 s65, s69, s71
    s_cselect_b32 s72, 0, 128
    s_cselect_b32 s12, 0, 9
    s_sub_u32 s73, s73, s12
    s_add_u32 s72, s72, s29
    s_lshl_b32 s12, s73, 14
    s_add_u32 s72, s72, s12
    s_lshl_b32 s73, s73, 7
    s_add_u32 s73, s73, s74
    s_add_u32 s12, s73, 0
    s_add_u32 m0, s83, 40960
    s_nop 0
    buffer_load_dwordx4 v5, s[64:67], s12 offen lds
    ds_read_b128 v[132:135], v239 offset:49152
    s_waitcnt lgkmcnt(5)
    v_mfma_f32_32x32x16_bf16 v[96:111], v[24:27], v[40:43], v[96:111]
    ds_read_b64_tr_b16 v[24:25], v233 offset:49152
    ds_read_b64_tr_b16 v[26:27], v245 offset:49152
    ds_read_b128 v[32:35], v240 offset:40960
    s_waitcnt lgkmcnt(5)
    v_mfma_f32_32x32x16_bf16 v[64:79], v[28:31], v[44:47], v[64:79]
    s_add_u32 s12, s73, 9216
    s_add_u32 m0, s83, 41984
    s_nop 0
    buffer_load_dwordx4 v6, s[64:67], s12 offen lds
    ds_read_b128 v[36:39], v240 offset:45056
    s_waitcnt lgkmcnt(5)
    v_mfma_f32_32x32x16_bf16 v[80:95], v[28:31], v[128:131], v[80:95]
    ds_read_b128 v[40:43], v240 offset:49152
    s_waitcnt lgkmcnt(5)
    v_mfma_f32_32x32x16_bf16 v[96:111], v[28:31], v[132:135], v[96:111]
    s_add_u32 s12, s73, 18432
    s_add_u32 m0, s83, 43008
    s_nop 0
    buffer_load_dwordx4 v5, s[64:67], s12 offen lds
    ds_read_b64_tr_b16 v[28:29], v233 offset:53248
    ds_read_b64_tr_b16 v[30:31], v245 offset:53248
    ds_read_b128 v[44:47], v241 offset:40960
    s_waitcnt lgkmcnt(5)
    v_mfma_f32_32x32x16_bf16 v[64:79], v[24:27], v[32:35], v[64:79]
    ds_read_b128 v[128:131], v241 offset:45056
    s_waitcnt lgkmcnt(5)
    v_mfma_f32_32x32x16_bf16 v[80:95], v[24:27], v[36:39], v[80:95]
    s_add_u32 m0, s82, 40960
    s_nop 0
    buffer_load_dwordx4 v4, s[48:51], s72 offen sc1 lds
    ds_read_b128 v[132:135], v241 offset:49152
    s_waitcnt lgkmcnt(5)
    v_mfma_f32_32x32x16_bf16 v[96:111], v[24:27], v[40:43], v[96:111]
    s_waitcnt vmcnt(10)
    s_barrier
    s_waitcnt vmcnt(7)
    s_cmp_lt_u32 s44, 3
    s_cbranch_scc1 NOF8_48
    v_cmp_ne_u32 vcc, s15, v13
    s_cbranch_vccnz SLOW_49
BACK_50:
NOF8_48:
    ds_read_b64_tr_b16 v[24:25], v232 offset:0
    ds_read_b64_tr_b16 v[26:27], v244 offset:0
    ds_read_b128 v[32:35], v234 offset:0
    s_waitcnt lgkmcnt(5)
    v_mfma_f32_32x32x16_bf16 v[64:79], v[28:31], v[44:47], v[64:79]
    s_add_u32 s12, s72, 147456
    s_add_u32 m0, s82, 41984
    s_nop 0
    buffer_load_dwordx4 v4, s[48:51], s12 offen sc1 lds
    ds_read_b128 v[36:39], v234 offset:4096
    s_waitcnt lgkmcnt(5)
    v_mfma_f32_32x32x16_bf16 v[80:95], v[28:31], v[128:131], v[80:95]
    ds_read_b128 v[40:43], v234 offset:8192
    s_waitcnt lgkmcnt(5)
    v_mfma_f32_32x32x16_bf16 v[96:111], v[28:31], v[132:135], v[96:111]
    global_load_ushort v112, v176, s[24:25] offset:0
    global_load_ushort v116, v176, s[24:25] offset:64
    global_load_ushort v120, v176, s[24:25] offset:128
    ds_read_b64_tr_b16 v[28:29], v232 offset:4096
    ds_read_b64_tr_b16 v[30:31], v244 offset:4096
    ds_read_b128 v[44:47], v235 offset:0
    s_waitcnt lgkmcnt(5)
    v_mfma_f32_32x32x16_bf16 v[64:79], v[24:27], v[32:35], v[64:79]
    ds_read_b128 v[128:131], v235 offset:4096
    s_waitcnt lgkmcnt(5)
    v_mfma_f32_32x32x16_bf16 v[80:95], v[24:27], v[36:39], v[80:95]
    global_load_ushort v113, v176, s[24:25] offset:1152
    global_load_ushort v117, v176, s[24:25] offset:1216
    global_load_ushort v121, v176, s[24:25] offset:1280
    ds_read_b128 v[132:135], v235 offset:8192
    s_waitcnt lgkmcnt(5)
    v_mfma_f32_32x32x16_bf16 v[96:111], v[24:27], v[40:43], v[96:111]
    ds_read_b64_tr_b16 v[24:25], v232 offset:8192
    ds_read_b64_tr_b16 v[26:27], v244 offset:8192
    ds_read_b128 v[32:35], v236 offset:0
    s_waitcnt lgkmcnt(5)
    v_mfma_f32_32x32x16_bf16 v[64:79], v[28:31], v[44:47], v[64:79]
    s_add_i32 s73, s44, 14
    s_cmp_eq_u32 s44, 3
    s_cselect_b32 s73, 8, s73
    s_min_u32 s73, s73, 17
    s_cmp_lt_u32 s73, 9
    s_cselect_b32 s64, s68, s70
    s_cselect_b32 s65, s69, s71
    s_cselect_b32 s72, 0, 128
    s_cselect_b32 s12, 0, 9
    s_sub_u32 s73, s73, s12
    s_add_u32 s72, s72, s29
    s_lshl_b32 s12, s73, 14
    s_add_u32 s72, s72, s12
    s_lshl_b32 s73, s73, 7
    s_add_u32 s73, s73, s74
    s_add_u32 s12, s73, 0
    s_add_u32 m0, s83, 81920
    s_nop 0
    buffer_load_dwordx4 v5, s[64:67], s12 offen lds
    ds_read_b128 v[36:39], v236 offset:4096
    s_waitcnt lgkmcnt(5)
    v_mfma_f32_32x32x16_bf16 v[80:95], v[28:31], v[128:131], v[80:95]
    ds_read_b128 v[40:43], v236 offset:8192
    s_waitcnt lgkmcnt(5)
    v_mfma_f32_32x32x16_bf16 v[96:111], v[28:31], v[132:135], v[96:111]
    s_add_u32 s12, s73, 9216
    s_add_u32 m0, s83, 82944
    s_nop 0
    buffer_load_dwordx4 v6, s[64:67], s12 offen lds
    ds_read_b64_tr_b16 v[28:29], v232 offset:12288
    ds_read_b64_tr_b16 v[30:31], v244 offset:12288
    ds_read_b128 v[44:47], v237 offset:0
    s_waitcnt lgkmcnt(5)
    v_mfma_f32_32x32x16_bf16 v[64:79], v[24:27], v[32:35], v[64:79]
    ds_read_b128 v[128:131], v237 offset:4096
    s_waitcnt lgkmcnt(5)
    v_mfma_f32_32x32x16_bf16 v[80:95], v[24:27], v[36:39], v[80:95]
    s_add_u32 s12, s73, 18432
    s_add_u32 m0, s83, 83968
    s_nop 0
    buffer_load_dwordx4 v5, s[64:67], s12 offen lds
    ds_read_b128 v[132:135], v237 offset:8192
    s_waitcnt lgkmcnt(5)
    v_mfma_f32_32x32x16_bf16 v[96:111], v[24:27], v[40:43], v[96:111]
    s_waitcnt vmcnt(9)
    s_barrier
    ds_read_b64_tr_b16 v[24:25], v232 offset:40960
    ds_read_b64_tr_b16 v[26:27], v244 offset:40960
    ds_read_b128 v[32:35], v234 offset:40960
    s_waitcnt lgkmcnt(5)
    v_mfma_f32_32x32x16_bf16 v[64:79], v[28:31], v[44:47], v[64:79]
    s_add_u32 m0, s82, 81920
    s_nop 0
    buffer_load_dwordx4 v4, s[48:51], s72 offen sc1 lds
    ds_read_b128 v[36:39], v234 offset:45056
    s_waitcnt lgkmcnt(5)
    v_mfma_f32_32x32x16_bf16 v[80:95], v[28:31], v[128:131], v[80:95]
    ds_read_b128 v[40:43], v234 offset:49152
    s_waitcnt lgkmcnt(5)
    v_mfma_f32_32x32x16_bf16 v[96:111], v[28:31], v[132:135], v[96:111]
    s_add_u32 s12, s72, 147456
    s_add_u32 m0, s82, 82944
    s_nop 0
    buffer_load_dwordx4 v4, s[48:51], s12 offen sc1 lds
    ds_read_b64_tr_b16 v[28:29], v232 offset:45056
    ds_read_b64_tr_b16 v[30:31], v244 offset:45056
    ds_read_b128 v[44:47], v235 offset:40960
    s_waitcnt lgkmcnt(5)
    v_mfma_f32_32x32x16_bf16 v[64:79], v[24:27], v[32:35], v[64:79]
    ds_read_b128 v[128:131], v235 offset:45056
    s_waitcnt lgkmcnt(5)
    v_mfma_f32_32x32x16_bf16 v[80:95], v[24:27], v[36:39], v[80:95]
    global_load_ushort v114, v176, s[24:25] offset:2304
    global_load_ushort v118, v176, s[24:25] offset:2368
    global_load_ushort v122, v176, s[24:25] offset:2432
    ds_read_b128 v[132:135], v235 offset:49152
    s_waitcnt lgkmcnt(5)
    v_mfma_f32_32x32x16_bf16 v[96:111], v[24:27], v[40:43], v[96:111]
    ds_read_b64_tr_b16 v[24:25], v232 offset:49152
    ds_read_b64_tr_b16 v[26:27], v244 offset:49152
    ds_read_b128 v[32:35], v236 offset:40960
    s_waitcnt lgkmcnt(5)
    v_mfma_f32_32x32x16_bf16 v[64:79], v[28:31], v[44:47], v[64:79]
    global_load_ushort v115, v176, s[24:25] offset:3456
    global_load_ushort v119, v176, s[24:25] offset:3520
    global_load_ushort v123, v176, s[24:25] offset:3584
    ds_read_b128 v[36:39], v236 offset:45056
    s_waitcnt lgkmcnt(5)
    v_mfma_f32_32x32x16_bf16 v[80:95], v[28:31], v[128:131], v[80:95]
    s_waitcnt vmcnt(0)
    s_mov_b32 s13, 0xffff0000
    v_lshlrev_b32 v124, 16, v124
    v_lshlrev_b32 v125, 16, v125
    v_lshlrev_b32 v126, 16, v126
    ds_read_b128 v[40:43], v236 offset:49152
    s_waitcnt lgkmcnt(5)
    v_mfma_f32_32x32x16_bf16 v[96:111], v[28:31], v[132:135], v[96:111]
    v_lshlrev_b32 v112, 16, v112
    v_lshlrev_b32 v113, 16, v113
    v_sub_f32 v180, v112, v168
    v_sub_f32 v181, v113, v170
    ds_read_b64_tr_b16 v[28:29], v232 offset:53248
    ds_read_b64_tr_b16 v[30:31], v244 offset:53248
    ds_read_b128 v[44:47], v237 offset:40960
    s_waitcnt lgkmcnt(5)
    v_mfma_f32_32x32x16_bf16 v[64:79], v[24:27], v[32:35], v[64:79]
    v_cvt_pk_bf16_f32 v181, v180, v181
    v_lshlrev_b32 v180, 16, v181
    v_and_b32 v181, s13, v181
    v_mul_f32 v180, v180, v169
    ds_read_b128 v[128:131], v237 offset:45056
    s_waitcnt lgkmcnt(5)
    v_mfma_f32_32x32x16_bf16 v[80:95], v[24:27], v[36:39], v[80:95]
    v_mul_f32 v181, v181, v171
    v_cvt_pk_bf16_f32 v181, v180, v181
    v_lshlrev_b32 v180, 16, v181
    v_and_b32 v181, s13, v181
    ds_read_b128 v[132:135], v237 offset:49152
    s_waitcnt lgkmcnt(5)
    v_mfma_f32_32x32x16_bf16 v[96:111], v[24:27], v[40:43], v[96:111]
    v_mul_f32 v180, v180, v124
    v_mul_f32 v181, v181, v124
    v_cvt_pk_bf16_f32 v181, v180, v181
    v_lshlrev_b32 v180, 16, v181
    s_barrier
    ds_read_b64_tr_b16 v[24:25], v233 offset:0
    ds_read_b64_tr_b16 v[26:27], v245 offset:0
    ds_read_b128 v[32:35], v238 offset:0
    s_waitcnt lgkmcnt(5)
    v_mfma_f32_32x32x16_bf16 v[64:79], v[28:31], v[44:47], v[64:79]
    v_and_b32 v181, s13, v181
    v_add_f32 v112, v112, v180
    v_add_f32 v113, v113, v181
    v_lshlrev_b32 v114, 16, v114
    ds_read_b128 v[36:39], v238 offset:4096
    s_waitcnt lgkmcnt(5)
    v_mfma_f32_32x32x16_bf16 v[80:95], v[28:31], v[128:131], v[80:95]
    v_lshlrev_b32 v115, 16, v115
    v_sub_f32 v180, v114, v172
    v_sub_f32 v181, v115, v174
    v_cvt_pk_bf16_f32 v181, v180, v181
    ds_read_b128 v[40:43], v238 offset:8192
    s_waitcnt lgkmcnt(5)
    v_mfma_f32_32x32x16_bf16 v[96:111], v[28:31], v[132:135], v[96:111]
    v_lshlrev_b32 v180, 16, v181
    v_and_b32 v181, s13, v181
    v_mul_f32 v180, v180, v173
    v_mul_f32 v181, v181, v175
    ds_read_b64_tr_b16 v[28:29], v233 offset:4096
    ds_read_b64_tr_b16 v[30:31], v245 offset:4096
    ds_read_b128 v[44:47], v239 offset:0
    s_waitcnt lgkmcnt(5)
    v_mfma_f32_32x32x16_bf16 v[64:79], v[24:27], v[32:35], v[64:79]
    v_cvt_pk_bf16_f32 v181, v180, v181
    v_lshlrev_b32 v180, 16, v181
    v_and_b32 v181, s13, v181
    v_mul_f32 v180, v180, v124
    ds_read_b128 v[128:131], v239 offset:4096
    s_waitcnt lgkmcnt(5)
    v_mfma_f32_32x32x16_bf16 v[80:95], v[24:27], v[36:39], v[80:95]
    v_mul_f32 v181, v181, v124
    v_cvt_pk_bf16_f32 v181, v180, v181
    v_lshlrev_b32 v180, 16, v181
    v_and_b32 v181, s13, v181
    ds_read_b128 v[132:135], v239 offset:8192
    s_waitcnt lgkmcnt(5)
    v_mfma_f32_32x32x16_bf16 v[96:111], v[24:27], v[40:43], v[96:111]
    v_add_f32 v114, v114, v180
    v_add_f32 v115, v115, v181
    v_lshlrev_b32 v116, 16, v116
    v_lshlrev_b32 v117, 16, v117
    ds_read_b64_tr_b16 v[24:25], v233 offset:8192
    ds_read_b64_tr_b16 v[26:27], v245 offset:8192
    ds_read_b128 v[32:35], v240 offset:0
    s_waitcnt lgkmcnt(5)
    v_mfma_f32_32x32x16_bf16 v[64:79], v[28:31], v[44:47], v[64:79]
    v_sub_f32 v180, v116, v168
    v_sub_f32 v181, v117, v170
    v_cvt_pk_bf16_f32 v181, v180, v181
    v_lshlrev_b32 v180, 16, v181
    ds_read_b128 v[36:39], v240 offset:4096
    s_waitcnt lgkmcnt(5)
    v_mfma_f32_32x32x16_bf16 v[80:95], v[28:31], v[128:131], v[80:95]
    v_and_b32 v181, s13, v181
    v_mul_f32 v180, v180, v169
    v_mul_f32 v181, v181, v171
    v_cvt_pk_bf16_f32 v181, v180, v181
    ds_read_b128 v[40:43], v240 offset:8192
    s_waitcnt lgkmcnt(5)
    v_mfma_f32_32x32x16_bf16 v[96:111], v[28:31], v[132:135], v[96:111]
    v_lshlrev_b32 v180, 16, v181
    v_and_b32 v181, s13, v181
    v_mul_f32 v180, v180, v125
    v_mul_f32 v181, v181, v125
    ds_read_b64_tr_b16 v[28:29], v233 offset:12288
    ds_read_b64_tr_b16 v[30:31], v245 offset:12288
    ds_read_b128 v[44:47], v241 offset:0
    s_waitcnt lgkmcnt(5)
    v_mfma_f32_32x32x16_bf16 v[64:79], v[24:27], v[32:35], v[64:79]
    v_cvt_pk_bf16_f32 v181, v180, v181
    v_lshlrev_b32 v180, 16, v181
    v_and_b32 v181, s13, v181
    v_add_f32 v116, v116, v180
    ds_read_b128 v[128:131], v241 offset:4096
    s_waitcnt lgkmcnt(5)
    v_mfma_f32_32x32x16_bf16 v[80:95], v[24:27], v[36:39], v[80:95]
    v_add_f32 v117, v117, v181
    v_lshlrev_b32 v118, 16, v118
    v_lshlrev_b32 v119, 16, v119
    v_sub_f32 v180, v118, v172
    ds_read_b128 v[132:135], v241 offset:8192
    s_waitcnt lgkmcnt(5)
    v_mfma_f32_32x32x16_bf16 v[96:111], v[24:27], v[40:43], v[96:111]
    v_sub_f32 v181, v119, v174
    v_cvt_pk_bf16_f32 v181, v180, v181
    v_lshlrev_b32 v180, 16, v181
    v_and_b32 v181, s13, v181
    s_waitcnt lgkmcnt(2)
    v_mfma_f32_32x32x16_bf16 v[64:79], v[28:31], v[44:47], v[64:79]
    v_mul_f32 v180, v180, v173
    v_mul_f32 v181, v181, v175
    v_cvt_pk_bf16_f32 v181, v180, v181
    v_lshlrev_b32 v180, 16, v181
    s_waitcnt lgkmcnt(1)
    v_mfma_f32_32x32x16_bf16 v[80:95], v[28:31], v[128:131], v[80:95]
    v_and_b32 v181, s13, v181
    v_mul_f32 v180, v180, v125
    v_mul_f32 v181, v181, v125
    v_cvt_pk_bf16_f32 v181, v180, v181
    s_waitcnt lgkmcnt(0)
    v_mfma_f32_32x32x16_bf16 v[96:111], v[28:31], v[132:135], v[96:111]
    v_lshlrev_b32 v180, 16, v181
    v_and_b32 v181, s13, v181
    v_add_f32 v118, v118, v180
    v_add_f32 v119, v119, v181
K2_J:
    s_mul_i32 s35, s47, 196608
    s_mul_i32 s14, s7, 1536
    s_add_u32 s35, s35, s14
    s_add_u32 s35, s35, 44040192
    v_lshlrev_b32 v2, 3, v1
    s_and_b32 s12, s44, 3
    s_cmp_eq_u32 s44, 4
    s_cselect_b32 s41, 0, 12288
    s_nop 3
    v_cvt_pk_bf16_f32 v144, v68, v69
    v_cvt_pk_bf16_f32 v145, v70, v71
    v_cvt_pk_bf16_f32 v146, v84, v85
    v_cvt_pk_bf16_f32 v147, v86, v87
    v_cvt_pk_bf16_f32 v148, v100, v101
    v_cvt_pk_bf16_f32 v149, v102, v103
    s_xor_b32 s14, s12, 1
    s_mul_i32 s14, s14, 49152
    s_add_u32 s14, s14, s35
    s_mul_i32 s13, s41, 1
    s_add_u32 s14, s14, s13
    buffer_store_dwordx4 v[144:147], v3, s[48:51], s14 offen sc1
    buffer_store_dwordx2 v[148:149], v2, s[48:51], s14 offen offset:1024 sc1
    v_cvt_pk_bf16_f32 v152, v72, v73
    v_cvt_pk_bf16_f32 v153, v74, v75
    v_cvt_pk_bf16_f32 v154, v88, v89
    v_cvt_pk_bf16_f32 v155, v90, v91
    v_cvt_pk_bf16_f32 v156, v104, v105
    v_cvt_pk_bf16_f32 v157, v106, v107
    s_xor_b32 s14, s12, 2
    s_mul_i32 s14, s14, 49152
    s_add_u32 s14, s14, s35
    s_mul_i32 s13, s41, 2
    s_add_u32 s14, s14, s13
    buffer_store_dwordx4 v[152:155], v3, s[48:51], s14 offen sc1
    buffer_store_dwordx2 v[156:157], v2, s[48:51], s14 offen offset:1024 sc1
    v_cvt_pk_bf16_f32 v160, v76, v77
    v_cvt_pk_bf16_f32 v161, v78, v79
    v_cvt_pk_bf16_f32 v162, v92, v93
    v_cvt_pk_bf16_f32 v163, v94, v95
    v_cvt_pk_bf16_f32 v164, v108, v109
    v_cvt_pk_bf16_f32 v165, v110, v111
    s_xor_b32 s14, s12, 3
    s_mul_i32 s14, s14, 49152
    s_add_u32 s14, s14, s35
    s_mul_i32 s13, s41, 3
    s_add_u32 s14, s14, s13
    buffer_store_dwordx4 v[160:163], v3, s[48:51], s14 offen sc1
    buffer_store_dwordx2 v[164:165], v2, s[48:51], s14 offen offset:1024 sc1
    s_cmp_lg_u32 s44, 4
    s_cbranch_scc1 NOPUB0
    v_cvt_pk_bf16_f32 v136, v64, v65
    v_cvt_pk_bf16_f32 v137, v66, v67
    v_cvt_pk_bf16_f32 v138, v80, v81
    v_cvt_pk_bf16_f32 v139, v82, v83
    v_cvt_pk_bf16_f32 v140, v96, v97
    v_cvt_pk_bf16_f32 v141, v98, v99
    s_xor_b32 s14, s12, 0
    s_mul_i32 s14, s14, 49152
    s_add_u32 s14, s14, s35
    s_mul_i32 s13, s41, 0
    s_add_u32 s14, s14, s13
    buffer_store_dwordx4 v[136:139], v3, s[48:51], s14 offen sc1
    buffer_store_dwordx2 v[140:141], v2, s[48:51], s14 offen offset:1024 sc1
NOPUB0:
    s_lshl_b32 s33, s47, 7
    s_add_u32 s33, s33, 65028096
    v_min_u32 v14, 4, v1
    v_lshlrev_b32 v14, 2, v14
    s_waitcnt vmcnt(0)
    s_barrier
    s_cmp_lg_u32 s7, 0
    s_cbranch_scc1 NOFLAG_51
    s_lshl_b32 s14, s44, 2
    s_add_u32 s14, s14, s33
    v_mov_b32 v12, s15
    s_mov_b64 exec, 1
    buffer_store_dword v12, off, s[48:51], s14 sc1
    s_mov_b64 exec, -1
NOFLAG_51:
    s_cmp_eq_u32 s44, 4
    s_cbranch_scc1 K_FIN
    buffer_load_dword v13, v14, s[48:51], s33 offen sc1
    s_mov_b32 s13, 0xffff0000
    v_lshlrev_b32 v120, 16, v120
    v_lshlrev_b32 v121, 16, v121
    v_sub_f32 v180, v120, v168
    v_sub_f32 v181, v121, v170
    v_cvt_pk_bf16_f32 v181, v180, v181
    v_lshlrev_b32 v180, 16, v181
    v_and_b32 v181, s13, v181
    v_mul_f32 v180, v180, v169
    v_mul_f32 v181, v181, v171
    v_cvt_pk_bf16_f32 v181, v180, v181
    v_lshlrev_b32 v180, 16, v181
    v_and_b32 v181, s13, v181
    v_mul_f32 v180, v180, v126
    v_mul_f32 v181, v181, v126
    v_cvt_pk_bf16_f32 v181, v180, v181
    v_lshlrev_b32 v180, 16, v181
    v_and_b32 v181, s13, v181
    v_add_f32 v120, v120, v180
    v_add_f32 v121, v121, v181
    v_lshlrev_b32 v122, 16, v122
    v_lshlrev_b32 v123, 16, v123
    v_sub_f32 v180, v122, v172
    v_sub_f32 v181, v123, v174
    v_cvt_pk_bf16_f32 v181, v180, v181
    v_lshlrev_b32 v180, 16, v181
    v_and_b32 v181, s13, v181
    v_mul_f32 v180, v180, v173
    v_mul_f32 v181, v181, v175
    v_cvt_pk_bf16_f32 v181, v180, v181
    v_lshlrev_b32 v180, 16, v181
    v_and_b32 v181, s13, v181
    v_mul_f32 v180, v180, v126
    v_mul_f32 v181, v181, v126
    v_cvt_pk_bf16_f32 v181, v180, v181
    v_lshlrev_b32 v180, 16, v181
    v_and_b32 v181, s13, v181
    v_add_f32 v122, v122, v180
    v_add_f32 v123, v123, v181
    v_add_f32 v64, v64, v112
    v_add_f32 v65, v65, v113
    v_add_f32 v66, v66, v114
    v_add_f32 v67, v67, v115
    v_add_f32 v80, v80, v116
    v_add_f32 v81, v81, v117
    v_add_f32 v82, v82, v118
    v_add_f32 v83, v83, v119
    v_add_f32 v96, v96, v120
    v_add_f32 v97, v97, v121
    v_add_f32 v98, v98, v122
    v_add_f32 v99, v99, v123
    s_mul_i32 s14, s44, 49152
    s_add_u32 s14, s14, s35
    s_waitcnt vmcnt(0)
    v_cmp_ne_u32 vcc, s15, v13
    s_cbranch_vccnz SLOW_52
BACK_53:
    buffer_load_dwordx4 v[136:139], v3, s[48:51], s14 offen sc1
    buffer_load_dwordx2 v[140:141], v2, s[48:51], s14 offen offset:1024 sc1
    s_add_u32 s14, s14, 12288
    buffer_load_dwordx4 v[144:147], v3, s[48:51], s14 offen sc1
    buffer_load_dwordx2 v[148:149], v2, s[48:51], s14 offen offset:1024 sc1
    s_add_u32 s14, s14, 12288
    buffer_load_dwordx4 v[152:155], v3, s[48:51], s14 offen sc1
    buffer_load_dwordx2 v[156:157], v2, s[48:51], s14 offen offset:1024 sc1
    s_add_u32 s14, s14, 12288
    buffer_load_dwordx4 v[160:163], v3, s[48:51], s14 offen sc1
    buffer_load_dwordx2 v[164:165], v2, s[48:51], s14 offen offset:1024 sc1
    s_waitcnt vmcnt(6)
    v_lshlrev_b32 v12, 16, v136
    v_and_b32 v13, s13, v136
    v_pk_add_f32 v[64:65], v[64:65], v[12:13]
    v_lshlrev_b32 v12, 16, v137
    v_and_b32 v13, s13, v137
    v_pk_add_f32 v[66:67], v[66:67], v[12:13]
    v_lshlrev_b32 v12, 16, v138
    v_and_b32 v13, s13, v138
    v_pk_add_f32 v[80:81], v[80:81], v[12:13]
    v_lshlrev_b32 v12, 16, v139
    v_and_b32 v13, s13, v139
    v_pk_add_f32 v[82:83], v[82:83], v[12:13]
    v_lshlrev_b32 v12, 16, v140
    v_and_b32 v13, s13, v140
    v_pk_add_f32 v[96:97], v[96:97], v[12:13]
    v_lshlrev_b32 v12, 16, v141
    v_and_b32 v13, s13, v141
    v_pk_add_f32 v[98:99], v[98:99], v[12:13]
    s_waitcnt vmcnt(4)
    v_lshlrev_b32 v12, 16, v144
    v_and_b32 v13, s13, v144
    v_pk_add_f32 v[64:65], v[64:65], v[12:13]
    v_lshlrev_b32 v12, 16, v145
    v_and_b32 v13, s13, v145
    v_pk_add_f32 v[66:67], v[66:67], v[12:13]
    v_lshlrev_b32 v12, 16, v146
    v_and_b32 v13, s13, v146
    v_pk_add_f32 v[80:81], v[80:81], v[12:13]
    v_lshlrev_b32 v12, 16, v147
    v_and_b32 v13, s13, v147
    v_pk_add_f32 v[82:83], v[82:83], v[12:13]
    v_lshlrev_b32 v12, 16, v148
    v_and_b32 v13, s13, v148
    v_pk_add_f32 v[96:97], v[96:97], v[12:13]
    v_lshlrev_b32 v12, 16, v149
    v_and_b32 v13, s13, v149
    v_pk_add_f32 v[98:99], v[98:99], v[12:13]
    s_waitcnt vmcnt(2)
    v_lshlrev_b32 v12, 16, v152
    v_and_b32 v13, s13, v152
    v_pk_add_f32 v[64:65], v[64:65], v[12:13]
    v_lshlrev_b32 v12, 16, v153
    v_and_b32 v13, s13, v153
    v_pk_add_f32 v[66:67], v[66:67], v[12:13]
    v_lshlrev_b32 v12, 16, v154
    v_and_b32 v13, s13, v154
    v_pk_add_f32 v[80:81], v[80:81], v[12:13]
    v_lshlrev_b32 v12, 16, v155
    v_and_b32 v13, s13, v155
    v_pk_add_f32 v[82:83], v[82:83], v[12:13]
    v_lshlrev_b32 v12, 16, v156
    v_and_b32 v13, s13, v156
    v_pk_add_f32 v[96:97], v[96:97], v[12:13]
    v_lshlrev_b32 v12, 16, v157
    v_and_b32 v13, s13, v157
    v_pk_add_f32 v[98:99], v[98:99], v[12:13]
    s_waitcnt vmcnt(0)
    v_lshlrev_b32 v12, 16, v160
    v_and_b32 v13, s13, v160
    v_pk_add_f32 v[64:65], v[64:65], v[12:13]
    v_lshlrev_b32 v12, 16, v161
    v_and_b32 v13, s13, v161
    v_pk_add_f32 v[66:67], v[66:67], v[12:13]
    v_lshlrev_b32 v12, 16, v162
    v_and_b32 v13, s13, v162
    v_pk_add_f32 v[80:81], v[80:81], v[12:13]
    v_lshlrev_b32 v12, 16, v163
    v_and_b32 v13, s13, v163
    v_pk_add_f32 v[82:83], v[82:83], v[12:13]
    v_lshlrev_b32 v12, 16, v164
    v_and_b32 v13, s13, v164
    v_pk_add_f32 v[96:97], v[96:97], v[12:13]
    v_lshlrev_b32 v12, 16, v165
    v_and_b32 v13, s13, v165
    v_pk_add_f32 v[98:99], v[98:99], v[12:13]
    s_add_u32 s14, s31, 0
    buffer_store_dword v64, v7, s[52:55], s14 offen offset:0 sc1
    buffer_store_dword v80, v7, s[52:55], s14 offen offset:128 sc1
    buffer_store_dword v96, v7, s[52:55], s14 offen offset:256 sc1
    s_add_u32 s14, s31, 2304
    buffer_store_dword v65, v7, s[52:55], s14 offen offset:0 sc1
    buffer_store_dword v81, v7, s[52:55], s14 offen offset:128 sc1
    buffer_store_dword v97, v7, s[52:55], s14 offen offset:256 sc1
    s_add_u32 s14, s31, 4608
    buffer_store_dword v66, v7, s[52:55], s14 offen offset:0 sc1
    buffer_store_dword v82, v7, s[52:55], s14 offen offset:128 sc1
    buffer_store_dword v98, v7, s[52:55], s14 offen offset:256 sc1
    s_add_u32 s14, s31, 6912
    buffer_store_dword v67, v7, s[52:55], s14 offen offset:0 sc1
    buffer_store_dword v83, v7, s[52:55], s14 offen offset:128 sc1
    buffer_store_dword v99, v7, s[52:55], s14 offen offset:256 sc1
K_FIN:
K_END:
    s_endpgm
TAGSLOW_3:
    s_sub_u32 s23, s23, 1
    s_cbranch_scc1 TAGBACK_4
    s_sleep 1
    buffer_load_dword v15, off, s[72:75], 0 sc1
    s_waitcnt vmcnt(0)
    v_readfirstlane_b32 s15, v15
    s_cmp_eq_u32 s15, 0
    s_cbranch_scc1 TAGSLOW_3
    s_branch TAGBACK_4
SLOW_6:
    s_sub_u32 s23, s23, 1
    s_cbranch_scc1 BACK_7
    s_sleep 1
    buffer_load_dword v16, v17, s[48:51], s33 offen sc1
    s_waitcnt vmcnt(0)
    v_cmp_ne_u32 vcc, s15, v16
    s_cbranch_vccnz SLOW_6
    s_branch BACK_7
SLOW_14:
    s_sub_u32 s23, s23, 1
    s_cbranch_scc1 BACK_15
    s_sleep 1
    buffer_load_dword v13, v15, s[48:51], s33 offen sc1
    s_waitcnt vmcnt(0)
    v_cmp_ne_u32 vcc, s15, v13
    s_cbranch_vccnz SLOW_14
    s_branch BACK_15
SLOW_16:
    s_sub_u32 s23, s23, 1
    s_cbranch_scc1 BACK_17
    s_sleep 1
    buffer_load_dword v12, v15, s[48:51], s32 offen sc1
    s_waitcnt vmcnt(0)
    v_cmp_ne_u32 vcc, s15, v12
    s_cbranch_vccnz SLOW_16
    s_branch BACK_17
SLOW_20:
    s_sub_u32 s23, s23, 1
    s_cbranch_scc1 BACK_21
    s_sleep 1
    buffer_load_dword v24, v14, s[48:51], s24 offen sc1
    s_waitcnt vmcnt(0)
    v_cmp_ne_u32 vcc, s15, v24
    s_cbranch_vccnz SLOW_20
    s_branch BACK_21
SLOW_22:
    s_sub_u32 s23, s23, 1
    s_cbranch_scc1 BACK_23
    s_sleep 1
    buffer_load_dword v25, v14, s[48:51], s25 offen sc1
    s_waitcnt vmcnt(0)
    v_cmp_ne_u32 vcc, s15, v25
    s_cbranch_vccnz SLOW_22
    s_branch BACK_23
SLOW_24:
    s_sub_u32 s23, s23, 1
    s_cbranch_scc1 BACK_25
    s_sleep 1
    buffer_load_dword v26, v14, s[48:51], s26 offen sc1
    s_waitcnt vmcnt(0)
    v_cmp_ne_u32 vcc, s15, v26
    s_cbranch_vccnz SLOW_24
    s_branch BACK_25
SLOW_26:
    s_sub_u32 s23, s23, 1
    s_cbranch_scc1 BACK_27
    s_sleep 1
    buffer_load_dword v27, v14, s[48:51], s27 offen sc1
    s_waitcnt vmcnt(0)
    v_cmp_ne_u32 vcc, s15, v27
    s_cbranch_vccnz SLOW_26
    s_branch BACK_27
SLOW_33:
    s_sub_u32 s23, s23, 1
    s_cbranch_scc1 BACK_34
    s_sleep 1
    buffer_load_dword v12, v15, s[48:51], s78 offen sc1
    s_waitcnt vmcnt(0)
    v_cmp_ne_u32 vcc, s15, v12
    s_cbranch_vccnz SLOW_33
    s_branch BACK_34
SLOW_36:
    s_sub_u32 s23, s23, 1
    s_cbranch_scc1 BACK_37
    s_sleep 1
    buffer_load_dword v12, v15, s[48:51], s79 offen sc1
    s_waitcnt vmcnt(0)
    v_cmp_ne_u32 vcc, s15, v12
    s_cbranch_vccnz SLOW_36
    s_branch BACK_37
SLOW_39:
    s_sub_u32 s23, s23, 1
    s_cbranch_scc1 BACK_40
    s_sleep 1
    buffer_load_dword v12, v15, s[48:51], s8 offen sc1
    s_waitcnt vmcnt(0)
    v_cmp_ne_u32 vcc, s15, v12
    s_cbranch_vccnz SLOW_39
    s_branch BACK_40
SLOW_41:
    s_sub_u32 s23, s23, 1
    s_cbranch_scc1 BACK_42
    s_sleep 1
    buffer_load_dword v13, v242, s[48:51], s33 offen sc1
    s_waitcnt vmcnt(0)
    v_cmp_ne_u32 vcc, s15, v13
    s_cbranch_vccnz SLOW_41
    s_branch BACK_42
SLOW_44:
    s_sub_u32 s23, s23, 1
    s_cbranch_scc1 BACK_45
    s_sleep 1
    buffer_load_dword v13, v242, s[48:51], s28 offen sc1
    s_waitcnt vmcnt(0)
    v_cmp_ne_u32 vcc, s15, v13
    s_cbranch_vccnz SLOW_44
    s_branch BACK_45
SLOW_46:
    s_sub_u32 s23, s23, 1
    s_cbranch_scc1 BACK_47
    s_sleep 1
    buffer_load_dword v13, v242, s[48:51], s33 offen sc1
    s_waitcnt vmcnt(0)
    v_cmp_ne_u32 vcc, s15, v13
    s_cbranch_vccnz SLOW_46
    s_branch BACK_47
SLOW_49:
    s_sub_u32 s23, s23, 1
    s_cbranch_scc1 BACK_50
    s_sleep 1
    buffer_load_dword v13, v242, s[48:51], s28 offen sc1
    s_waitcnt vmcnt(0)
    v_cmp_ne_u32 vcc, s15, v13
    s_cbranch_vccnz SLOW_49
    s_branch BACK_50
SLOW_52:
    s_sub_u32 s23, s23, 1
    s_cbranch_scc1 BACK_53
    s_sleep 1
    buffer_load_dword v13, v14, s[48:51], s33 offen sc1
    s_waitcnt vmcnt(0)
    v_cmp_ne_u32 vcc, s15, v13
    s_cbranch_vccnz SLOW_52
    s_branch BACK_53
K_LAST:
    s_endpgm
.section .rodata,"a"
.p2align 6
.amdhsa_kernel parallel_sum__ssm_conv_s5__geglu_ffn__prompt_kernel
  .amdhsa_next_free_vgpr 256
  .amdhsa_next_free_sgpr 102
  .amdhsa_accum_offset 256
  .amdhsa_group_segment_fixed_size 0
  .amdhsa_kernarg_size 128
  .amdhsa_user_sgpr_count 2
  .amdhsa_user_sgpr_kernarg_segment_ptr 1
  .amdhsa_system_sgpr_workgroup_id_x 1
  .amdhsa_float_denorm_mode_32 3
.end_amdhsa_kernel
```
